```python
import torch

def _softmax(x, axis=-1):
    return torch.softmax(x, dim=axis)

def _gelu(x):
    return torch.nn.functional.gelu(x, approximate='tanh')

def _silu(x):
    return torch.nn.functional.silu(x)

def _sigmoid(x):
    return torch.sigmoid(x)

def _layernorm(x, axis=-1, eps=1e-05):
    m = x.mean(dim=axis, keepdim=True)
    v = x.var(dim=axis, keepdim=True, unbiased=False)
    return (x - m) / torch.sqrt(v + eps)

def _scatter_add(tgt, idx, src, axis=0):
    return tgt.clone().index_add_(axis, idx, src)

def _segment_sum(src, seg, n):
    out = torch.zeros((n,) + src.shape[1:], dtype=src.dtype)
    return out.index_add_(0, seg, src)

def _pad(x, pw):
    flat = tuple((v for pair in reversed(pw) for v in pair))
    return torch.nn.functional.pad(x, flat)
kernel_name = 'gated_mix__memory_aug_recurrent_mem_tr__ssm_conv_s4__prompt'

def setup_inputs():

    _w = lambda a: (lambda t: t.to(torch.bfloat16) if t.is_floating_point() else t)(torch.as_tensor(a))

    def _A_setup():
        B, S, Dm = (1, 2048, 640)
        H, Dh = (32, 128)
        M, seg = (8, 32)
        seg = min(seg, S)
        S = S // seg * seg
        return {'x': _w((lambda *s: torch.randn(*s, dtype=torch.bfloat16) * 0.05)(B, S, Dm)), 'mem0': _w((lambda *s: torch.randn(*s, dtype=torch.bfloat16) * 0.4)(B, M, Dm)), 'Wq': _w((lambda *s: torch.randn(*s, dtype=torch.bfloat16) * 6.4)(Dm, H, Dh) * Dm ** (-0.5)), 'Wk': _w((lambda *s: torch.randn(*s, dtype=torch.bfloat16) * 6.4)(Dm, H, Dh) * Dm ** (-0.5)), 'Wv': _w((lambda *s: torch.randn(*s, dtype=torch.bfloat16) * 0.4)(Dm, H, Dh) * Dm ** (-0.5)), 'Wo': _w((lambda *s: torch.randn(*s, dtype=torch.bfloat16) * 0.4)(H, Dh, Dm) * (H * Dh) ** (-0.5)), 'seg_len': seg}
    _A_in = _A_setup()

    def _B_setup():
        B, L, D, N = (1, 2048, 640, 128)
        A_re = -(lambda _x: torch.exp(torch.as_tensor(_x)))((lambda *s: torch.randn(*s, dtype=torch.bfloat16) * 6.4)(D, N))
        A_im = torch.pi * (lambda *s: torch.randn(*s, dtype=torch.bfloat16) * 0.05)(D, N)
        B_re = (lambda *s: torch.randn(*s, dtype=torch.bfloat16) * 0.1)(D, N)
        B_im = (lambda *s: torch.randn(*s, dtype=torch.bfloat16) * 0.1)(D, N)
        C_re = (lambda *s: torch.randn(*s, dtype=torch.bfloat16) * 0.1)(D, N)
        C_im = (lambda *s: torch.randn(*s, dtype=torch.bfloat16) * 0.1)(D, N)
        log_dt = (lambda *s: torch.randn(*s, dtype=torch.bfloat16) * 0.05)(D) * 0.5 - 4.0
        Dskip = (lambda *s: torch.randn(*s, dtype=torch.bfloat16) * 0.05)(D)
        return {'u': _w((lambda *s: torch.randn(*s, dtype=torch.bfloat16) * 0.05)(B, L, D)), 'A_re': _w(A_re), 'A_im': _w(A_im), 'B_re': _w(B_re), 'B_im': _w(B_im), 'C_re': _w(C_re), 'C_im': _w(C_im), 'log_dt': _w(log_dt), 'Dskip': _w(Dskip)}
    _B_in = _B_setup()
    return {'A_x': _A_in['x'], 'A_mem0': _A_in['mem0'], 'A_Wq': _A_in['Wq'], 'A_Wk': _A_in['Wk'], 'A_Wv': _A_in['Wv'], 'A_Wo': _A_in['Wo'], 'A_seg_len': _A_in['seg_len'], 'B_u': _B_in['u'], 'B_A_re': _B_in['A_re'], 'B_A_im': _B_in['A_im'], 'B_B_re': _B_in['B_re'], 'B_B_im': _B_in['B_im'], 'B_C_re': _B_in['C_re'], 'B_C_im': _B_in['C_im'], 'B_log_dt': _B_in['log_dt'], 'B_Dskip': _B_in['Dskip'], 'gate_w': _w((lambda *s: torch.randn(*s, dtype=torch.bfloat16) * 0.05)(640) * 16.0)}

def reference(A_x, A_mem0, A_Wq, A_Wk, A_Wv, A_Wo, A_seg_len, B_u, B_A_re, B_A_im, B_B_re, B_B_im, B_C_re, B_C_im, B_log_dt, B_Dskip, gate_w):

    def _A_ref(x, mem0, Wq, Wk, Wv, Wo, seg_len):
        B, S, Dm = x.shape
        H, Dh = (Wq.shape[1], Wq.shape[2])
        M = mem0.shape[1]
        scale = Dh ** (-0.5)
        n_seg = S // seg_len
        L = M + seg_len
        idx = torch.arange(L)
        mask = (idx[:, None] < M) | (idx[:, None] >= idx[None, :])
        mem = mem0
        outs = []
        for s in range(n_seg):
            xs = x[:, s * seg_len:(s + 1) * seg_len, :].clone()
            h = torch.concatenate([mem, xs], axis=1)
            q = torch.einsum('btd,dhe->bhte', h, Wq)
            k = torch.einsum('btd,dhe->bhte', h, Wk)
            v = torch.einsum('btd,dhe->bhte', h, Wv)
            scores = torch.einsum('bhqe,bhke->bhqk', q, k) * scale
            scores = torch.where(mask[None, None], scores, -1000000000.0)
            p = _softmax(scores, axis=-1)
            o = torch.einsum('bhqk,bhke->bhqe', p, v)
            o = torch.einsum('bhte,hed->btd', o, Wo)
            mem = o[:, :M, :].clone()
            outs.append(o[:, M:, :])
        return torch.concatenate(outs, axis=1)

    def _B_ref(u, A_re, A_im, B_re, B_im, C_re, C_im, log_dt, Dskip):
        Bsz, L, D = u.shape
        dt = torch.exp(log_dt)[:, None]
        A = A_re + 1j * A_im
        Bc = B_re + 1j * B_im
        Cc = C_re + 1j * C_im
        logdA = dt * A
        dB = dt * Bc
        l = (lambda x, dt: x.to(dt))(torch.arange(L), A_re.dtype)
        P = torch.exp(logdA[:, :, None] * l[None, None, :])
        K = torch.einsum('dn,dnl,dn->dl', Cc, P, dB).real
        L2 = 2 * L
        Kp = _pad(K, ((0, 0), (0, L)))
        up = (lambda x, *d: x.permute(*d))(u, 0, 2, 1)
        up = _pad(up, ((0, 0), (0, 0), (0, L)))
        Kf = (lambda x, axes=(-2, -1): torch.fft.rfft2(x.float(), dim=axes))(Kp[:, None, :], axes=(-2, -1))
        Uf = (lambda x, axes=(-2, -1): torch.fft.rfft2(x.float(), dim=axes))(up[:, :, None, :], axes=(-2, -1))
        Yf = Uf * Kf[None, :, :, :]
        y = (lambda x, s, axes=(-2, -1): torch.fft.irfft2(x, s=s, dim=axes).to(torch.bfloat16))(Yf, (1, L2), axes=(-2, -1))[:, :, 0, :L]
        y = (lambda x, *d: x.permute(*d))(y, 0, 2, 1) + u * Dskip[None, None, :]
        return y
    x = A_x
    g = _sigmoid((x * gate_w).sum(-1, keepdims=True))
    a = _A_ref(x, A_mem0, A_Wq, A_Wk, A_Wv, A_Wo, A_seg_len)
    b = _B_ref(x, B_A_re, B_A_im, B_B_re, B_B_im, B_C_re, B_C_im, B_log_dt, B_Dskip)
    return g * a + (1 - g) * b
```

```asm
; @launch kernel=fused_kernel grid=(256,1,1) block=(256,1,1) lds=151552
.amdgcn_target "amdgcn-amd-amdhsa--gfx950"
.text
.globl fused_kernel
.p2align 8
.type fused_kernel,@function
fused_kernel:
    s_cmp_ge_u32 s2, 256
    s_cbranch_scc1 fused_kernel_exit
    s_load_dwordx16 s[32:47], s[0:1], 0
    s_load_dwordx4 s[60:63], s[0:1], 144
    s_getreg_b32 s12, hwreg(HW_REG_XCC_ID)
    s_and_b32 s12, s12, 7
    s_mov_b32 s2, s12
    v_mov_b32 v250, v0
    v_lshrrev_b32 v2, 6, v0
    v_and_b32 v0, 63, v0
    s_nop 0
    v_readfirstlane_b32 s14, v2
    s_waitcnt lgkmcnt(0)
    s_mov_b32 s4, s62
    s_and_b32 s5, s63, 0xffff
    s_mov_b32 s6, 268435456
    s_mov_b32 s7, 0x00020000
    s_mov_b32 s96, s60
    s_and_b32 s97, s61, 0xffff
    s_mov_b32 s98, 256
    s_mov_b32 s99, 0x00020000
    s_cmp_lg_u32 s14, 0
    s_cbranch_scc1 Lrk
    s_mov_b64 exec, 1
    v_mov_b32 v2, 1
    v_mov_b32 v3, s12
    v_lshlrev_b32 v3, 2, v3
    buffer_atomic_add v2, v3, s[96:99], 0 offen sc0 sc1
    s_waitcnt vmcnt(0)
    v_mov_b32 v3, 151488
    ds_write_b32 v3, v2
    s_waitcnt lgkmcnt(0)
    s_mov_b64 exec, -1
Lrk:
    s_barrier
    v_mov_b32 v3, 151488
    ds_read_b32 v2, v3
    s_waitcnt lgkmcnt(0)
    v_readfirstlane_b32 s13, v2
    s_barrier
    s_cmp_lt_u32 s13, 32
    s_cbranch_scc1 Lrole
    v_mov_b32 v2, 1
    v_mov_b32 v3, 40
    s_mov_b64 exec, 1
    buffer_atomic_or v2, v3, s[96:99], 0 offen sc1
    s_waitcnt vmcnt(0)
    s_mov_b64 exec, -1
    s_cmp_lg_u32 s14, 0
    s_cbranch_scc1 Lsur
    s_mov_b64 exec, 1
    v_mov_b32 v2, 1
    v_mov_b32 v3, 44
    buffer_atomic_add v2, v3, s[96:99], 0 offen sc0 sc1
    s_waitcnt vmcnt(0)
    v_mov_b32 v3, 151488
    ds_write_b32 v3, v2
    s_waitcnt lgkmcnt(0)
    s_mov_b64 exec, -1
Lsur:
    s_barrier
    v_mov_b32 v3, 151488
    ds_read_b32 v2, v3
    s_waitcnt lgkmcnt(0)
    v_readfirstlane_b32 s16, v2
    s_barrier
    v_mov_b32 v3, 0
    s_mov_b32 s17, 0
Lsw:
    buffer_load_dwordx4 v[4:7], v3, s[96:99], 0 offen sc1
    buffer_load_dwordx4 v[8:11], v3, s[96:99], 0 offen offset:16 sc1
    s_waitcnt vmcnt(0)
    v_readfirstlane_b32 s20, v4
    v_readfirstlane_b32 s21, v5
    v_readfirstlane_b32 s22, v6
    v_readfirstlane_b32 s23, v7
    v_readfirstlane_b32 s24, v8
    v_readfirstlane_b32 s25, v9
    v_readfirstlane_b32 s26, v10
    v_readfirstlane_b32 s27, v11
    s_add_u32 s17, s17, 1
    s_cmp_gt_u32 s17, 0x100000
    s_cbranch_scc1 fused_kernel_exit
    s_add_u32 s18, s20, s21
    s_add_u32 s18, s18, s22
    s_add_u32 s18, s18, s23
    s_add_u32 s18, s18, s24
    s_add_u32 s18, s18, s25
    s_add_u32 s18, s18, s26
    s_add_u32 s18, s18, s27
    s_cmp_lt_u32 s18, 256
    s_cbranch_scc1 Lsw
    s_min_u32 s18, s20, 32
    s_sub_u32 s19, 32, s18
    s_mov_b32 s12, 0
    s_add_u32 s13, s18, s16
    s_cmp_lt_u32 s16, s19
    s_cbranch_scc1 Lrole
    s_sub_u32 s16, s16, s19
    s_min_u32 s18, s21, 32
    s_sub_u32 s19, 32, s18
    s_mov_b32 s12, 1
    s_add_u32 s13, s18, s16
    s_cmp_lt_u32 s16, s19
    s_cbranch_scc1 Lrole
    s_sub_u32 s16, s16, s19
    s_min_u32 s18, s22, 32
    s_sub_u32 s19, 32, s18
    s_mov_b32 s12, 2
    s_add_u32 s13, s18, s16
    s_cmp_lt_u32 s16, s19
    s_cbranch_scc1 Lrole
    s_sub_u32 s16, s16, s19
    s_min_u32 s18, s23, 32
    s_sub_u32 s19, 32, s18
    s_mov_b32 s12, 3
    s_add_u32 s13, s18, s16
    s_cmp_lt_u32 s16, s19
    s_cbranch_scc1 Lrole
    s_sub_u32 s16, s16, s19
    s_min_u32 s18, s24, 32
    s_sub_u32 s19, 32, s18
    s_mov_b32 s12, 4
    s_add_u32 s13, s18, s16
    s_cmp_lt_u32 s16, s19
    s_cbranch_scc1 Lrole
    s_sub_u32 s16, s16, s19
    s_min_u32 s18, s25, 32
    s_sub_u32 s19, 32, s18
    s_mov_b32 s12, 5
    s_add_u32 s13, s18, s16
    s_cmp_lt_u32 s16, s19
    s_cbranch_scc1 Lrole
    s_sub_u32 s16, s16, s19
    s_min_u32 s18, s26, 32
    s_sub_u32 s19, 32, s18
    s_mov_b32 s12, 6
    s_add_u32 s13, s18, s16
    s_cmp_lt_u32 s16, s19
    s_cbranch_scc1 Lrole
    s_sub_u32 s16, s16, s19
    s_min_u32 s18, s27, 32
    s_sub_u32 s19, 32, s18
    s_mov_b32 s12, 7
    s_add_u32 s13, s18, s16
    s_cmp_lt_u32 s16, s19
    s_cbranch_scc1 Lrole
    s_sub_u32 s16, s16, s19
    s_branch fused_kernel_exit
Lrole:
    s_cmp_ge_u32 s12, 4
    s_cbranch_scc1 Lworker
    s_mov_b32 s96, s60
    s_and_b32 s97, s61, 0xffff
    s_mov_b32 s98, 256
    s_mov_b32 s99, 0x00020000
    s_mov_b32 s20, 0x00ff00ff
    s_mov_b32 s21, 0x00ff00ff
    s_mov_b32 s22, 0x03ff03ff
    s_mov_b32 s23, 0x03ff03ff
    s_mov_b32 s24, -1
    s_mov_b32 s25, 0
    s_mov_b32 s51, 0x3e0293ee
    v_lshrrev_b32 v25, 4, v0
    v_and_b32 v26, 15, v0
    v_lshlrev_b32 v2, 4, v0
    v_mov_b32 v27, 0xff800000
    v_mov_b32 v28, -1
    v_mov_b32 v29, -1
    v_mov_b32 v30, -1
    v_mov_b32 v31, -1
    v_mov_b32 v1, 0xeeee
    v_mov_b32 v23, 0x4444
    v_cndmask_b32 v1, v1, v23, s[20:21]
    s_lshl_b32 s56, s12, 10
    s_lshl_b32 s18, s13, 5
    s_add_u32 s56, s56, s18
    s_mul_i32 s18, s14, 3
    s_min_u32 s18, s18, 8
    s_lshl_b32 s18, s18, 10
    v_add_u32 v4, s18, v2
    s_mul_i32 s19, s12, 10240
    s_add_u32 s19, s19, 101007360
    v_add_u32 v3, s19, v4
    v_and_b32 v23, 1, v25
    v_lshlrev_b32 v23, 2, v23
    v_lshrrev_b32 v24, 1, v25
    v_lshl_add_u32 v23, v24, 1, v23
    v_mul_u32_u24 v23, 80, v23
    v_lshl_add_u32 v23, v26, 1, v23
    s_lshr_b32 s18, s14, 1
    s_mul_i32 s18, s18, 640
    s_and_b32 s19, s14, 1
    s_lshl_b32 s19, s19, 5
    s_add_u32 s18, s18, s19
    s_add_u32 s18, s18, 10240
    v_add_u32 v5, s18, v23
    v_and_b32 v23, 7, v0
    v_mul_u32_u24 v24, 80, v23
    v_lshl_add_u32 v24, v25, 4, v24
    v_add_u32 v6, 10240, v24
    v_add_u32 v7, 10880, v24
    v_lshl_add_u32 v23, v25, 3, v23
    v_lshlrev_b32 v23, 4, v23
    s_lshl_b32 s18, s12, 5
    s_add_u32 s18, s18, s13
    s_mul_i32 s19, s18, 1536
    s_lshl_b32 s26, s14, 9
    s_add_u32 s19, s19, s26
    s_add_u32 s19, s19, 100663296
    v_add_u32 v8, s19, v23
    s_and_b32 s18, s18, 0xfffffffc
    s_mul_i32 s19, s18, 1536
    s_add_u32 s19, s19, 100663296
    v_bfe_u32 v24, v0, 3, 1
    v_mul_u32_u24 v24, 3072, v24
    v_add3_u32 v9, s19, v23, v24
    v_bfe_u32 v24, v0, 3, 1
    v_lshlrev_b32 v24, 9, v24
    v_add3_u32 v208, s19, v23, v24
    v_add_u32 v208, 512, v208
    v_add_u32 v209, 3072, v208
    v_mov_b32 v200, 0x3f803f80
    v_mov_b32 v201, 0x3f803f80
    v_mov_b32 v202, 0x3f803f80
    v_mov_b32 v203, 0x3f803f80
    v_mov_b32 v204, 0x3f803f80
    v_mov_b32 v205, 0x3f803f80
    v_mov_b32 v206, 0
    v_mov_b32 v207, 0
    v_mov_b32 v190, 0
    v_mov_b32 v191, 0
    v_mov_b32 v198, 0
    v_mov_b32 v199, 0
    s_lshl_b32 s18, s12, 14
    s_add_u32 s18, s18, 100859904
    s_lshr_b32 s19, s13, 1
    s_lshl_b32 s19, s19, 10
    s_and_b32 s26, s13, 1
    s_lshl_b32 s26, s26, 7
    s_add_u32 s19, s19, s26
    s_add_u32 s19, s19, s18
    v_and_b32 v23, 7, v0
    v_lshlrev_b32 v23, 4, v23
    v_lshl_add_u32 v23, v25, 8, v23
    v_add_u32 v10, s19, v23
    s_lshl_b32 s19, s14, 12
    s_add_u32 s19, s19, s18
    v_add_u32 v11, s19, v2
    s_lshl_b32 s18, s13, 14
    s_add_u32 s18, s18, 167772160
    v_min_u32 v23, 9, v26
    v_mad_u32_u24 v23, v25, 10, v23
    v_lshlrev_b32 v23, 4, v23
    v_add_u32 v13, s18, v23
    s_mul_i32 s19, s12, 640
    v_add_u32 v12, s19, v13
    s_add_u32 s48, s12, 1
    s_and_b32 s48, s48, 3
    s_mul_i32 s48, s48, 640
    s_add_u32 s49, s12, 2
    s_and_b32 s49, s49, 3
    s_mul_i32 s49, s49, 640
    s_add_u32 s50, s12, 3
    s_and_b32 s50, s50, 3
    s_mul_i32 s50, s50, 640
    s_mul_i32 s18, s13, 5
    v_min_u32 v23, 9, v26
    v_lshrrev_b32 v24, 1, v23
    v_add_u32 v24, s18, v24
    v_and_b32 v23, 1, v23
    v_lshlrev_b32 v23, 7, v23
    v_lshrrev_b32 v156, 2, v24
    v_lshl_add_u32 v23, v156, 8, v23
    v_and_b32 v156, 3, v24
    v_lshl_add_u32 v23, v156, 2, v23
    v_and_b32 v156, 1, v25
    v_lshl_add_u32 v23, v156, 6, v23
    v_lshrrev_b32 v156, 1, v25
    v_lshl_add_u32 v23, v156, 4, v23
    s_mul_i32 s19, s12, 10240
    s_add_u32 s19, s19, 101007360
    v_add_u32 v14, s19, v23
    v_lshrrev_b32 v23, 2, v26
    v_lshlrev_b32 v23, 3, v23
    v_and_b32 v24, 3, v26
    v_add_u32 v23, v23, v24
    s_add_u32 s18, s14, 3
    s_and_b32 s18, s18, 1
    s_lshl_b32 s18, s18, 2
    v_add_u32 v23, s18, v23
    v_mul_u32_u24 v23, 8320, v23
    v_lshl_add_u32 v23, v25, 4, v23
    s_lshl_b32 s19, s56, 1
    v_add_u32 v15, s19, v23
    v_mul_u32_u24 v23, 4224, v26
    v_lshl_add_u32 v23, v25, 4, v23
    s_mul_i32 s19, s56, 4224
    s_add_u32 s19, s19, 18874368
    v_add_u32 v16, s19, v23
    v_add_u32 v17, 67584, v16
    v_and_b32 v23, 7, v0
    v_lshlrev_b32 v23, 6, v23
    v_lshl_add_u32 v23, v25, 4, v23
    s_lshl_b32 s19, s56, 4
    s_add_u32 s19, s19, 75497472
    v_add_u32 v18, s19, v23
    v_lshrrev_b32 v23, 1, v25
    v_lshl_add_u32 v23, v23, 4, v26
    v_lshlrev_b32 v23, 4, v23
    v_and_b32 v24, 1, v25
    v_lshl_add_u32 v23, v24, 3, v23
    s_lshl_b32 s19, s56, 4
    s_add_u32 s19, s19, 79691776
    v_add_u32 v19, s19, v23
    s_lshl_b32 s18, s12, 5
    s_add_u32 s18, s18, s13
    s_lshr_b32 s19, s18, 2
    s_lshl_b32 s19, s19, 7
    s_and_b32 s18, s18, 3
    s_lshl_b32 s18, s18, 2
    s_add_u32 s18, s18, s19
    s_add_u32 s18, s18, 104333312
    v_mov_b32 v180, s18
    s_lshl_b32 s18, s14, 10
    v_add_u32 v23, s18, v2
    v_add_u32 v20, 12288, v23
    v_add_u32 v22, 16384, v23
    v_lshrrev_b32 v23, 1, v25
    v_lshlrev_b32 v23, 10, v23
    v_and_b32 v24, 31, v0
    v_lshl_add_u32 v23, v24, 4, v23
    v_add_u32 v21, 12288, v23
    s_cmp_eq_u32 s14, 3
    s_cbranch_scc1 Lpz3_2
    s_mov_b64 exec, s[20:21]
    s_mov_b32 s18, 0
    buffer_store_dwordx4 v[28:31], v8, s[4:7], s18 offen sc1
    s_mov_b32 s18, 524288
    buffer_store_dwordx4 v[28:31], v8, s[4:7], s18 offen sc1
    s_mov_b32 s18, 1048576
    buffer_store_dwordx4 v[28:31], v8, s[4:7], s18 offen sc1
    s_mov_b32 s18, 1572864
    buffer_store_dwordx4 v[28:31], v8, s[4:7], s18 offen sc1
    s_branch Lpz_1
Lpz3_2:
    s_mov_b64 exec, s[20:21]
    s_mov_b32 s18, 0
    buffer_store_dwordx4 v[28:31], v10, s[4:7], s18 offen sc1
    s_mov_b32 s18, 524288
    buffer_store_dwordx4 v[28:31], v10, s[4:7], s18 offen sc1
    s_mov_b32 s18, 1048576
    buffer_store_dwordx4 v[28:31], v10, s[4:7], s18 offen sc1
    s_mov_b32 s18, 1572864
    buffer_store_dwordx4 v[28:31], v10, s[4:7], s18 offen sc1
    s_mov_b64 exec, s[22:23]
    s_mov_b32 s18, 0
    buffer_store_dword v28, v14, s[4:7], s18 offen sc1
    buffer_store_dword v28, v14, s[4:7], s18 offen offset:32 sc1
    s_mov_b32 s18, 524288
    buffer_store_dword v28, v14, s[4:7], s18 offen sc1
    buffer_store_dword v28, v14, s[4:7], s18 offen offset:32 sc1
    s_mov_b32 s18, 1048576
    buffer_store_dword v28, v14, s[4:7], s18 offen sc1
    buffer_store_dword v28, v14, s[4:7], s18 offen offset:32 sc1
    s_mov_b32 s18, 1572864
    buffer_store_dword v28, v14, s[4:7], s18 offen sc1
    buffer_store_dword v28, v14, s[4:7], s18 offen offset:32 sc1
    s_mov_b64 exec, 1
    v_mov_b32 v156, 0
    buffer_store_dword v156, v180, s[4:7], 0 offen sc1
    s_lshl_b32 s18, s12, 5
    s_add_u32 s18, s18, s13
    s_lshl_b32 s18, s18, 7
    s_add_u32 s18, s18, 104398848
    v_mov_b32 v157, s18
    buffer_store_dword v156, v157, s[4:7], 0 offen sc1
Lpz_1:
    s_mov_b64 exec, -1
    s_mov_b32 s8, s42
    s_and_b32 s9, s43, 0xffff
    s_mov_b32 s10, 5242880
    s_mov_b32 s11, 0x00020000
    v_and_b32 v24, 1, v25
    v_lshlrev_b32 v24, 4, v24
    v_lshrrev_b32 v156, 1, v25
    v_lshl_add_u32 v24, v156, 2, v24
    v_mul_u32_u24 v24, 1280, v24
    v_min_u32 v23, 9, v26
    v_lshl_add_u32 v23, v23, 2, v24
    s_mul_i32 s18, s13, 40
    v_add_u32 v23, s18, v23
    s_lshl_b32 s26, s12, 10
    s_lshl_b32 s18, s14, 8
    s_add_u32 s26, s26, s18
    s_mul_i32 s26, s26, 1280
    s_add_u32 s27, s26, 0
    buffer_load_dword v32, v23, s[8:11], s27 offen
    buffer_load_dword v33, v23, s[8:11], s27 offen offset:1280
    s_add_u32 s27, s26, 40960
    buffer_load_dword v34, v23, s[8:11], s27 offen
    buffer_load_dword v35, v23, s[8:11], s27 offen offset:1280
    s_add_u32 s27, s26, 2560
    buffer_load_dword v36, v23, s[8:11], s27 offen
    buffer_load_dword v37, v23, s[8:11], s27 offen offset:1280
    s_add_u32 s27, s26, 43520
    buffer_load_dword v38, v23, s[8:11], s27 offen
    buffer_load_dword v39, v23, s[8:11], s27 offen offset:1280
    s_add_u32 s27, s26, 10240
    buffer_load_dword v40, v23, s[8:11], s27 offen
    buffer_load_dword v41, v23, s[8:11], s27 offen offset:1280
    s_add_u32 s27, s26, 51200
    buffer_load_dword v42, v23, s[8:11], s27 offen
    buffer_load_dword v43, v23, s[8:11], s27 offen offset:1280
    s_add_u32 s27, s26, 12800
    buffer_load_dword v44, v23, s[8:11], s27 offen
    buffer_load_dword v45, v23, s[8:11], s27 offen offset:1280
    s_add_u32 s27, s26, 53760
    buffer_load_dword v46, v23, s[8:11], s27 offen
    buffer_load_dword v47, v23, s[8:11], s27 offen offset:1280
    s_add_u32 s27, s26, 81920
    buffer_load_dword v48, v23, s[8:11], s27 offen
    buffer_load_dword v49, v23, s[8:11], s27 offen offset:1280
    s_add_u32 s27, s26, 122880
    buffer_load_dword v50, v23, s[8:11], s27 offen
    buffer_load_dword v51, v23, s[8:11], s27 offen offset:1280
    s_add_u32 s27, s26, 84480
    buffer_load_dword v52, v23, s[8:11], s27 offen
    buffer_load_dword v53, v23, s[8:11], s27 offen offset:1280
    s_add_u32 s27, s26, 125440
    buffer_load_dword v54, v23, s[8:11], s27 offen
    buffer_load_dword v55, v23, s[8:11], s27 offen offset:1280
    s_add_u32 s27, s26, 92160
    buffer_load_dword v56, v23, s[8:11], s27 offen
    buffer_load_dword v57, v23, s[8:11], s27 offen offset:1280
    s_add_u32 s27, s26, 133120
    buffer_load_dword v58, v23, s[8:11], s27 offen
    buffer_load_dword v59, v23, s[8:11], s27 offen offset:1280
    s_add_u32 s27, s26, 94720
    buffer_load_dword v60, v23, s[8:11], s27 offen
    buffer_load_dword v61, v23, s[8:11], s27 offen offset:1280
    s_add_u32 s27, s26, 135680
    buffer_load_dword v62, v23, s[8:11], s27 offen
    buffer_load_dword v63, v23, s[8:11], s27 offen offset:1280
    s_add_u32 s27, s26, 163840
    buffer_load_dword v64, v23, s[8:11], s27 offen
    buffer_load_dword v65, v23, s[8:11], s27 offen offset:1280
    s_add_u32 s27, s26, 204800
    buffer_load_dword v66, v23, s[8:11], s27 offen
    buffer_load_dword v67, v23, s[8:11], s27 offen offset:1280
    s_add_u32 s27, s26, 166400
    buffer_load_dword v68, v23, s[8:11], s27 offen
    buffer_load_dword v69, v23, s[8:11], s27 offen offset:1280
    s_add_u32 s27, s26, 207360
    buffer_load_dword v70, v23, s[8:11], s27 offen
    buffer_load_dword v71, v23, s[8:11], s27 offen offset:1280
    s_add_u32 s27, s26, 174080
    buffer_load_dword v72, v23, s[8:11], s27 offen
    buffer_load_dword v73, v23, s[8:11], s27 offen offset:1280
    s_add_u32 s27, s26, 215040
    buffer_load_dword v74, v23, s[8:11], s27 offen
    buffer_load_dword v75, v23, s[8:11], s27 offen offset:1280
    s_add_u32 s27, s26, 176640
    buffer_load_dword v76, v23, s[8:11], s27 offen
    buffer_load_dword v77, v23, s[8:11], s27 offen offset:1280
    s_add_u32 s27, s26, 217600
    buffer_load_dword v78, v23, s[8:11], s27 offen
    buffer_load_dword v79, v23, s[8:11], s27 offen offset:1280
    s_add_u32 s27, s26, 245760
    buffer_load_dword v80, v23, s[8:11], s27 offen
    buffer_load_dword v81, v23, s[8:11], s27 offen offset:1280
    s_add_u32 s27, s26, 286720
    buffer_load_dword v82, v23, s[8:11], s27 offen
    buffer_load_dword v83, v23, s[8:11], s27 offen offset:1280
    s_add_u32 s27, s26, 248320
    buffer_load_dword v84, v23, s[8:11], s27 offen
    buffer_load_dword v85, v23, s[8:11], s27 offen offset:1280
    s_add_u32 s27, s26, 289280
    buffer_load_dword v86, v23, s[8:11], s27 offen
    buffer_load_dword v87, v23, s[8:11], s27 offen offset:1280
    s_add_u32 s27, s26, 256000
    buffer_load_dword v88, v23, s[8:11], s27 offen
    buffer_load_dword v89, v23, s[8:11], s27 offen offset:1280
    s_add_u32 s27, s26, 296960
    buffer_load_dword v90, v23, s[8:11], s27 offen
    buffer_load_dword v91, v23, s[8:11], s27 offen offset:1280
    s_add_u32 s27, s26, 258560
    buffer_load_dword v92, v23, s[8:11], s27 offen
    buffer_load_dword v93, v23, s[8:11], s27 offen offset:1280
    s_add_u32 s27, s26, 299520
    buffer_load_dword v94, v23, s[8:11], s27 offen
    buffer_load_dword v95, v23, s[8:11], s27 offen offset:1280
    v_lshrrev_b32 v24, 2, v0
    v_lshlrev_b32 v24, 13, v24
    v_and_b32 v156, 3, v0
    v_lshl_add_u32 v24, v156, 4, v24
    s_mul_i32 s26, s14, 1310720
    s_lshl_b32 s18, s56, 1
    s_add_u32 s26, s26, s18
    s_mul_i32 s19, s14, 10240
    s_mov_b32 s86, 5242880
    s_mov_b32 s87, 0x00020000
    s_mov_b32 s84, s36
    s_and_b32 s85, s37, 0xffff
    s_add_u32 m0, s19, 0
    s_add_u32 s27, s26, 0
    buffer_load_dwordx4 v24, s[84:87], s27 offen lds
    s_add_u32 m0, s19, 1024
    s_add_u32 s27, s26, 131072
    buffer_load_dwordx4 v24, s[84:87], s27 offen lds
    s_add_u32 m0, s19, 2048
    s_add_u32 s27, s26, 262144
    buffer_load_dwordx4 v24, s[84:87], s27 offen lds
    s_add_u32 m0, s19, 3072
    s_add_u32 s27, s26, 393216
    buffer_load_dwordx4 v24, s[84:87], s27 offen lds
    s_add_u32 m0, s19, 4096
    s_add_u32 s27, s26, 524288
    buffer_load_dwordx4 v24, s[84:87], s27 offen lds
    s_add_u32 m0, s19, 5120
    s_add_u32 s27, s26, 655360
    buffer_load_dwordx4 v24, s[84:87], s27 offen lds
    s_add_u32 m0, s19, 6144
    s_add_u32 s27, s26, 786432
    buffer_load_dwordx4 v24, s[84:87], s27 offen lds
    s_add_u32 m0, s19, 7168
    s_add_u32 s27, s26, 917504
    buffer_load_dwordx4 v24, s[84:87], s27 offen lds
    s_add_u32 m0, s19, 8192
    s_add_u32 s27, s26, 1048576
    buffer_load_dwordx4 v24, s[84:87], s27 offen lds
    s_add_u32 m0, s19, 9216
    s_add_u32 s27, s26, 1179648
    buffer_load_dwordx4 v24, s[84:87], s27 offen lds
    s_mov_b32 s84, s38
    s_and_b32 s85, s39, 0xffff
    s_add_u32 m0, s19, 40960
    s_add_u32 s27, s26, 0
    buffer_load_dwordx4 v24, s[84:87], s27 offen lds
    s_add_u32 m0, s19, 41984
    s_add_u32 s27, s26, 131072
    buffer_load_dwordx4 v24, s[84:87], s27 offen lds
    s_add_u32 m0, s19, 43008
    s_add_u32 s27, s26, 262144
    buffer_load_dwordx4 v24, s[84:87], s27 offen lds
    s_add_u32 m0, s19, 44032
    s_add_u32 s27, s26, 393216
    buffer_load_dwordx4 v24, s[84:87], s27 offen lds
    s_add_u32 m0, s19, 45056
    s_add_u32 s27, s26, 524288
    buffer_load_dwordx4 v24, s[84:87], s27 offen lds
    s_add_u32 m0, s19, 46080
    s_add_u32 s27, s26, 655360
    buffer_load_dwordx4 v24, s[84:87], s27 offen lds
    s_add_u32 m0, s19, 47104
    s_add_u32 s27, s26, 786432
    buffer_load_dwordx4 v24, s[84:87], s27 offen lds
    s_add_u32 m0, s19, 48128
    s_add_u32 s27, s26, 917504
    buffer_load_dwordx4 v24, s[84:87], s27 offen lds
    s_add_u32 m0, s19, 49152
    s_add_u32 s27, s26, 1048576
    buffer_load_dwordx4 v24, s[84:87], s27 offen lds
    s_add_u32 m0, s19, 50176
    s_add_u32 s27, s26, 1179648
    buffer_load_dwordx4 v24, s[84:87], s27 offen lds
    s_mov_b32 s84, s40
    s_and_b32 s85, s41, 0xffff
    s_add_u32 m0, s19, 81920
    s_add_u32 s27, s26, 0
    buffer_load_dwordx4 v24, s[84:87], s27 offen lds
    s_add_u32 m0, s19, 82944
    s_add_u32 s27, s26, 131072
    buffer_load_dwordx4 v24, s[84:87], s27 offen lds
    s_add_u32 m0, s19, 83968
    s_add_u32 s27, s26, 262144
    buffer_load_dwordx4 v24, s[84:87], s27 offen lds
    s_add_u32 m0, s19, 84992
    s_add_u32 s27, s26, 393216
    buffer_load_dwordx4 v24, s[84:87], s27 offen lds
    s_add_u32 m0, s19, 86016
    s_add_u32 s27, s26, 524288
    buffer_load_dwordx4 v24, s[84:87], s27 offen lds
    s_add_u32 m0, s19, 87040
    s_add_u32 s27, s26, 655360
    buffer_load_dwordx4 v24, s[84:87], s27 offen lds
    s_add_u32 m0, s19, 88064
    s_add_u32 s27, s26, 786432
    buffer_load_dwordx4 v24, s[84:87], s27 offen lds
    s_add_u32 m0, s19, 89088
    s_add_u32 s27, s26, 917504
    buffer_load_dwordx4 v24, s[84:87], s27 offen lds
    s_add_u32 m0, s19, 90112
    s_add_u32 s27, s26, 1048576
    buffer_load_dwordx4 v24, s[84:87], s27 offen lds
    s_add_u32 m0, s19, 91136
    s_add_u32 s27, s26, 1179648
    buffer_load_dwordx4 v24, s[84:87], s27 offen lds
    s_mov_b32 s18, 0x05040100
    s_mov_b32 s19, 0x07060302
    s_waitcnt vmcnt(63)
    v_perm_b32 v156, v33, v32, s18
    v_perm_b32 v157, v33, v32, s19
    v_accvgpr_write_b32 a120, v156
    v_accvgpr_write_b32 a152, v157
    v_perm_b32 v156, v35, v34, s18
    v_perm_b32 v157, v35, v34, s19
    v_accvgpr_write_b32 a121, v156
    v_accvgpr_write_b32 a153, v157
    v_perm_b32 v156, v37, v36, s18
    v_perm_b32 v157, v37, v36, s19
    v_accvgpr_write_b32 a122, v156
    v_accvgpr_write_b32 a154, v157
    v_perm_b32 v156, v39, v38, s18
    v_perm_b32 v157, v39, v38, s19
    v_accvgpr_write_b32 a123, v156
    v_accvgpr_write_b32 a155, v157
    v_perm_b32 v156, v41, v40, s18
    v_perm_b32 v157, v41, v40, s19
    v_accvgpr_write_b32 a124, v156
    v_accvgpr_write_b32 a156, v157
    v_perm_b32 v156, v43, v42, s18
    v_perm_b32 v157, v43, v42, s19
    v_accvgpr_write_b32 a125, v156
    v_accvgpr_write_b32 a157, v157
    v_perm_b32 v156, v45, v44, s18
    v_perm_b32 v157, v45, v44, s19
    v_accvgpr_write_b32 a126, v156
    v_accvgpr_write_b32 a158, v157
    v_perm_b32 v156, v47, v46, s18
    v_perm_b32 v157, v47, v46, s19
    v_accvgpr_write_b32 a127, v156
    v_accvgpr_write_b32 a159, v157
    s_waitcnt vmcnt(62)
    v_perm_b32 v156, v49, v48, s18
    v_perm_b32 v157, v49, v48, s19
    v_accvgpr_write_b32 a128, v156
    v_accvgpr_write_b32 a160, v157
    v_perm_b32 v156, v51, v50, s18
    v_perm_b32 v157, v51, v50, s19
    v_accvgpr_write_b32 a129, v156
    v_accvgpr_write_b32 a161, v157
    v_perm_b32 v156, v53, v52, s18
    v_perm_b32 v157, v53, v52, s19
    v_accvgpr_write_b32 a130, v156
    v_accvgpr_write_b32 a162, v157
    v_perm_b32 v156, v55, v54, s18
    v_perm_b32 v157, v55, v54, s19
    v_accvgpr_write_b32 a131, v156
    v_accvgpr_write_b32 a163, v157
    v_perm_b32 v156, v57, v56, s18
    v_perm_b32 v157, v57, v56, s19
    v_accvgpr_write_b32 a132, v156
    v_accvgpr_write_b32 a164, v157
    v_perm_b32 v156, v59, v58, s18
    v_perm_b32 v157, v59, v58, s19
    v_accvgpr_write_b32 a133, v156
    v_accvgpr_write_b32 a165, v157
    v_perm_b32 v156, v61, v60, s18
    v_perm_b32 v157, v61, v60, s19
    v_accvgpr_write_b32 a134, v156
    v_accvgpr_write_b32 a166, v157
    v_perm_b32 v156, v63, v62, s18
    v_perm_b32 v157, v63, v62, s19
    v_accvgpr_write_b32 a135, v156
    v_accvgpr_write_b32 a167, v157
    s_waitcnt vmcnt(46)
    v_perm_b32 v156, v65, v64, s18
    v_perm_b32 v157, v65, v64, s19
    v_accvgpr_write_b32 a136, v156
    v_accvgpr_write_b32 a168, v157
    v_perm_b32 v156, v67, v66, s18
    v_perm_b32 v157, v67, v66, s19
    v_accvgpr_write_b32 a137, v156
    v_accvgpr_write_b32 a169, v157
    v_perm_b32 v156, v69, v68, s18
    v_perm_b32 v157, v69, v68, s19
    v_accvgpr_write_b32 a138, v156
    v_accvgpr_write_b32 a170, v157
    v_perm_b32 v156, v71, v70, s18
    v_perm_b32 v157, v71, v70, s19
    v_accvgpr_write_b32 a139, v156
    v_accvgpr_write_b32 a171, v157
    v_perm_b32 v156, v73, v72, s18
    v_perm_b32 v157, v73, v72, s19
    v_accvgpr_write_b32 a140, v156
    v_accvgpr_write_b32 a172, v157
    v_perm_b32 v156, v75, v74, s18
    v_perm_b32 v157, v75, v74, s19
    v_accvgpr_write_b32 a141, v156
    v_accvgpr_write_b32 a173, v157
    v_perm_b32 v156, v77, v76, s18
    v_perm_b32 v157, v77, v76, s19
    v_accvgpr_write_b32 a142, v156
    v_accvgpr_write_b32 a174, v157
    v_perm_b32 v156, v79, v78, s18
    v_perm_b32 v157, v79, v78, s19
    v_accvgpr_write_b32 a143, v156
    v_accvgpr_write_b32 a175, v157
    s_waitcnt vmcnt(30)
    v_perm_b32 v156, v81, v80, s18
    v_perm_b32 v157, v81, v80, s19
    v_accvgpr_write_b32 a144, v156
    v_accvgpr_write_b32 a176, v157
    v_perm_b32 v156, v83, v82, s18
    v_perm_b32 v157, v83, v82, s19
    v_accvgpr_write_b32 a145, v156
    v_accvgpr_write_b32 a177, v157
    v_perm_b32 v156, v85, v84, s18
    v_perm_b32 v157, v85, v84, s19
    v_accvgpr_write_b32 a146, v156
    v_accvgpr_write_b32 a178, v157
    v_perm_b32 v156, v87, v86, s18
    v_perm_b32 v157, v87, v86, s19
    v_accvgpr_write_b32 a147, v156
    v_accvgpr_write_b32 a179, v157
    v_perm_b32 v156, v89, v88, s18
    v_perm_b32 v157, v89, v88, s19
    v_accvgpr_write_b32 a148, v156
    v_accvgpr_write_b32 a180, v157
    v_perm_b32 v156, v91, v90, s18
    v_perm_b32 v157, v91, v90, s19
    v_accvgpr_write_b32 a149, v156
    v_accvgpr_write_b32 a181, v157
    v_perm_b32 v156, v93, v92, s18
    v_perm_b32 v157, v93, v92, s19
    v_accvgpr_write_b32 a150, v156
    v_accvgpr_write_b32 a182, v157
    v_perm_b32 v156, v95, v94, s18
    v_perm_b32 v157, v95, v94, s19
    v_accvgpr_write_b32 a151, v156
    v_accvgpr_write_b32 a183, v157
    s_waitcnt vmcnt(0)
    s_barrier
    s_cmp_lg_u32 s14, 0
    s_cbranch_scc1 Larr_3
    s_mov_b64 exec, 1
    v_mov_b32 v156, 1
    v_mov_b32 v157, 32
    buffer_atomic_add v156, v157, s[96:99], 0 offen sc1
    s_mov_b64 exec, -1
Larr_3:
    v_bfe_u32 v24, v0, 2, 2
    v_lshl_add_u32 v24, v25, 3, v24
    v_lshlrev_b32 v24, 6, v24
    v_and_b32 v156, 3, v0
    v_lshl_add_u32 v24, v156, 3, v24
    s_and_b32 s18, s14, 1
    s_lshl_b32 s18, s18, 5
    s_lshr_b32 s19, s14, 1
    s_mul_i32 s26, s19, 40960
    s_add_u32 s26, s26, s18
    v_add_u32 v23, s26, v24
    s_mul_i32 s26, s19, 20480
    s_add_u32 s26, s26, s18
    s_add_u32 s26, s26, 81920
    v_add_u32 v24, s26, v24
    ds_read_b64_tr_b16 a[0:1], v23 offset:0
    ds_read_b64_tr_b16 a[2:3], v23 offset:256
    ds_read_b64_tr_b16 a[4:5], v23 offset:2048
    ds_read_b64_tr_b16 a[6:7], v23 offset:2304
    ds_read_b64_tr_b16 a[8:9], v23 offset:4096
    ds_read_b64_tr_b16 a[10:11], v23 offset:4352
    ds_read_b64_tr_b16 a[12:13], v23 offset:6144
    ds_read_b64_tr_b16 a[14:15], v23 offset:6400
    ds_read_b64_tr_b16 a[16:17], v23 offset:8192
    ds_read_b64_tr_b16 a[18:19], v23 offset:8448
    ds_read_b64_tr_b16 a[20:21], v23 offset:10240
    ds_read_b64_tr_b16 a[22:23], v23 offset:10496
    s_waitcnt lgkmcnt(0)
    ds_read_b64_tr_b16 a[24:25], v23 offset:12288
    ds_read_b64_tr_b16 a[26:27], v23 offset:12544
    ds_read_b64_tr_b16 a[28:29], v23 offset:14336
    ds_read_b64_tr_b16 a[30:31], v23 offset:14592
    ds_read_b64_tr_b16 a[32:33], v23 offset:16384
    ds_read_b64_tr_b16 a[34:35], v23 offset:16640
    ds_read_b64_tr_b16 a[36:37], v23 offset:18432
    ds_read_b64_tr_b16 a[38:39], v23 offset:18688
    ds_read_b64_tr_b16 a[40:41], v23 offset:20480
    ds_read_b64_tr_b16 a[42:43], v23 offset:20736
    ds_read_b64_tr_b16 a[44:45], v23 offset:22528
    ds_read_b64_tr_b16 a[46:47], v23 offset:22784
    s_waitcnt lgkmcnt(0)
    ds_read_b64_tr_b16 a[48:49], v23 offset:24576
    ds_read_b64_tr_b16 a[50:51], v23 offset:24832
    ds_read_b64_tr_b16 a[52:53], v23 offset:26624
    ds_read_b64_tr_b16 a[54:55], v23 offset:26880
    ds_read_b64_tr_b16 a[56:57], v23 offset:28672
    ds_read_b64_tr_b16 a[58:59], v23 offset:28928
    ds_read_b64_tr_b16 a[60:61], v23 offset:30720
    ds_read_b64_tr_b16 a[62:63], v23 offset:30976
    ds_read_b64_tr_b16 a[64:65], v23 offset:32768
    ds_read_b64_tr_b16 a[66:67], v23 offset:33024
    ds_read_b64_tr_b16 a[68:69], v23 offset:34816
    ds_read_b64_tr_b16 a[70:71], v23 offset:35072
    s_waitcnt lgkmcnt(0)
    ds_read_b64_tr_b16 a[72:73], v23 offset:36864
    ds_read_b64_tr_b16 a[74:75], v23 offset:37120
    ds_read_b64_tr_b16 a[76:77], v23 offset:38912
    ds_read_b64_tr_b16 a[78:79], v23 offset:39168
    s_waitcnt lgkmcnt(0)
    ds_read_b64_tr_b16 a[80:81], v24 offset:0
    ds_read_b64_tr_b16 a[82:83], v24 offset:256
    ds_read_b64_tr_b16 a[84:85], v24 offset:2048
    ds_read_b64_tr_b16 a[86:87], v24 offset:2304
    ds_read_b64_tr_b16 a[88:89], v24 offset:4096
    ds_read_b64_tr_b16 a[90:91], v24 offset:4352
    ds_read_b64_tr_b16 a[92:93], v24 offset:6144
    ds_read_b64_tr_b16 a[94:95], v24 offset:6400
    ds_read_b64_tr_b16 a[96:97], v24 offset:8192
    ds_read_b64_tr_b16 a[98:99], v24 offset:8448
    ds_read_b64_tr_b16 a[100:101], v24 offset:10240
    ds_read_b64_tr_b16 a[102:103], v24 offset:10496
    s_waitcnt lgkmcnt(0)
    ds_read_b64_tr_b16 a[104:105], v24 offset:12288
    ds_read_b64_tr_b16 a[106:107], v24 offset:12544
    ds_read_b64_tr_b16 a[108:109], v24 offset:14336
    ds_read_b64_tr_b16 a[110:111], v24 offset:14592
    ds_read_b64_tr_b16 a[112:113], v24 offset:16384
    ds_read_b64_tr_b16 a[114:115], v24 offset:16640
    ds_read_b64_tr_b16 a[116:117], v24 offset:18432
    ds_read_b64_tr_b16 a[118:119], v24 offset:18688
    s_waitcnt lgkmcnt(0)
    s_barrier
    s_mov_b32 s8, s34
    s_and_b32 s9, s35, 0xffff
    s_mov_b32 s10, 10240
    v_and_b32 v23, 7, v0
    v_mul_u32_u24 v23, 1280, v23
    v_lshl_add_u32 v23, v25, 5, v23
    v_bfe_u32 v24, v0, 3, 1
    v_lshl_add_u32 v23, v24, 2, v23
    s_mul_i32 s18, s14, 3
    s_min_u32 s18, s18, 8
    s_lshl_b32 s18, s18, 7
    buffer_load_dword v80, v23, s[8:11], s18 offen offset:0
    buffer_load_dword v81, v23, s[8:11], s18 offen offset:8
    buffer_load_dword v82, v23, s[8:11], s18 offen offset:16
    buffer_load_dword v83, v23, s[8:11], s18 offen offset:24
    buffer_load_dword v84, v23, s[8:11], s18 offen offset:128
    buffer_load_dword v85, v23, s[8:11], s18 offen offset:136
    buffer_load_dword v86, v23, s[8:11], s18 offen offset:144
    buffer_load_dword v87, v23, s[8:11], s18 offen offset:152
    buffer_load_dword v88, v23, s[8:11], s18 offen offset:256
    buffer_load_dword v89, v23, s[8:11], s18 offen offset:264
    buffer_load_dword v90, v23, s[8:11], s18 offen offset:272
    buffer_load_dword v91, v23, s[8:11], s18 offen offset:280
    s_lshl_b32 s18, s56, 1
    s_and_b32 s18, s18, 0xffffff80
    s_and_b32 s19, s13, 1
    s_mul_i32 s19, s19, 133120
    s_add_u32 s18, s18, s19
    s_add_u32 s90, s18, 532480
    s_mul_i32 s18, s14, 41600
    s_add_u32 s90, s90, s18
    s_mul_i32 s18, s56, 4224
    s_add_u32 s91, s18, 18874624
    v_mov_b32 v24, 32
    s_mov_b32 s19, 0
    s_cmp_lg_u32 s14, 0
    s_cbranch_scc1 Lpd_5
Lpar_4:
    s_sleep 3
    buffer_load_dwordx2 v[156:157], v24, s[96:99], 0 offen sc1
    buffer_load_dword v158, v24, s[96:99], 0 offen offset:96 sc1
    s_waitcnt vmcnt(0)
    v_readfirstlane_b32 s26, v156
    v_readfirstlane_b32 s18, v157
    v_readfirstlane_b32 s27, v158
    s_add_u32 s19, s19, 1
    s_cmp_gt_u32 s19, 0x100000
    s_cbranch_scc1 fused_kernel_exit
    s_cmp_lt_u32 s26, 128
    s_cbranch_scc1 Lpar_4
    s_and_b32 s27, s27, 0xffff
    s_cmp_lt_u32 s27, 128
    s_cbranch_scc1 Lpar_4
Lpd_5:
    s_barrier
    buffer_load_dwordx2 v[156:157], v24, s[96:99], 0 offen offset:4 sc1
    s_waitcnt vmcnt(0)
    v_readfirstlane_b32 s58, v156
    v_readfirstlane_b32 s59, v157
    s_mov_b32 s58, 0
    s_mov_b32 s15, 0
    s_mov_b32 s28, 0
    s_mov_b32 s29, 0
    s_mov_b32 s30, 0
    s_mov_b32 s16, 0
    s_mov_b32 s17, 1048576
    s_waitcnt vmcnt(0)
    s_mov_b32 s57, 0
    s_cmp_eq_u32 s14, 0
    s_cbranch_scc1 Lpfb_7
    s_cmp_eq_u32 s14, 3
    s_cbranch_scc1 Lpfa_6
    buffer_load_dwordx4 v[104:107], v15, s[4:7], s28 offen sc1
    s_branch Lpfb_7
Lpfa_6:
    buffer_load_dwordx2 v[184:185], v16, s[4:7], s29 offen sc1
    buffer_load_dwordx2 v[188:189], v16, s[4:7], s29 offen offset:8 sc1
    buffer_load_dwordx2 v[192:193], v17, s[4:7], s29 offen sc1
    buffer_load_dwordx2 v[196:197], v17, s[4:7], s29 offen offset:8 sc1
Lpfb_7:
    v_mov_b32 v72, 0
    v_mov_b32 v73, 0
    v_mov_b32 v74, 0
    v_mov_b32 v75, 0
    v_mov_b32 v76, 0
    v_mov_b32 v77, 0
    v_mov_b32 v78, 0
    v_mov_b32 v79, 0
    ds_write_b128 v4, v[80:83] offset:0
    ds_write_b128 v4, v[84:87] offset:1024
    s_cmp_ge_u32 s14, 2
    s_cbranch_scc1 Lp3_8
    ds_write_b128 v4, v[88:91] offset:2048
Lp3_8:
    s_cmp_lg_u32 s59, 0
    s_cbranch_scc1 ch_loopS
.p2align 6
ch_loopF:
    s_waitcnt lgkmcnt(0)
    s_barrier
    ds_read_b128 v[32:35], v2 offset:0
    ds_read_b128 v[36:39], v2 offset:1024
    ds_read_b128 v[40:43], v2 offset:2048
    ds_read_b128 v[44:47], v2 offset:3072
    ds_read_b128 v[48:51], v2 offset:4096
    ds_read_b128 v[52:55], v2 offset:5120
    ds_read_b128 v[56:59], v2 offset:6144
    ds_read_b128 v[60:63], v2 offset:7168
    ds_read_b128 v[64:67], v2 offset:8192
    ds_read_b128 v[68:71], v2 offset:9216
    s_waitcnt lgkmcnt(9)
    v_smfmac_f32_16x16x64_bf16 v[72:75], v[32:35], a[0:7], v1
    s_waitcnt lgkmcnt(8)
    v_smfmac_f32_16x16x64_bf16 v[72:75], v[36:39], a[8:15], v1
    s_waitcnt lgkmcnt(7)
    v_smfmac_f32_16x16x64_bf16 v[72:75], v[40:43], a[16:23], v1
    s_waitcnt lgkmcnt(6)
    v_smfmac_f32_16x16x64_bf16 v[72:75], v[44:47], a[24:31], v1
    s_waitcnt lgkmcnt(5)
    v_smfmac_f32_16x16x64_bf16 v[72:75], v[48:51], a[32:39], v1
    s_waitcnt lgkmcnt(4)
    v_smfmac_f32_16x16x64_bf16 v[72:75], v[52:55], a[40:47], v1
    s_waitcnt lgkmcnt(3)
    v_smfmac_f32_16x16x64_bf16 v[72:75], v[56:59], a[48:55], v1
    s_waitcnt lgkmcnt(2)
    v_smfmac_f32_16x16x64_bf16 v[72:75], v[60:63], a[56:63], v1
    s_waitcnt lgkmcnt(1)
    v_smfmac_f32_16x16x64_bf16 v[72:75], v[64:67], a[64:71], v1
    s_waitcnt lgkmcnt(0)
    v_smfmac_f32_16x16x64_bf16 v[72:75], v[68:71], a[72:79], v1
    s_nop 7
    v_permlane32_swap_b32 v72, v74
    v_permlane32_swap_b32 v73, v75
    v_add_f32 v156, v72, v74
    v_add_f32 v157, v73, v75
    v_cvt_pk_bf16_f32 v158, v156, v157
    ds_write_b16 v5, v158
    ds_write_b16_d16_hi v5, v158 offset:80
    s_waitcnt lgkmcnt(0)
    s_barrier
    s_cmp_eq_u32 s14, 3
    s_cbranch_scc1 Lw3_9
    ds_read_b128 v[108:111], v6
    s_cmp_lg_u32 s14, 0
    s_cbranch_scc1 Lnot0_11
    ds_read_b128 v[104:107], v7
Lnot0_11:
    s_waitcnt vmcnt(0) lgkmcnt(0)
    v_mfma_f32_16x16x32_bf16 v[112:115], v[104:107], v[108:111], 0
    s_mov_b64 exec, s[20:21]
    s_nop 6
    v_min_u32 v112, -2, v112
    v_min_u32 v113, -2, v113
    v_min_u32 v114, -2, v114
    v_min_u32 v115, -2, v115
    buffer_store_dwordx4 v[112:115], v8, s[4:7], s16 offen
    s_mov_b64 exec, -1
    s_cmp_eq_u32 s14, 2
    s_cbranch_scc1 Lvhi_12
    v_smfmac_f32_16x16x64_bf16 v[76:79], v[32:35], a[80:87], v1
    v_smfmac_f32_16x16x64_bf16 v[76:79], v[36:39], a[88:95], v1
    v_smfmac_f32_16x16x64_bf16 v[76:79], v[40:43], a[96:103], v1
    v_smfmac_f32_16x16x64_bf16 v[76:79], v[44:47], a[104:111], v1
    v_smfmac_f32_16x16x64_bf16 v[76:79], v[48:51], a[112:119], v1
    s_branch Lvdone_13
Lvhi_12:
    v_smfmac_f32_16x16x64_bf16 v[76:79], v[52:55], a[80:87], v1
    v_smfmac_f32_16x16x64_bf16 v[76:79], v[56:59], a[88:95], v1
    v_smfmac_f32_16x16x64_bf16 v[76:79], v[60:63], a[96:103], v1
    v_smfmac_f32_16x16x64_bf16 v[76:79], v[64:67], a[104:111], v1
    v_smfmac_f32_16x16x64_bf16 v[76:79], v[68:71], a[112:119], v1
Lvdone_13:
    s_nop 7
    ds_write_b128 v20, v[76:79]
    s_waitcnt lgkmcnt(0)
    s_barrier
    s_and_b32 s18, s15, 3
    s_cmp_lg_u32 s14, 0
    s_cbranch_scc1 Lnk_16
    s_lshl_b32 s18, s18, 10
    v_add_u32 v23, s18, v2
    ds_write_b128 v23, v[104:107] offset:24576
    s_waitcnt lgkmcnt(0)
Lnk_16:
    s_cmp_lg_u32 s14, 1
    s_cbranch_scc1 Lnv_15
    ds_read_b128 v[156:159], v21 offset:0
    ds_read_b128 v[160:163], v21 offset:512
    ds_read_b128 v[164:167], v21 offset:2048
    ds_read_b128 v[168:171], v21 offset:2560
    s_waitcnt lgkmcnt(0)
    v_add_f32 v156, v156, v160
    v_add_f32 v164, v164, v168
    v_add_f32 v157, v157, v161
    v_add_f32 v165, v165, v169
    v_add_f32 v158, v158, v162
    v_add_f32 v166, v166, v170
    v_add_f32 v159, v159, v163
    v_add_f32 v167, v167, v171
    v_add_f32 v156, v156, v164
    v_add_f32 v157, v157, v165
    v_add_f32 v158, v158, v166
    v_add_f32 v159, v159, v167
    v_cvt_pk_bf16_f32 v124, v156, v157
    v_cvt_pk_bf16_f32 v125, v158, v159
    s_lshl_b32 s18, s18, 9
    v_lshrrev_b32 v23, 1, v2
    v_add_u32 v23, s18, v23
    ds_write_b64 v23, v[124:125] offset:28672
    s_waitcnt lgkmcnt(0)
Lnv_15:
    s_cmp_eq_u32 s15, 63
    s_cbranch_scc1 ch_done
    s_buffer_load_dwordx2 s[92:93], s[4:7], s90 offset:60
    s_buffer_load_dwordx2 s[92:93], s[4:7], s90 offset:8380
    s_buffer_load_dwordx2 s[92:93], s[4:7], s90 offset:16700
    s_buffer_load_dwordx2 s[92:93], s[4:7], s90 offset:25020
    s_buffer_load_dwordx2 s[92:93], s[4:7], s90 offset:33340
    s_buffer_load_dwordx2 s[92:93], s[4:7], s90 offset:41660
    s_add_u32 s90, s90, 266240
    s_branch Ljoin4_10
Lw3_9:
    v_smfmac_f32_16x16x64_bf16 v[76:79], v[52:55], a[80:87], v1
    v_smfmac_f32_16x16x64_bf16 v[76:79], v[56:59], a[88:95], v1
    v_smfmac_f32_16x16x64_bf16 v[76:79], v[60:63], a[96:103], v1
    v_smfmac_f32_16x16x64_bf16 v[76:79], v[64:67], a[104:111], v1
    v_smfmac_f32_16x16x64_bf16 v[76:79], v[68:71], a[112:119], v1
    v_mov_b32 v194, 0
    v_mov_b32 v195, 0
    s_nop 5
    ds_write_b128 v20, v[76:79]
    s_waitcnt lgkmcnt(0)
    s_sleep 3
    buffer_load_dwordx4 v[80:83], v208, s[4:7], s16 offen offset:0 sc1
    buffer_load_dwordx4 v[84:87], v208, s[4:7], s16 offen offset:1536 sc1
    buffer_load_dwordx4 v[88:91], v209, s[4:7], s16 offen offset:0 sc1
    buffer_load_dwordx4 v[92:95], v209, s[4:7], s16 offen offset:1536 sc1
    buffer_load_dwordx4 v[96:99], v9, s[4:7], s16 offen offset:0 sc1
    buffer_load_dwordx4 v[100:103], v9, s[4:7], s16 offen offset:1536 sc1
    s_barrier
    ds_read_b128 v[156:159], v21 offset:0
    ds_read_b128 v[160:163], v21 offset:512
    ds_read_b128 v[164:167], v21 offset:2048
    ds_read_b128 v[168:171], v21 offset:2560
    s_waitcnt lgkmcnt(0)
    v_add_f32 v156, v156, v160
    v_add_f32 v164, v164, v168
    v_add_f32 v157, v157, v161
    v_add_f32 v165, v165, v169
    v_add_f32 v158, v158, v162
    v_add_f32 v166, v166, v170
    v_add_f32 v159, v159, v163
    v_add_f32 v167, v167, v171
    v_add_f32 v156, v156, v164
    v_add_f32 v157, v157, v165
    v_add_f32 v158, v158, v166
    v_add_f32 v159, v159, v167
    v_cvt_pk_bf16_f32 v124, v156, v157
    v_cvt_pk_bf16_f32 v125, v158, v159
    s_cmp_eq_u32 s15, 63
    s_cbranch_scc1 ch_done
    v_mov_b32 v186, v124
    v_mov_b32 v187, v125
    s_nop 1
    v_permlane32_swap_b32 v186, v194
    v_permlane32_swap_b32 v187, v195
Lr1_17:
    buffer_load_dwordx4 v[80:83], v208, s[4:7], s16 offen offset:0 sc1
    buffer_load_dwordx4 v[84:87], v208, s[4:7], s16 offen offset:1536 sc1
    buffer_load_dwordx4 v[88:91], v209, s[4:7], s16 offen offset:0 sc1
    buffer_load_dwordx4 v[92:95], v209, s[4:7], s16 offen offset:1536 sc1
    buffer_load_dwordx4 v[96:99], v9, s[4:7], s16 offen offset:0 sc1
    buffer_load_dwordx4 v[100:103], v9, s[4:7], s16 offen offset:1536 sc1
    s_waitcnt vmcnt(6)
    v_max3_u32 v156, v80, v81, v82
    v_max3_u32 v157, v83, v84, v85
    v_max3_u32 v158, v86, v87, v88
    v_max3_u32 v159, v89, v90, v91
    v_max3_u32 v160, v92, v93, v94
    v_max3_u32 v161, v95, v96, v97
    v_max3_u32 v162, v98, v99, v100
    v_max3_u32 v163, v101, v102, v103
    v_max3_u32 v164, v156, v157, v158
    v_max3_u32 v165, v159, v160, v161
    v_max_u32 v166, v162, v163
    v_max3_u32 v167, v164, v165, v166
    v_cmp_eq_u32 vcc, -1, v167
    s_cbranch_vccnz Lretry_19
    s_mov_b64 exec, -1
    v_add_f32 v132, v96, v100
    v_add_f32 v133, v97, v101
    v_add_f32 v134, v98, v102
    v_add_f32 v135, v99, v103
    v_add_f32 v128, v80, v84
    v_add_f32 v136, v88, v92
    v_add_f32 v129, v81, v85
    v_add_f32 v137, v89, v93
    v_add_f32 v130, v82, v86
    v_add_f32 v138, v90, v94
    v_add_f32 v131, v83, v87
    v_add_f32 v139, v91, v95
    v_add_f32_dpp v132, v132, v132 row_ror:8 row_mask:0xf bank_mask:0xf
    v_add_f32_dpp v133, v133, v133 row_ror:8 row_mask:0xf bank_mask:0xf
    v_add_f32_dpp v134, v134, v134 row_ror:8 row_mask:0xf bank_mask:0xf
    v_add_f32_dpp v135, v135, v135 row_ror:8 row_mask:0xf bank_mask:0xf
    v_add_f32 v128, v128, v136
    v_add_f32 v129, v129, v137
    v_add_f32 v130, v130, v138
    v_add_f32 v131, v131, v139
    v_cndmask_b32 v132, v27, v132, s[24:25]
    v_cndmask_b32 v133, v27, v133, s[24:25]
    v_cndmask_b32 v134, v27, v134, s[24:25]
    v_cndmask_b32 v135, v27, v135, s[24:25]
    v_max3_f32 v156, v128, v129, v130
    v_max3_f32 v157, v131, v132, v133
    v_max3_f32 v156, v156, v134, v135
    v_max_f32 v156, v156, v157
    s_nop 1
    v_max_f32_dpp v156, v156, v156 row_ror:8 row_mask:0xf bank_mask:0xf
    v_mov_b32 v157, v156
    s_nop 1
    v_permlane16_swap_b32 v156, v157
    v_max_f32 v156, v156, v157
    v_mov_b32 v157, v156
    s_nop 1
    v_permlane32_swap_b32 v156, v157
    v_max_f32 v156, v156, v157
    v_mul_f32 v156, s51, v156
    v_fma_f32 v128, v128, s51, -v156
    v_fma_f32 v129, v129, s51, -v156
    v_fma_f32 v130, v130, s51, -v156
    v_fma_f32 v131, v131, s51, -v156
    v_fma_f32 v132, v132, s51, -v156
    v_fma_f32 v133, v133, s51, -v156
    v_fma_f32 v134, v134, s51, -v156
    v_fma_f32 v135, v135, s51, -v156
    v_exp_f32 v128, v128
    v_exp_f32 v129, v129
    v_exp_f32 v130, v130
    v_exp_f32 v131, v131
    v_exp_f32 v132, v132
    v_exp_f32 v133, v133
    v_exp_f32 v134, v134
    v_exp_f32 v135, v135
    s_nop 0
    v_cvt_pk_bf16_f32 v140, v128, v129
    v_cvt_pk_bf16_f32 v141, v130, v131
    v_cvt_pk_bf16_f32 v142, v132, v133
    v_cvt_pk_bf16_f32 v143, v134, v135
    s_nop 1
    v_mfma_f32_16x16x32_bf16 v[220:223], v[200:203], v[140:143], 0
    v_mfma_f32_16x16x32_bf16 v[224:227], v[204:207], v[140:143], 0
    v_mfma_f32_16x16x32_bf16 v[148:151], v[184:187], v[140:143], 0
    v_mfma_f32_16x16x32_bf16 v[212:215], v[188:191], v[140:143], 0
    v_mfma_f32_16x16x32_bf16 v[152:155], v[192:195], v[140:143], 0
    v_mfma_f32_16x16x32_bf16 v[216:219], v[196:199], v[140:143], 0
    s_nop 3
    v_add_f32_dpp v156, v224, v220 row_ror:8 row_mask:0xf bank_mask:0xf
    v_rcp_f32 v156, v156
    s_nop 1
    v_add_f32_dpp v148, v212, v148 row_ror:8 row_mask:0xf bank_mask:0xf
    v_add_f32_dpp v149, v213, v149 row_ror:8 row_mask:0xf bank_mask:0xf
    v_add_f32_dpp v150, v214, v150 row_ror:8 row_mask:0xf bank_mask:0xf
    v_add_f32_dpp v151, v215, v151 row_ror:8 row_mask:0xf bank_mask:0xf
    v_add_f32_dpp v152, v216, v152 row_ror:8 row_mask:0xf bank_mask:0xf
    v_add_f32_dpp v153, v217, v153 row_ror:8 row_mask:0xf bank_mask:0xf
    v_add_f32_dpp v154, v218, v154 row_ror:8 row_mask:0xf bank_mask:0xf
    v_add_f32_dpp v155, v219, v155 row_ror:8 row_mask:0xf bank_mask:0xf
    v_mul_f32 v148, v148, v156
    v_mul_f32 v149, v149, v156
    v_mul_f32 v150, v150, v156
    v_mul_f32 v151, v151, v156
    v_mul_f32 v152, v152, v156
    v_mul_f32 v153, v153, v156
    v_mul_f32 v154, v154, v156
    v_mul_f32 v155, v155, v156
    v_cvt_pk_bf16_f32 v112, v148, v149
    v_cvt_pk_bf16_f32 v114, v152, v153
    v_cvt_pk_bf16_f32 v113, v150, v151
    v_cvt_pk_bf16_f32 v115, v154, v155
    s_mov_b64 exec, s[20:21]
    v_min_u32 v112, -2, v112
    v_min_u32 v113, -2, v113
    v_min_u32 v114, -2, v114
    v_min_u32 v115, -2, v115
    buffer_store_dwordx4 v[112:115], v10, s[4:7], s16 offen
    s_mov_b64 exec, -1
Ljoin4_10:
    s_barrier
    s_add_u32 s28, s28, 266240
    s_add_u32 s29, s29, 64
    v_mov_b32 v172, 0
    v_mov_b32 v176, 0
    v_mov_b32 v173, 0
    v_mov_b32 v177, 0
    v_mov_b32 v174, 0
    v_mov_b32 v178, 0
    v_mov_b32 v175, 0
    v_mov_b32 v179, 0
    s_lshr_b32 s27, s15, 2
    s_lshr_b32 s27, s58, s27
    s_and_b32 s27, s27, 1
    s_lshl_b32 s27, s27, 13
    s_lshl_b32 s18, s15, 19
    s_add_u32 s27, s27, s18
    s_sleep 1
    buffer_load_dwordx4 v[80:83], v11, s[4:7], s16 offen offset:0 sc1
    buffer_load_dwordx4 v[84:87], v11, s[4:7], s16 offen offset:1024 sc1
    buffer_load_dwordx4 v[88:91], v11, s[4:7], s16 offen offset:2048 sc1
    buffer_load_dwordx4 v[92:95], v11, s[4:7], s16 offen offset:3072 sc1
    s_sleep 2
Lr2a_20:
    buffer_load_dwordx4 v[80:83], v11, s[4:7], s16 offen offset:0 sc1
    buffer_load_dwordx4 v[84:87], v11, s[4:7], s16 offen offset:1024 sc1
    buffer_load_dwordx4 v[88:91], v11, s[4:7], s16 offen offset:2048 sc1
    buffer_load_dwordx4 v[92:95], v11, s[4:7], s16 offen offset:3072 sc1
    s_waitcnt vmcnt(4)
    v_max3_u32 v156, v80, v81, v82
    v_max3_u32 v157, v83, v84, v85
    v_max3_u32 v158, v86, v87, v88
    v_max3_u32 v159, v89, v90, v91
    v_max3_u32 v160, v92, v93, v94
    v_max3_u32 v161, v156, v157, v158
    v_max3_u32 v162, v159, v160, v95
    v_max_u32 v163, v161, v162
    v_cmp_eq_u32 vcc, -1, v163
    s_cbranch_vccnz Lretry_21
    s_mov_b64 exec, -1
    v_smfmac_f32_16x16x64_bf16 v[172:175], v[80:83], a[120:127], v1
    v_smfmac_f32_16x16x64_bf16 v[176:179], v[80:83], a[152:159], v1
    v_smfmac_f32_16x16x64_bf16 v[172:175], v[84:87], a[128:135], v1
    v_smfmac_f32_16x16x64_bf16 v[176:179], v[84:87], a[160:167], v1
    v_smfmac_f32_16x16x64_bf16 v[172:175], v[88:91], a[136:143], v1
    v_smfmac_f32_16x16x64_bf16 v[176:179], v[88:91], a[168:175], v1
    v_smfmac_f32_16x16x64_bf16 v[172:175], v[92:95], a[144:151], v1
    v_smfmac_f32_16x16x64_bf16 v[176:179], v[92:95], a[176:183], v1
    s_nop 7
    v_permlane32_swap_b32 v172, v176
    v_permlane32_swap_b32 v173, v177
    v_permlane32_swap_b32 v174, v178
    v_permlane32_swap_b32 v175, v179
    v_add_f32 v172, v172, v176
    v_add_f32 v173, v173, v177
    v_add_f32 v174, v174, v178
    v_add_f32 v175, v175, v179
    ds_write_b128 v22, v[172:175]
    s_waitcnt lgkmcnt(0)
    s_barrier
    s_cmp_eq_u32 s14, 0
    s_cbranch_scc1 Lw0_24
    s_cmp_eq_u32 s14, 1
    s_cbranch_scc1 Lw1_25
    s_cmp_eq_u32 s14, 2
    s_cbranch_scc1 Lw2_26
    s_sleep 3
    s_and_b32 s18, s15, 3
    s_cmp_lg_u32 s18, 3
    s_cbranch_scc1 Lxv_27
    s_sleep 1
    v_lshrrev_b32 v23, 1, v2
    ds_read_b64 v[156:157], v23 offset:28672
    ds_read_b64 v[158:159], v23 offset:29184
    ds_read_b64 v[160:161], v23 offset:29696
    ds_read_b64 v[162:163], v23 offset:30208
    s_and_b32 s30, s15, 0xfc
    s_lshl_b32 s30, s30, 16
    s_add_u32 s18, s30, 0
    s_waitcnt lgkmcnt(3)
    buffer_store_dwordx2 v[156:157], v19, s[4:7], s18 offen sc1
    s_add_u32 s18, s30, 65536
    s_waitcnt lgkmcnt(2)
    buffer_store_dwordx2 v[158:159], v19, s[4:7], s18 offen sc1
    s_add_u32 s18, s30, 131072
    s_waitcnt lgkmcnt(1)
    buffer_store_dwordx2 v[160:161], v19, s[4:7], s18 offen sc1
    s_add_u32 s18, s30, 196608
    s_waitcnt lgkmcnt(0)
    buffer_store_dwordx2 v[162:163], v19, s[4:7], s18 offen sc1
Lxv_27:
    s_and_b32 s18, s15, 1
    s_mul_i32 s18, s18, 67584
    s_lshr_b32 s19, s15, 1
    s_lshl_b32 s19, s19, 7
    s_add_u32 s18, s18, s19
    s_add_u32 s18, s91, s18
    s_buffer_load_dwordx2 s[92:93], s[4:7], s18 offset:42300
    s_buffer_load_dwordx2 s[92:93], s[4:7], s18 offset:46524
    s_buffer_load_dwordx2 s[92:93], s[4:7], s18 offset:50748
    s_buffer_load_dwordx2 s[92:93], s[4:7], s18 offset:54972
    s_buffer_load_dwordx2 s[92:93], s[4:7], s18 offset:59196
    s_buffer_load_dwordx2 s[92:93], s[4:7], s18 offset:63420
    s_mov_b64 exec, s[20:21]
    buffer_store_dwordx4 v[28:31], v10, s[4:7], s17 offen
    s_mov_b64 exec, s[22:23]
    buffer_store_dword v28, v14, s[4:7], s17 offen
    buffer_store_dword v28, v14, s[4:7], s17 offen offset:32
    s_mov_b64 exec, -1
    s_branch Ljoin6_22
Lw2_26:
    s_sleep 3
    s_and_b32 s18, s15, 3
    s_cmp_lg_u32 s18, 3
    s_cbranch_scc1 Lxk_28
    s_sleep 1
    ds_read_b128 v[156:159], v2 offset:24576
    ds_read_b128 v[160:163], v2 offset:25600
    ds_read_b128 v[164:167], v2 offset:26624
    ds_read_b128 v[168:171], v2 offset:27648
    s_and_b32 s30, s15, 0xfc
    s_lshl_b32 s30, s30, 16
    s_mov_b64 exec, s[20:21]
    s_add_u32 s18, s30, 0
    s_waitcnt lgkmcnt(3)
    buffer_store_dwordx4 v[156:159], v18, s[4:7], s18 offen sc1
    s_add_u32 s18, s30, 65536
    s_waitcnt lgkmcnt(2)
    buffer_store_dwordx4 v[160:163], v18, s[4:7], s18 offen sc1
    s_add_u32 s18, s30, 131072
    s_waitcnt lgkmcnt(1)
    buffer_store_dwordx4 v[164:167], v18, s[4:7], s18 offen sc1
    s_add_u32 s18, s30, 196608
    s_waitcnt lgkmcnt(0)
    buffer_store_dwordx4 v[168:171], v18, s[4:7], s18 offen sc1
    s_mov_b64 exec, -1
    s_branch Lxp_29
Lxk_28:
    s_cmp_lg_u32 s18, 0
    s_cbranch_scc1 Lxp_29
    s_cmp_eq_u32 s15, 0
    s_cbranch_scc1 Lxp_29
    s_sleep 2
    s_mov_b64 exec, 1
    v_mov_b32 v157, s15
    buffer_store_dword v157, v180, s[4:7], 0 offen sc1
    s_mov_b64 exec, -1
Lxp_29:
    s_and_b32 s18, s15, 7
    s_cmp_lg_u32 s18, 7
    s_cbranch_scc1 Lkvd_31
    s_add_u32 s18, s15, 1
    s_lshr_b32 s18, s18, 1
    s_add_u32 s18, s18, 128
    v_mov_b32 v181, s18
Lkv_30:
    buffer_load_dword v158, v181, s[96:99], 0 offen sc1
    s_waitcnt vmcnt(0)
    v_readfirstlane_b32 s18, v158
    s_add_u32 s57, s57, 1
    s_cmp_gt_u32 s57, 0x100000
    s_cbranch_scc1 fused_kernel_exit
    s_and_b32 s18, s18, 0xffff
    s_cmp_lt_u32 s18, 128
    s_cbranch_scc1 Lkv_30
Lkvd_31:
    s_and_b32 s18, s15, 1
    s_mul_i32 s18, s18, 67584
    s_lshr_b32 s19, s15, 1
    s_lshl_b32 s19, s19, 7
    s_add_u32 s18, s18, s19
    s_add_u32 s18, s91, s18
    s_buffer_load_dwordx2 s[92:93], s[4:7], s18 offset:21180
    s_buffer_load_dwordx2 s[92:93], s[4:7], s18 offset:25404
    s_buffer_load_dwordx2 s[92:93], s[4:7], s18 offset:29628
    s_buffer_load_dwordx2 s[92:93], s[4:7], s18 offset:33852
    s_buffer_load_dwordx2 s[92:93], s[4:7], s18 offset:38076
    s_mov_b64 exec, s[20:21]
    v_subrev_u32 v156, 1024, v8
    buffer_store_dwordx4 v[28:31], v156, s[4:7], s17 offen offset:0
    buffer_store_dwordx4 v[28:31], v156, s[4:7], s17 offen offset:512
    buffer_store_dwordx4 v[28:31], v156, s[4:7], s17 offen offset:1024
    s_mov_b64 exec, -1
    s_branch Ljoin6_22
Lw1_25:
    ds_read_b128 v[156:159], v2 offset:16384
    ds_read_b128 v[160:163], v2 offset:17408
    ds_read_b128 v[164:167], v2 offset:18432
    ds_read_b128 v[168:171], v2 offset:19456
    s_waitcnt lgkmcnt(0)
    v_add_f32 v172, v156, v160
    v_add_f32 v164, v164, v168
    v_add_f32 v173, v157, v161
    v_add_f32 v165, v165, v169
    v_add_f32 v174, v158, v162
    v_add_f32 v166, v166, v170
    v_add_f32 v175, v159, v163
    v_add_f32 v167, v167, v171
    v_add_f32 v172, v172, v164
    v_add_f32 v173, v173, v165
    v_add_f32 v174, v174, v166
    v_add_f32 v175, v175, v167
    s_mov_b64 exec, s[22:23]
    v_min_u32 v172, -2, v172
    v_min_u32 v173, -2, v173
    v_min_u32 v174, -2, v174
    v_min_u32 v175, -2, v175
    buffer_store_dwordx4 v[172:175], v12, s[4:7], s27 offen sc1
    buffer_store_dwordx4 v[172:175], v12, s[4:7], s27 offen offset:2560 sc1
    s_add_u32 s27, s27, 2560
    buffer_store_dwordx4 v[172:175], v12, s[4:7], s27 offen offset:2560 sc1
    s_mov_b64 exec, -1
    s_and_b32 s18, s15, 1
    s_mul_i32 s18, s18, 67584
    s_lshr_b32 s19, s15, 1
    s_lshl_b32 s19, s19, 7
    s_add_u32 s18, s18, s19
    s_add_u32 s18, s91, s18
    s_buffer_load_dwordx2 s[92:93], s[4:7], s18 offset:60
    s_buffer_load_dwordx2 s[92:93], s[4:7], s18 offset:4284
    s_buffer_load_dwordx2 s[92:93], s[4:7], s18 offset:8508
    s_buffer_load_dwordx2 s[92:93], s[4:7], s18 offset:12732
    s_buffer_load_dwordx2 s[92:93], s[4:7], s18 offset:16956
    s_branch Ljoin6_22
Lw0_24:
    s_add_u32 s18, s27, s48
    s_add_u32 s19, s27, s49
    s_add_u32 s26, s27, s50
    ds_read_b128 v[156:159], v2 offset:16384
    ds_read_b128 v[160:163], v2 offset:17408
    ds_read_b128 v[164:167], v2 offset:18432
    ds_read_b128 v[168:171], v2 offset:19456
    s_waitcnt lgkmcnt(0)
    v_add_f32 v172, v156, v160
    v_add_f32 v164, v164, v168
    v_add_f32 v173, v157, v161
    v_add_f32 v165, v165, v169
    v_add_f32 v174, v158, v162
    v_add_f32 v166, v166, v170
    v_add_f32 v175, v159, v163
    v_add_f32 v167, v167, v171
    v_add_f32 v172, v172, v164
    v_add_f32 v173, v173, v165
    v_add_f32 v174, v174, v166
    v_add_f32 v175, v175, v167
    v_add_u32 v23, 2560, v13
    s_sleep 5
    buffer_load_dwordx4 v[80:83], v13, s[4:7], s18 offen offset:0 sc1
    buffer_load_dwordx4 v[84:87], v13, s[4:7], s19 offen offset:0 sc1
    buffer_load_dwordx4 v[88:91], v13, s[4:7], s26 offen offset:0 sc1
    s_sleep 4
    buffer_load_dwordx4 v[92:95], v13, s[4:7], s18 offen offset:2560 sc1
    buffer_load_dwordx4 v[96:99], v13, s[4:7], s19 offen offset:2560 sc1
    buffer_load_dwordx4 v[100:103], v13, s[4:7], s26 offen offset:2560 sc1
    s_waitcnt vmcnt(3)
    v_max3_u32 v156, v80, v81, v82
    v_max3_u32 v157, v83, v84, v85
    v_max3_u32 v158, v86, v87, v88
    v_max3_u32 v159, v89, v90, v91
    v_max3_u32 v160, v156, v157, v158
    v_max_u32 v161, v160, v159
    v_cmp_eq_u32 vcc, -1, v161
    s_cbranch_vccnz Lr2bB_32
    v_add_f32 v112, v172, v80
    v_add_f32 v160, v84, v88
    v_add_f32 v113, v173, v81
    v_add_f32 v161, v85, v89
    v_add_f32 v114, v174, v82
    v_add_f32 v162, v86, v90
    v_add_f32 v115, v175, v83
    v_add_f32 v163, v87, v91
    s_branch Lr2bJ_34
Lr2bB_32:
    buffer_load_dwordx4 v[32:35], v23, s[4:7], s18 offen offset:2560 sc1
    buffer_load_dwordx4 v[36:39], v23, s[4:7], s19 offen offset:2560 sc1
    buffer_load_dwordx4 v[40:43], v23, s[4:7], s26 offen offset:2560 sc1
    s_waitcnt vmcnt(3)
    v_max3_u32 v156, v92, v93, v94
    v_max3_u32 v157, v95, v96, v97
    v_max3_u32 v158, v98, v99, v100
    v_max3_u32 v159, v101, v102, v103
    v_max3_u32 v160, v156, v157, v158
    v_max_u32 v161, v160, v159
    v_cmp_eq_u32 vcc, -1, v161
    s_cbranch_vccnz Lr2bC_33
    v_add_f32 v112, v172, v92
    v_add_f32 v160, v96, v100
    v_add_f32 v113, v173, v93
    v_add_f32 v161, v97, v101
    v_add_f32 v114, v174, v94
    v_add_f32 v162, v98, v102
    v_add_f32 v115, v175, v95
    v_add_f32 v163, v99, v103
    s_branch Lr2bJ_34
Lr2b_23:
    buffer_load_dwordx4 v[32:35], v23, s[4:7], s18 offen offset:2560 sc1
    buffer_load_dwordx4 v[36:39], v23, s[4:7], s19 offen offset:2560 sc1
    buffer_load_dwordx4 v[40:43], v23, s[4:7], s26 offen offset:2560 sc1
Lr2bC_33:
    s_waitcnt vmcnt(0)
    v_max3_u32 v156, v32, v33, v34
    v_max3_u32 v157, v35, v36, v37
    v_max3_u32 v158, v38, v39, v40
    v_max3_u32 v159, v41, v42, v43
    v_max3_u32 v160, v156, v157, v158
    v_max_u32 v161, v160, v159
    v_cmp_eq_u32 vcc, -1, v161
    s_cbranch_vccnz Lretry_35
    s_mov_b64 exec, -1
    v_add_f32 v112, v172, v32
    v_add_f32 v160, v36, v40
    v_add_f32 v113, v173, v33
    v_add_f32 v161, v37, v41
    v_add_f32 v114, v174, v34
    v_add_f32 v162, v38, v42
    v_add_f32 v115, v175, v35
    v_add_f32 v163, v39, v43
Lr2bJ_34:
    v_add_f32 v112, v112, v160
    v_add_f32 v113, v113, v161
    v_add_f32 v114, v114, v162
    v_add_f32 v115, v115, v163
    s_nop 1
    v_permlane32_swap_b32 v112, v113
    v_permlane32_swap_b32 v114, v115
    v_cvt_pk_bf16_f32 v156, v112, v113
    v_cvt_pk_bf16_f32 v157, v114, v115
    s_mov_b64 exec, s[22:23]
    v_min_u32 v156, -2, v156
    v_min_u32 v157, -2, v157
    buffer_store_dword v156, v14, s[4:7], s16 offen
    buffer_store_dword v157, v14, s[4:7], s16 offen offset:32
    s_mov_b64 exec, -1
Ljoin6_22:
    s_barrier
    s_cmp_lg_u32 s15, 7
    s_cbranch_scc1 Lnpar_37
    v_mov_b32 v24, 36
    buffer_load_dword v23, v24, s[96:99], 0 offen sc1
    s_waitcnt vmcnt(0)
    v_readfirstlane_b32 s58, v23
Lnpar_37:
    s_cmp_eq_u32 s14, 0
    s_cbranch_scc1 Lpfb_39
    s_cmp_eq_u32 s14, 3
    s_cbranch_scc1 Lpfa_38
    buffer_load_dwordx4 v[104:107], v15, s[4:7], s28 offen sc1
    s_branch Lpfb_39
Lpfa_38:
    buffer_load_dwordx2 v[184:185], v16, s[4:7], s29 offen sc1
    buffer_load_dwordx2 v[188:189], v16, s[4:7], s29 offen offset:8 sc1
    buffer_load_dwordx2 v[192:193], v17, s[4:7], s29 offen sc1
    buffer_load_dwordx2 v[196:197], v17, s[4:7], s29 offen offset:8 sc1
Lpfb_39:
    v_mov_b32 v72, 0
    v_mov_b32 v73, 0
    v_mov_b32 v74, 0
    v_mov_b32 v75, 0
    v_mov_b32 v76, 0
    v_mov_b32 v77, 0
    v_mov_b32 v78, 0
    v_mov_b32 v79, 0
    s_sleep 3
    s_cmp_ge_u32 s14, 2
    s_cbranch_scc1 Lr2c2_40
Lr2c_36:
    buffer_load_dwordx4 v[80:83], v3, s[4:7], s16 offen offset:0 sc1
    buffer_load_dwordx4 v[84:87], v3, s[4:7], s16 offen offset:1024 sc1
    buffer_load_dwordx4 v[88:91], v3, s[4:7], s16 offen offset:2048 sc1
    s_waitcnt vmcnt(0)
    ds_write_b128 v4, v[80:83] offset:0
    ds_write_b128 v4, v[84:87] offset:1024
    ds_write_b128 v4, v[88:91] offset:2048
    v_max3_u32 v156, v80, v81, v82
    v_max3_u32 v157, v83, v84, v85
    v_max3_u32 v158, v86, v87, v88
    v_max3_u32 v159, v89, v90, v91
    v_max3_u32 v160, v156, v157, v158
    v_max_u32 v161, v160, v159
    v_cmp_eq_u32 vcc, -1, v161
    s_cbranch_vccnz Lretry_42
    s_mov_b64 exec, -1
    s_branch Lr2cJ_41
Lr2c2_40:
    buffer_load_dwordx4 v[80:83], v3, s[4:7], s16 offen offset:0 sc1
    buffer_load_dwordx4 v[84:87], v3, s[4:7], s16 offen offset:1024 sc1
    s_waitcnt vmcnt(0)
    ds_write_b128 v4, v[80:83] offset:0
    ds_write_b128 v4, v[84:87] offset:1024
    v_max3_u32 v156, v80, v81, v82
    v_max3_u32 v157, v83, v84, v85
    v_max_u32 v158, v86, v87
    v_max3_u32 v159, v156, v157, v158
    v_cmp_eq_u32 vcc, -1, v159
    s_cbranch_vccnz Lretry_43
    s_mov_b64 exec, -1
Lr2cJ_41:
    s_add_u32 s15, s15, 1
    s_add_u32 s16, s16, 524288
    s_and_b32 s16, s16, 2097151
    s_add_u32 s17, s17, 524288
    s_and_b32 s17, s17, 2097151
    s_branch ch_loopF
Lretry_19:
    s_mov_b64 exec, vcc
    s_add_u32 s57, s57, 1
    s_cmp_lt_u32 s57, 0x100000
    s_cbranch_scc1 Lr1_17
    s_branch fused_kernel_exit
Lretry_21:
    s_mov_b64 exec, vcc
    s_add_u32 s57, s57, 1
    s_cmp_lt_u32 s57, 0x100000
    s_cbranch_scc1 Lr2a_20
    s_branch fused_kernel_exit
Lretry_35:
    s_mov_b64 exec, vcc
    s_add_u32 s57, s57, 1
    s_cmp_lt_u32 s57, 0x100000
    s_cbranch_scc1 Lr2b_23
    s_branch fused_kernel_exit
Lretry_42:
    s_mov_b64 exec, vcc
    s_add_u32 s57, s57, 1
    s_cmp_lt_u32 s57, 0x100000
    s_cbranch_scc1 Lr2c_36
    s_branch fused_kernel_exit
Lretry_43:
    s_mov_b64 exec, vcc
    s_add_u32 s57, s57, 1
    s_cmp_lt_u32 s57, 0x100000
    s_cbranch_scc1 Lr2c2_40
    s_branch fused_kernel_exit
.p2align 6
ch_loopS:
    s_waitcnt lgkmcnt(0)
    s_barrier
    ds_read_b128 v[32:35], v2 offset:0
    ds_read_b128 v[36:39], v2 offset:1024
    ds_read_b128 v[40:43], v2 offset:2048
    ds_read_b128 v[44:47], v2 offset:3072
    ds_read_b128 v[48:51], v2 offset:4096
    ds_read_b128 v[52:55], v2 offset:5120
    ds_read_b128 v[56:59], v2 offset:6144
    ds_read_b128 v[60:63], v2 offset:7168
    ds_read_b128 v[64:67], v2 offset:8192
    ds_read_b128 v[68:71], v2 offset:9216
    s_waitcnt lgkmcnt(9)
    v_smfmac_f32_16x16x64_bf16 v[72:75], v[32:35], a[0:7], v1
    s_waitcnt lgkmcnt(8)
    v_smfmac_f32_16x16x64_bf16 v[72:75], v[36:39], a[8:15], v1
    s_waitcnt lgkmcnt(7)
    v_smfmac_f32_16x16x64_bf16 v[72:75], v[40:43], a[16:23], v1
    s_waitcnt lgkmcnt(6)
    v_smfmac_f32_16x16x64_bf16 v[72:75], v[44:47], a[24:31], v1
    s_waitcnt lgkmcnt(5)
    v_smfmac_f32_16x16x64_bf16 v[72:75], v[48:51], a[32:39], v1
    s_waitcnt lgkmcnt(4)
    v_smfmac_f32_16x16x64_bf16 v[72:75], v[52:55], a[40:47], v1
    s_waitcnt lgkmcnt(3)
    v_smfmac_f32_16x16x64_bf16 v[72:75], v[56:59], a[48:55], v1
    s_waitcnt lgkmcnt(2)
    v_smfmac_f32_16x16x64_bf16 v[72:75], v[60:63], a[56:63], v1
    s_waitcnt lgkmcnt(1)
    v_smfmac_f32_16x16x64_bf16 v[72:75], v[64:67], a[64:71], v1
    s_waitcnt lgkmcnt(0)
    v_smfmac_f32_16x16x64_bf16 v[72:75], v[68:71], a[72:79], v1
    s_nop 7
    v_permlane32_swap_b32 v72, v74
    v_permlane32_swap_b32 v73, v75
    v_add_f32 v156, v72, v74
    v_add_f32 v157, v73, v75
    v_cvt_pk_bf16_f32 v158, v156, v157
    ds_write_b16 v5, v158
    ds_write_b16_d16_hi v5, v158 offset:80
    s_waitcnt lgkmcnt(0)
    s_barrier
    s_cmp_eq_u32 s14, 3
    s_cbranch_scc1 Lw3_44
    ds_read_b128 v[108:111], v6
    s_cmp_lg_u32 s14, 0
    s_cbranch_scc1 Lnot0_46
    ds_read_b128 v[104:107], v7
Lnot0_46:
    s_waitcnt vmcnt(0) lgkmcnt(0)
    v_mfma_f32_16x16x32_bf16 v[112:115], v[104:107], v[108:111], 0
    s_mov_b64 exec, s[20:21]
    s_nop 6
    v_min_u32 v112, -2, v112
    v_min_u32 v113, -2, v113
    v_min_u32 v114, -2, v114
    v_min_u32 v115, -2, v115
    buffer_store_dwordx4 v[112:115], v8, s[4:7], s16 offen sc1
    s_mov_b64 exec, -1
    s_cmp_eq_u32 s14, 2
    s_cbranch_scc1 Lvhi_47
    v_smfmac_f32_16x16x64_bf16 v[76:79], v[32:35], a[80:87], v1
    v_smfmac_f32_16x16x64_bf16 v[76:79], v[36:39], a[88:95], v1
    v_smfmac_f32_16x16x64_bf16 v[76:79], v[40:43], a[96:103], v1
    v_smfmac_f32_16x16x64_bf16 v[76:79], v[44:47], a[104:111], v1
    v_smfmac_f32_16x16x64_bf16 v[76:79], v[48:51], a[112:119], v1
    s_branch Lvdone_48
Lvhi_47:
    v_smfmac_f32_16x16x64_bf16 v[76:79], v[52:55], a[80:87], v1
    v_smfmac_f32_16x16x64_bf16 v[76:79], v[56:59], a[88:95], v1
    v_smfmac_f32_16x16x64_bf16 v[76:79], v[60:63], a[96:103], v1
    v_smfmac_f32_16x16x64_bf16 v[76:79], v[64:67], a[104:111], v1
    v_smfmac_f32_16x16x64_bf16 v[76:79], v[68:71], a[112:119], v1
Lvdone_48:
    s_nop 7
    ds_write_b128 v20, v[76:79]
    s_waitcnt lgkmcnt(0)
    s_barrier
    s_and_b32 s18, s15, 3
    s_cmp_lg_u32 s14, 0
    s_cbranch_scc1 Lnk_51
    s_lshl_b32 s18, s18, 10
    v_add_u32 v23, s18, v2
    ds_write_b128 v23, v[104:107] offset:24576
    s_waitcnt lgkmcnt(0)
Lnk_51:
    s_cmp_lg_u32 s14, 1
    s_cbranch_scc1 Lnv_50
    ds_read_b128 v[156:159], v21 offset:0
    ds_read_b128 v[160:163], v21 offset:512
    ds_read_b128 v[164:167], v21 offset:2048
    ds_read_b128 v[168:171], v21 offset:2560
    s_waitcnt lgkmcnt(0)
    v_add_f32 v156, v156, v160
    v_add_f32 v164, v164, v168
    v_add_f32 v157, v157, v161
    v_add_f32 v165, v165, v169
    v_add_f32 v158, v158, v162
    v_add_f32 v166, v166, v170
    v_add_f32 v159, v159, v163
    v_add_f32 v167, v167, v171
    v_add_f32 v156, v156, v164
    v_add_f32 v157, v157, v165
    v_add_f32 v158, v158, v166
    v_add_f32 v159, v159, v167
    v_cvt_pk_bf16_f32 v124, v156, v157
    v_cvt_pk_bf16_f32 v125, v158, v159
    s_lshl_b32 s18, s18, 9
    v_lshrrev_b32 v23, 1, v2
    v_add_u32 v23, s18, v23
    ds_write_b64 v23, v[124:125] offset:28672
    s_waitcnt lgkmcnt(0)
Lnv_50:
    s_cmp_eq_u32 s15, 63
    s_cbranch_scc1 ch_done
    s_buffer_load_dwordx2 s[92:93], s[4:7], s90 offset:60
    s_buffer_load_dwordx2 s[92:93], s[4:7], s90 offset:8380
    s_buffer_load_dwordx2 s[92:93], s[4:7], s90 offset:16700
    s_buffer_load_dwordx2 s[92:93], s[4:7], s90 offset:25020
    s_buffer_load_dwordx2 s[92:93], s[4:7], s90 offset:33340
    s_buffer_load_dwordx2 s[92:93], s[4:7], s90 offset:41660
    s_add_u32 s90, s90, 266240
    s_branch Ljoin4_45
Lw3_44:
    v_smfmac_f32_16x16x64_bf16 v[76:79], v[52:55], a[80:87], v1
    v_smfmac_f32_16x16x64_bf16 v[76:79], v[56:59], a[88:95], v1
    v_smfmac_f32_16x16x64_bf16 v[76:79], v[60:63], a[96:103], v1
    v_smfmac_f32_16x16x64_bf16 v[76:79], v[64:67], a[104:111], v1
    v_smfmac_f32_16x16x64_bf16 v[76:79], v[68:71], a[112:119], v1
    v_mov_b32 v194, 0
    v_mov_b32 v195, 0
    s_nop 5
    ds_write_b128 v20, v[76:79]
    s_waitcnt lgkmcnt(0)
    s_sleep 3
    buffer_load_dwordx4 v[80:83], v208, s[4:7], s16 offen offset:0 sc1
    buffer_load_dwordx4 v[84:87], v208, s[4:7], s16 offen offset:1536 sc1
    buffer_load_dwordx4 v[88:91], v209, s[4:7], s16 offen offset:0 sc1
    buffer_load_dwordx4 v[92:95], v209, s[4:7], s16 offen offset:1536 sc1
    buffer_load_dwordx4 v[96:99], v9, s[4:7], s16 offen offset:0 sc1
    buffer_load_dwordx4 v[100:103], v9, s[4:7], s16 offen offset:1536 sc1
    s_barrier
    ds_read_b128 v[156:159], v21 offset:0
    ds_read_b128 v[160:163], v21 offset:512
    ds_read_b128 v[164:167], v21 offset:2048
    ds_read_b128 v[168:171], v21 offset:2560
    s_waitcnt lgkmcnt(0)
    v_add_f32 v156, v156, v160
    v_add_f32 v164, v164, v168
    v_add_f32 v157, v157, v161
    v_add_f32 v165, v165, v169
    v_add_f32 v158, v158, v162
    v_add_f32 v166, v166, v170
    v_add_f32 v159, v159, v163
    v_add_f32 v167, v167, v171
    v_add_f32 v156, v156, v164
    v_add_f32 v157, v157, v165
    v_add_f32 v158, v158, v166
    v_add_f32 v159, v159, v167
    v_cvt_pk_bf16_f32 v124, v156, v157
    v_cvt_pk_bf16_f32 v125, v158, v159
    s_cmp_eq_u32 s15, 63
    s_cbranch_scc1 ch_done
    v_mov_b32 v186, v124
    v_mov_b32 v187, v125
    s_nop 1
    v_permlane32_swap_b32 v186, v194
    v_permlane32_swap_b32 v187, v195
Lr1_52:
    buffer_load_dwordx4 v[80:83], v208, s[4:7], s16 offen offset:0 sc1
    buffer_load_dwordx4 v[84:87], v208, s[4:7], s16 offen offset:1536 sc1
    buffer_load_dwordx4 v[88:91], v209, s[4:7], s16 offen offset:0 sc1
    buffer_load_dwordx4 v[92:95], v209, s[4:7], s16 offen offset:1536 sc1
    buffer_load_dwordx4 v[96:99], v9, s[4:7], s16 offen offset:0 sc1
    buffer_load_dwordx4 v[100:103], v9, s[4:7], s16 offen offset:1536 sc1
    s_waitcnt vmcnt(6)
    v_max3_u32 v156, v80, v81, v82
    v_max3_u32 v157, v83, v84, v85
    v_max3_u32 v158, v86, v87, v88
    v_max3_u32 v159, v89, v90, v91
    v_max3_u32 v160, v92, v93, v94
    v_max3_u32 v161, v95, v96, v97
    v_max3_u32 v162, v98, v99, v100
    v_max3_u32 v163, v101, v102, v103
    v_max3_u32 v164, v156, v157, v158
    v_max3_u32 v165, v159, v160, v161
    v_max_u32 v166, v162, v163
    v_max3_u32 v167, v164, v165, v166
    v_cmp_eq_u32 vcc, -1, v167
    s_cbranch_vccnz Lretry_54
    s_mov_b64 exec, -1
    v_add_f32 v132, v96, v100
    v_add_f32 v133, v97, v101
    v_add_f32 v134, v98, v102
    v_add_f32 v135, v99, v103
    v_add_f32 v128, v80, v84
    v_add_f32 v136, v88, v92
    v_add_f32 v129, v81, v85
    v_add_f32 v137, v89, v93
    v_add_f32 v130, v82, v86
    v_add_f32 v138, v90, v94
    v_add_f32 v131, v83, v87
    v_add_f32 v139, v91, v95
    v_add_f32_dpp v132, v132, v132 row_ror:8 row_mask:0xf bank_mask:0xf
    v_add_f32_dpp v133, v133, v133 row_ror:8 row_mask:0xf bank_mask:0xf
    v_add_f32_dpp v134, v134, v134 row_ror:8 row_mask:0xf bank_mask:0xf
    v_add_f32_dpp v135, v135, v135 row_ror:8 row_mask:0xf bank_mask:0xf
    v_add_f32 v128, v128, v136
    v_add_f32 v129, v129, v137
    v_add_f32 v130, v130, v138
    v_add_f32 v131, v131, v139
    v_cndmask_b32 v132, v27, v132, s[24:25]
    v_cndmask_b32 v133, v27, v133, s[24:25]
    v_cndmask_b32 v134, v27, v134, s[24:25]
    v_cndmask_b32 v135, v27, v135, s[24:25]
    v_max3_f32 v156, v128, v129, v130
    v_max3_f32 v157, v131, v132, v133
    v_max3_f32 v156, v156, v134, v135
    v_max_f32 v156, v156, v157
    s_nop 1
    v_max_f32_dpp v156, v156, v156 row_ror:8 row_mask:0xf bank_mask:0xf
    v_mov_b32 v157, v156
    s_nop 1
    v_permlane16_swap_b32 v156, v157
    v_max_f32 v156, v156, v157
    v_mov_b32 v157, v156
    s_nop 1
    v_permlane32_swap_b32 v156, v157
    v_max_f32 v156, v156, v157
    v_mul_f32 v156, s51, v156
    v_fma_f32 v128, v128, s51, -v156
    v_fma_f32 v129, v129, s51, -v156
    v_fma_f32 v130, v130, s51, -v156
    v_fma_f32 v131, v131, s51, -v156
    v_fma_f32 v132, v132, s51, -v156
    v_fma_f32 v133, v133, s51, -v156
    v_fma_f32 v134, v134, s51, -v156
    v_fma_f32 v135, v135, s51, -v156
    v_exp_f32 v128, v128
    v_exp_f32 v129, v129
    v_exp_f32 v130, v130
    v_exp_f32 v131, v131
    v_exp_f32 v132, v132
    v_exp_f32 v133, v133
    v_exp_f32 v134, v134
    v_exp_f32 v135, v135
    s_nop 0
    v_cvt_pk_bf16_f32 v140, v128, v129
    v_cvt_pk_bf16_f32 v141, v130, v131
    v_cvt_pk_bf16_f32 v142, v132, v133
    v_cvt_pk_bf16_f32 v143, v134, v135
    s_nop 1
    v_mfma_f32_16x16x32_bf16 v[220:223], v[200:203], v[140:143], 0
    v_mfma_f32_16x16x32_bf16 v[224:227], v[204:207], v[140:143], 0
    v_mfma_f32_16x16x32_bf16 v[148:151], v[184:187], v[140:143], 0
    v_mfma_f32_16x16x32_bf16 v[212:215], v[188:191], v[140:143], 0
    v_mfma_f32_16x16x32_bf16 v[152:155], v[192:195], v[140:143], 0
    v_mfma_f32_16x16x32_bf16 v[216:219], v[196:199], v[140:143], 0
    s_nop 3
    v_add_f32_dpp v156, v224, v220 row_ror:8 row_mask:0xf bank_mask:0xf
    v_rcp_f32 v156, v156
    s_nop 1
    v_add_f32_dpp v148, v212, v148 row_ror:8 row_mask:0xf bank_mask:0xf
    v_add_f32_dpp v149, v213, v149 row_ror:8 row_mask:0xf bank_mask:0xf
    v_add_f32_dpp v150, v214, v150 row_ror:8 row_mask:0xf bank_mask:0xf
    v_add_f32_dpp v151, v215, v151 row_ror:8 row_mask:0xf bank_mask:0xf
    v_add_f32_dpp v152, v216, v152 row_ror:8 row_mask:0xf bank_mask:0xf
    v_add_f32_dpp v153, v217, v153 row_ror:8 row_mask:0xf bank_mask:0xf
    v_add_f32_dpp v154, v218, v154 row_ror:8 row_mask:0xf bank_mask:0xf
    v_add_f32_dpp v155, v219, v155 row_ror:8 row_mask:0xf bank_mask:0xf
    v_mul_f32 v148, v148, v156
    v_mul_f32 v149, v149, v156
    v_mul_f32 v150, v150, v156
    v_mul_f32 v151, v151, v156
    v_mul_f32 v152, v152, v156
    v_mul_f32 v153, v153, v156
    v_mul_f32 v154, v154, v156
    v_mul_f32 v155, v155, v156
    v_cvt_pk_bf16_f32 v112, v148, v149
    v_cvt_pk_bf16_f32 v114, v152, v153
    v_cvt_pk_bf16_f32 v113, v150, v151
    v_cvt_pk_bf16_f32 v115, v154, v155
    s_mov_b64 exec, s[20:21]
    v_min_u32 v112, -2, v112
    v_min_u32 v113, -2, v113
    v_min_u32 v114, -2, v114
    v_min_u32 v115, -2, v115
    buffer_store_dwordx4 v[112:115], v10, s[4:7], s16 offen sc1
    s_mov_b64 exec, -1
Ljoin4_45:
    s_barrier
    s_add_u32 s28, s28, 266240
    s_add_u32 s29, s29, 64
    v_mov_b32 v172, 0
    v_mov_b32 v176, 0
    v_mov_b32 v173, 0
    v_mov_b32 v177, 0
    v_mov_b32 v174, 0
    v_mov_b32 v178, 0
    v_mov_b32 v175, 0
    v_mov_b32 v179, 0
    s_lshr_b32 s27, s15, 2
    s_lshr_b32 s27, s58, s27
    s_and_b32 s27, s27, 1
    s_lshl_b32 s27, s27, 13
    s_lshl_b32 s18, s15, 19
    s_add_u32 s27, s27, s18
    s_sleep 1
    buffer_load_dwordx4 v[80:83], v11, s[4:7], s16 offen offset:0 sc1
    buffer_load_dwordx4 v[84:87], v11, s[4:7], s16 offen offset:1024 sc1
    buffer_load_dwordx4 v[88:91], v11, s[4:7], s16 offen offset:2048 sc1
    buffer_load_dwordx4 v[92:95], v11, s[4:7], s16 offen offset:3072 sc1
    s_sleep 2
Lr2a_55:
    buffer_load_dwordx4 v[80:83], v11, s[4:7], s16 offen offset:0 sc1
    buffer_load_dwordx4 v[84:87], v11, s[4:7], s16 offen offset:1024 sc1
    buffer_load_dwordx4 v[88:91], v11, s[4:7], s16 offen offset:2048 sc1
    buffer_load_dwordx4 v[92:95], v11, s[4:7], s16 offen offset:3072 sc1
    s_waitcnt vmcnt(4)
    v_max3_u32 v156, v80, v81, v82
    v_max3_u32 v157, v83, v84, v85
    v_max3_u32 v158, v86, v87, v88
    v_max3_u32 v159, v89, v90, v91
    v_max3_u32 v160, v92, v93, v94
    v_max3_u32 v161, v156, v157, v158
    v_max3_u32 v162, v159, v160, v95
    v_max_u32 v163, v161, v162
    v_cmp_eq_u32 vcc, -1, v163
    s_cbranch_vccnz Lretry_56
    s_mov_b64 exec, -1
    v_smfmac_f32_16x16x64_bf16 v[172:175], v[80:83], a[120:127], v1
    v_smfmac_f32_16x16x64_bf16 v[176:179], v[80:83], a[152:159], v1
    v_smfmac_f32_16x16x64_bf16 v[172:175], v[84:87], a[128:135], v1
    v_smfmac_f32_16x16x64_bf16 v[176:179], v[84:87], a[160:167], v1
    v_smfmac_f32_16x16x64_bf16 v[172:175], v[88:91], a[136:143], v1
    v_smfmac_f32_16x16x64_bf16 v[176:179], v[88:91], a[168:175], v1
    v_smfmac_f32_16x16x64_bf16 v[172:175], v[92:95], a[144:151], v1
    v_smfmac_f32_16x16x64_bf16 v[176:179], v[92:95], a[176:183], v1
    s_nop 7
    v_permlane32_swap_b32 v172, v176
    v_permlane32_swap_b32 v173, v177
    v_permlane32_swap_b32 v174, v178
    v_permlane32_swap_b32 v175, v179
    v_add_f32 v172, v172, v176
    v_add_f32 v173, v173, v177
    v_add_f32 v174, v174, v178
    v_add_f32 v175, v175, v179
    ds_write_b128 v22, v[172:175]
    s_waitcnt lgkmcnt(0)
    s_barrier
    s_cmp_eq_u32 s14, 0
    s_cbranch_scc1 Lw0_59
    s_cmp_eq_u32 s14, 1
    s_cbranch_scc1 Lw1_60
    s_cmp_eq_u32 s14, 2
    s_cbranch_scc1 Lw2_61
    s_sleep 3
    s_and_b32 s18, s15, 3
    s_cmp_lg_u32 s18, 3
    s_cbranch_scc1 Lxv_62
    s_sleep 1
    v_lshrrev_b32 v23, 1, v2
    ds_read_b64 v[156:157], v23 offset:28672
    ds_read_b64 v[158:159], v23 offset:29184
    ds_read_b64 v[160:161], v23 offset:29696
    ds_read_b64 v[162:163], v23 offset:30208
    s_and_b32 s30, s15, 0xfc
    s_lshl_b32 s30, s30, 16
    s_add_u32 s18, s30, 0
    s_waitcnt lgkmcnt(3)
    buffer_store_dwordx2 v[156:157], v19, s[4:7], s18 offen sc1
    s_add_u32 s18, s30, 65536
    s_waitcnt lgkmcnt(2)
    buffer_store_dwordx2 v[158:159], v19, s[4:7], s18 offen sc1
    s_add_u32 s18, s30, 131072
    s_waitcnt lgkmcnt(1)
    buffer_store_dwordx2 v[160:161], v19, s[4:7], s18 offen sc1
    s_add_u32 s18, s30, 196608
    s_waitcnt lgkmcnt(0)
    buffer_store_dwordx2 v[162:163], v19, s[4:7], s18 offen sc1
Lxv_62:
    s_and_b32 s18, s15, 1
    s_mul_i32 s18, s18, 67584
    s_lshr_b32 s19, s15, 1
    s_lshl_b32 s19, s19, 7
    s_add_u32 s18, s18, s19
    s_add_u32 s18, s91, s18
    s_buffer_load_dwordx2 s[92:93], s[4:7], s18 offset:42300
    s_buffer_load_dwordx2 s[92:93], s[4:7], s18 offset:46524
    s_buffer_load_dwordx2 s[92:93], s[4:7], s18 offset:50748
    s_buffer_load_dwordx2 s[92:93], s[4:7], s18 offset:54972
    s_buffer_load_dwordx2 s[92:93], s[4:7], s18 offset:59196
    s_buffer_load_dwordx2 s[92:93], s[4:7], s18 offset:63420
    s_mov_b64 exec, s[20:21]
    buffer_store_dwordx4 v[28:31], v10, s[4:7], s17 offen sc1
    s_mov_b64 exec, s[22:23]
    buffer_store_dword v28, v14, s[4:7], s17 offen sc1
    buffer_store_dword v28, v14, s[4:7], s17 offen offset:32 sc1
    s_mov_b64 exec, -1
    s_branch Ljoin6_57
Lw2_61:
    s_sleep 3
    s_and_b32 s18, s15, 3
    s_cmp_lg_u32 s18, 3
    s_cbranch_scc1 Lxk_63
    s_sleep 1
    ds_read_b128 v[156:159], v2 offset:24576
    ds_read_b128 v[160:163], v2 offset:25600
    ds_read_b128 v[164:167], v2 offset:26624
    ds_read_b128 v[168:171], v2 offset:27648
    s_and_b32 s30, s15, 0xfc
    s_lshl_b32 s30, s30, 16
    s_mov_b64 exec, s[20:21]
    s_add_u32 s18, s30, 0
    s_waitcnt lgkmcnt(3)
    buffer_store_dwordx4 v[156:159], v18, s[4:7], s18 offen sc1
    s_add_u32 s18, s30, 65536
    s_waitcnt lgkmcnt(2)
    buffer_store_dwordx4 v[160:163], v18, s[4:7], s18 offen sc1
    s_add_u32 s18, s30, 131072
    s_waitcnt lgkmcnt(1)
    buffer_store_dwordx4 v[164:167], v18, s[4:7], s18 offen sc1
    s_add_u32 s18, s30, 196608
    s_waitcnt lgkmcnt(0)
    buffer_store_dwordx4 v[168:171], v18, s[4:7], s18 offen sc1
    s_mov_b64 exec, -1
    s_branch Lxp_64
Lxk_63:
    s_cmp_lg_u32 s18, 0
    s_cbranch_scc1 Lxp_64
    s_cmp_eq_u32 s15, 0
    s_cbranch_scc1 Lxp_64
    s_sleep 2
    s_mov_b64 exec, 1
    v_mov_b32 v157, s15
    buffer_store_dword v157, v180, s[4:7], 0 offen sc1
    s_mov_b64 exec, -1
Lxp_64:
    s_and_b32 s18, s15, 7
    s_cmp_lg_u32 s18, 7
    s_cbranch_scc1 Lkvd_66
    s_add_u32 s18, s15, 1
    s_lshr_b32 s18, s18, 1
    s_add_u32 s18, s18, 128
    v_mov_b32 v181, s18
Lkv_65:
    buffer_load_dword v158, v181, s[96:99], 0 offen sc1
    s_waitcnt vmcnt(0)
    v_readfirstlane_b32 s18, v158
    s_add_u32 s57, s57, 1
    s_cmp_gt_u32 s57, 0x100000
    s_cbranch_scc1 fused_kernel_exit
    s_and_b32 s18, s18, 0xffff
    s_cmp_lt_u32 s18, 128
    s_cbranch_scc1 Lkv_65
Lkvd_66:
    s_and_b32 s18, s15, 1
    s_mul_i32 s18, s18, 67584
    s_lshr_b32 s19, s15, 1
    s_lshl_b32 s19, s19, 7
    s_add_u32 s18, s18, s19
    s_add_u32 s18, s91, s18
    s_buffer_load_dwordx2 s[92:93], s[4:7], s18 offset:21180
    s_buffer_load_dwordx2 s[92:93], s[4:7], s18 offset:25404
    s_buffer_load_dwordx2 s[92:93], s[4:7], s18 offset:29628
    s_buffer_load_dwordx2 s[92:93], s[4:7], s18 offset:33852
    s_buffer_load_dwordx2 s[92:93], s[4:7], s18 offset:38076
    s_mov_b64 exec, s[20:21]
    v_subrev_u32 v156, 1024, v8
    buffer_store_dwordx4 v[28:31], v156, s[4:7], s17 offen offset:0 sc1
    buffer_store_dwordx4 v[28:31], v156, s[4:7], s17 offen offset:512 sc1
    buffer_store_dwordx4 v[28:31], v156, s[4:7], s17 offen offset:1024 sc1
    s_mov_b64 exec, -1
    s_branch Ljoin6_57
Lw1_60:
    ds_read_b128 v[156:159], v2 offset:16384
    ds_read_b128 v[160:163], v2 offset:17408
    ds_read_b128 v[164:167], v2 offset:18432
    ds_read_b128 v[168:171], v2 offset:19456
    s_waitcnt lgkmcnt(0)
    v_add_f32 v172, v156, v160
    v_add_f32 v164, v164, v168
    v_add_f32 v173, v157, v161
    v_add_f32 v165, v165, v169
    v_add_f32 v174, v158, v162
    v_add_f32 v166, v166, v170
    v_add_f32 v175, v159, v163
    v_add_f32 v167, v167, v171
    v_add_f32 v172, v172, v164
    v_add_f32 v173, v173, v165
    v_add_f32 v174, v174, v166
    v_add_f32 v175, v175, v167
    s_mov_b64 exec, s[22:23]
    v_min_u32 v172, -2, v172
    v_min_u32 v173, -2, v173
    v_min_u32 v174, -2, v174
    v_min_u32 v175, -2, v175
    buffer_store_dwordx4 v[172:175], v12, s[4:7], s27 offen sc1
    buffer_store_dwordx4 v[172:175], v12, s[4:7], s27 offen offset:2560 sc1
    s_add_u32 s27, s27, 2560
    buffer_store_dwordx4 v[172:175], v12, s[4:7], s27 offen offset:2560 sc1
    s_mov_b64 exec, -1
    s_and_b32 s18, s15, 1
    s_mul_i32 s18, s18, 67584
    s_lshr_b32 s19, s15, 1
    s_lshl_b32 s19, s19, 7
    s_add_u32 s18, s18, s19
    s_add_u32 s18, s91, s18
    s_buffer_load_dwordx2 s[92:93], s[4:7], s18 offset:60
    s_buffer_load_dwordx2 s[92:93], s[4:7], s18 offset:4284
    s_buffer_load_dwordx2 s[92:93], s[4:7], s18 offset:8508
    s_buffer_load_dwordx2 s[92:93], s[4:7], s18 offset:12732
    s_buffer_load_dwordx2 s[92:93], s[4:7], s18 offset:16956
    s_branch Ljoin6_57
Lw0_59:
    s_add_u32 s18, s27, s48
    s_add_u32 s19, s27, s49
    s_add_u32 s26, s27, s50
    ds_read_b128 v[156:159], v2 offset:16384
    ds_read_b128 v[160:163], v2 offset:17408
    ds_read_b128 v[164:167], v2 offset:18432
    ds_read_b128 v[168:171], v2 offset:19456
    s_waitcnt lgkmcnt(0)
    v_add_f32 v172, v156, v160
    v_add_f32 v164, v164, v168
    v_add_f32 v173, v157, v161
    v_add_f32 v165, v165, v169
    v_add_f32 v174, v158, v162
    v_add_f32 v166, v166, v170
    v_add_f32 v175, v159, v163
    v_add_f32 v167, v167, v171
    v_add_f32 v172, v172, v164
    v_add_f32 v173, v173, v165
    v_add_f32 v174, v174, v166
    v_add_f32 v175, v175, v167
    v_add_u32 v23, 2560, v13
    s_sleep 5
    buffer_load_dwordx4 v[80:83], v13, s[4:7], s18 offen offset:0 sc1
    buffer_load_dwordx4 v[84:87], v13, s[4:7], s19 offen offset:0 sc1
    buffer_load_dwordx4 v[88:91], v13, s[4:7], s26 offen offset:0 sc1
    s_sleep 4
    buffer_load_dwordx4 v[92:95], v13, s[4:7], s18 offen offset:2560 sc1
    buffer_load_dwordx4 v[96:99], v13, s[4:7], s19 offen offset:2560 sc1
    buffer_load_dwordx4 v[100:103], v13, s[4:7], s26 offen offset:2560 sc1
    s_waitcnt vmcnt(3)
    v_max3_u32 v156, v80, v81, v82
    v_max3_u32 v157, v83, v84, v85
    v_max3_u32 v158, v86, v87, v88
    v_max3_u32 v159, v89, v90, v91
    v_max3_u32 v160, v156, v157, v158
    v_max_u32 v161, v160, v159
    v_cmp_eq_u32 vcc, -1, v161
    s_cbranch_vccnz Lr2bB_67
    v_add_f32 v112, v172, v80
    v_add_f32 v160, v84, v88
    v_add_f32 v113, v173, v81
    v_add_f32 v161, v85, v89
    v_add_f32 v114, v174, v82
    v_add_f32 v162, v86, v90
    v_add_f32 v115, v175, v83
    v_add_f32 v163, v87, v91
    s_branch Lr2bJ_69
Lr2bB_67:
    buffer_load_dwordx4 v[32:35], v23, s[4:7], s18 offen offset:2560 sc1
    buffer_load_dwordx4 v[36:39], v23, s[4:7], s19 offen offset:2560 sc1
    buffer_load_dwordx4 v[40:43], v23, s[4:7], s26 offen offset:2560 sc1
    s_waitcnt vmcnt(3)
    v_max3_u32 v156, v92, v93, v94
    v_max3_u32 v157, v95, v96, v97
    v_max3_u32 v158, v98, v99, v100
    v_max3_u32 v159, v101, v102, v103
    v_max3_u32 v160, v156, v157, v158
    v_max_u32 v161, v160, v159
    v_cmp_eq_u32 vcc, -1, v161
    s_cbranch_vccnz Lr2bC_68
    v_add_f32 v112, v172, v92
    v_add_f32 v160, v96, v100
    v_add_f32 v113, v173, v93
    v_add_f32 v161, v97, v101
    v_add_f32 v114, v174, v94
    v_add_f32 v162, v98, v102
    v_add_f32 v115, v175, v95
    v_add_f32 v163, v99, v103
    s_branch Lr2bJ_69
Lr2b_58:
    buffer_load_dwordx4 v[32:35], v23, s[4:7], s18 offen offset:2560 sc1
    buffer_load_dwordx4 v[36:39], v23, s[4:7], s19 offen offset:2560 sc1
    buffer_load_dwordx4 v[40:43], v23, s[4:7], s26 offen offset:2560 sc1
Lr2bC_68:
    s_waitcnt vmcnt(0)
    v_max3_u32 v156, v32, v33, v34
    v_max3_u32 v157, v35, v36, v37
    v_max3_u32 v158, v38, v39, v40
    v_max3_u32 v159, v41, v42, v43
    v_max3_u32 v160, v156, v157, v158
    v_max_u32 v161, v160, v159
    v_cmp_eq_u32 vcc, -1, v161
    s_cbranch_vccnz Lretry_70
    s_mov_b64 exec, -1
    v_add_f32 v112, v172, v32
    v_add_f32 v160, v36, v40
    v_add_f32 v113, v173, v33
    v_add_f32 v161, v37, v41
    v_add_f32 v114, v174, v34
    v_add_f32 v162, v38, v42
    v_add_f32 v115, v175, v35
    v_add_f32 v163, v39, v43
Lr2bJ_69:
    v_add_f32 v112, v112, v160
    v_add_f32 v113, v113, v161
    v_add_f32 v114, v114, v162
    v_add_f32 v115, v115, v163
    s_nop 1
    v_permlane32_swap_b32 v112, v113
    v_permlane32_swap_b32 v114, v115
    v_cvt_pk_bf16_f32 v156, v112, v113
    v_cvt_pk_bf16_f32 v157, v114, v115
    s_mov_b64 exec, s[22:23]
    v_min_u32 v156, -2, v156
    v_min_u32 v157, -2, v157
    buffer_store_dword v156, v14, s[4:7], s16 offen sc1
    buffer_store_dword v157, v14, s[4:7], s16 offen offset:32 sc1
    s_mov_b64 exec, -1
Ljoin6_57:
    s_barrier
    s_cmp_lg_u32 s15, 7
    s_cbranch_scc1 Lnpar_72
    v_mov_b32 v24, 36
    buffer_load_dword v23, v24, s[96:99], 0 offen sc1
    s_waitcnt vmcnt(0)
    v_readfirstlane_b32 s58, v23
Lnpar_72:
    s_cmp_eq_u32 s14, 0
    s_cbranch_scc1 Lpfb_74
    s_cmp_eq_u32 s14, 3
    s_cbranch_scc1 Lpfa_73
    buffer_load_dwordx4 v[104:107], v15, s[4:7], s28 offen sc1
    s_branch Lpfb_74
Lpfa_73:
    buffer_load_dwordx2 v[184:185], v16, s[4:7], s29 offen sc1
    buffer_load_dwordx2 v[188:189], v16, s[4:7], s29 offen offset:8 sc1
    buffer_load_dwordx2 v[192:193], v17, s[4:7], s29 offen sc1
    buffer_load_dwordx2 v[196:197], v17, s[4:7], s29 offen offset:8 sc1
Lpfb_74:
    v_mov_b32 v72, 0
    v_mov_b32 v73, 0
    v_mov_b32 v74, 0
    v_mov_b32 v75, 0
    v_mov_b32 v76, 0
    v_mov_b32 v77, 0
    v_mov_b32 v78, 0
    v_mov_b32 v79, 0
    s_sleep 3
    s_cmp_ge_u32 s14, 2
    s_cbranch_scc1 Lr2c2_75
Lr2c_71:
    buffer_load_dwordx4 v[80:83], v3, s[4:7], s16 offen offset:0 sc1
    buffer_load_dwordx4 v[84:87], v3, s[4:7], s16 offen offset:1024 sc1
    buffer_load_dwordx4 v[88:91], v3, s[4:7], s16 offen offset:2048 sc1
    s_waitcnt vmcnt(0)
    ds_write_b128 v4, v[80:83] offset:0
    ds_write_b128 v4, v[84:87] offset:1024
    ds_write_b128 v4, v[88:91] offset:2048
    v_max3_u32 v156, v80, v81, v82
    v_max3_u32 v157, v83, v84, v85
    v_max3_u32 v158, v86, v87, v88
    v_max3_u32 v159, v89, v90, v91
    v_max3_u32 v160, v156, v157, v158
    v_max_u32 v161, v160, v159
    v_cmp_eq_u32 vcc, -1, v161
    s_cbranch_vccnz Lretry_77
    s_mov_b64 exec, -1
    s_branch Lr2cJ_76
Lr2c2_75:
    buffer_load_dwordx4 v[80:83], v3, s[4:7], s16 offen offset:0 sc1
    buffer_load_dwordx4 v[84:87], v3, s[4:7], s16 offen offset:1024 sc1
    s_waitcnt vmcnt(0)
    ds_write_b128 v4, v[80:83] offset:0
    ds_write_b128 v4, v[84:87] offset:1024
    v_max3_u32 v156, v80, v81, v82
    v_max3_u32 v157, v83, v84, v85
    v_max_u32 v158, v86, v87
    v_max3_u32 v159, v156, v157, v158
    v_cmp_eq_u32 vcc, -1, v159
    s_cbranch_vccnz Lretry_78
    s_mov_b64 exec, -1
Lr2cJ_76:
    s_add_u32 s15, s15, 1
    s_add_u32 s16, s16, 524288
    s_and_b32 s16, s16, 2097151
    s_add_u32 s17, s17, 524288
    s_and_b32 s17, s17, 2097151
    s_branch ch_loopS
Lretry_54:
    s_mov_b64 exec, vcc
    s_add_u32 s57, s57, 1
    s_cmp_lt_u32 s57, 0x100000
    s_cbranch_scc1 Lr1_52
    s_branch fused_kernel_exit
Lretry_56:
    s_mov_b64 exec, vcc
    s_add_u32 s57, s57, 1
    s_cmp_lt_u32 s57, 0x100000
    s_cbranch_scc1 Lr2a_55
    s_branch fused_kernel_exit
Lretry_70:
    s_mov_b64 exec, vcc
    s_add_u32 s57, s57, 1
    s_cmp_lt_u32 s57, 0x100000
    s_cbranch_scc1 Lr2b_58
    s_branch fused_kernel_exit
Lretry_77:
    s_mov_b64 exec, vcc
    s_add_u32 s57, s57, 1
    s_cmp_lt_u32 s57, 0x100000
    s_cbranch_scc1 Lr2c_71
    s_branch fused_kernel_exit
Lretry_78:
    s_mov_b64 exec, vcc
    s_add_u32 s57, s57, 1
    s_cmp_lt_u32 s57, 0x100000
    s_cbranch_scc1 Lr2c2_75
    s_branch fused_kernel_exit
ch_done:
    s_waitcnt lgkmcnt(0)
    s_barrier
    s_cmp_lg_u32 s14, 0
    s_cbranch_scc1 Lf0_79
    ds_read_b128 v[156:159], v2 offset:24576
    ds_read_b128 v[160:163], v2 offset:25600
    ds_read_b128 v[164:167], v2 offset:26624
    ds_read_b128 v[168:171], v2 offset:27648
    s_and_b32 s30, s15, 0xfc
    s_lshl_b32 s30, s30, 16
    s_mov_b64 exec, s[20:21]
    s_add_u32 s18, s30, 0
    s_waitcnt lgkmcnt(3)
    buffer_store_dwordx4 v[156:159], v18, s[4:7], s18 offen sc1
    s_add_u32 s18, s30, 65536
    s_waitcnt lgkmcnt(2)
    buffer_store_dwordx4 v[160:163], v18, s[4:7], s18 offen sc1
    s_add_u32 s18, s30, 131072
    s_waitcnt lgkmcnt(1)
    buffer_store_dwordx4 v[164:167], v18, s[4:7], s18 offen sc1
    s_add_u32 s18, s30, 196608
    s_waitcnt lgkmcnt(0)
    buffer_store_dwordx4 v[168:171], v18, s[4:7], s18 offen sc1
    s_mov_b64 exec, -1
Lf0_79:
    s_cmp_lg_u32 s14, 1
    s_cbranch_scc1 Lf1_80
    v_lshrrev_b32 v23, 1, v2
    ds_read_b64 v[156:157], v23 offset:28672
    ds_read_b64 v[158:159], v23 offset:29184
    ds_read_b64 v[160:161], v23 offset:29696
    ds_read_b64 v[162:163], v23 offset:30208
    s_and_b32 s30, s15, 0xfc
    s_lshl_b32 s30, s30, 16
    s_add_u32 s18, s30, 0
    s_waitcnt lgkmcnt(3)
    buffer_store_dwordx2 v[156:157], v19, s[4:7], s18 offen sc1
    s_add_u32 s18, s30, 65536
    s_waitcnt lgkmcnt(2)
    buffer_store_dwordx2 v[158:159], v19, s[4:7], s18 offen sc1
    s_add_u32 s18, s30, 131072
    s_waitcnt lgkmcnt(1)
    buffer_store_dwordx2 v[160:161], v19, s[4:7], s18 offen sc1
    s_add_u32 s18, s30, 196608
    s_waitcnt lgkmcnt(0)
    buffer_store_dwordx2 v[162:163], v19, s[4:7], s18 offen sc1
Lf1_80:
    s_waitcnt vmcnt(0)
    s_barrier
    s_cmp_lg_u32 s14, 2
    s_cbranch_scc1 Lfin_81
    s_mov_b64 exec, 1
    v_mov_b32 v156, 64
    buffer_store_dword v156, v180, s[4:7], 0 offen sc1
    s_mov_b64 exec, -1
Lfin_81:
    s_branch Lchelp
Lchelp:
    v_mov_b32 v1, v0
    s_mov_b32 s3, 0
    s_mov_b32 s81, 0
    s_load_dwordx16 s[40:55], s[0:1], 0
    s_load_dwordx16 s[56:71], s[0:1], 64
    s_load_dwordx8 s[72:79], s[0:1], 128
    s_waitcnt lgkmcnt(0)
    s_branch Lcomb
Lworker:
    v_mov_b32 v1, v0
    s_load_dwordx16 s[40:55], s[0:1], 0
    s_load_dwordx16 s[56:71], s[0:1], 64
    s_load_dwordx8 s[72:79], s[0:1], 128
    s_waitcnt lgkmcnt(0)
    s_sub_u32 s3, s12, 4
    s_sub_u32 s15, s12, 4
    s_lshl_b32 s15, s15, 5
    s_add_u32 s15, s15, s13
    s_cmp_ge_u32 s15, 128
    s_cbranch_scc1 fused_kernel_exit
    s_cmp_ge_u32 s13, 32
    s_cbranch_scc1 fused_kernel_exit
    s_mov_b32 s81, 0
    s_mov_b32 s82, 0
    s_mov_b32 s83, 0
    v_lshrrev_b32 v9, 3, v1
    s_lshl_b32 s21, s14, 4
    v_add_u32 v9, s21, v9
    v_lshlrev_b32 v9, 13, v9
    v_bfe_u32 v10, v1, 2, 1
    v_bfe_u32 v11, v1, 4, 1
    v_xor_b32 v10, v10, v11
    v_lshl_add_u32 v9, v10, 6, v9
    v_and_b32 v10, 3, v1
    v_lshl_add_u32 v2, v10, 4, v9
    s_lshl_b32 s26, s14, 11
    v_lshrrev_b32 v9, 5, v1
    v_lshlrev_b32 v9, 3, v9
    v_bfe_u32 v10, v1, 2, 2
    v_add_u32 v9, v9, v10
    v_lshlrev_b32 v9, 7, v9
    v_lshl_add_u32 v9, v11, 5, v9
    v_and_b32 v11, 3, v1
    v_lshl_add_u32 v9, v11, 3, v9
    v_lshrrev_b32 v10, 1, v10
    v_lshl_add_u32 v3, v10, 6, v9
    v_xor_b32 v10, 1, v10
    v_lshl_add_u32 v4, v10, 6, v9
    v_add_u32 v5, 40960, v3
    v_add_u32 v6, 40960, v4
    s_lshl_b32 s21, s14, 13
    s_add_u32 s21, s21, 81920
    v_and_b32 v9, 31, v1
    v_lshrrev_b32 v10, 5, v1
    v_and_b32 v18, 7, v1
    v_xor_b32 v10, v10, v18
    v_lshlrev_b32 v9, 7, v9
    v_add_u32 v9, s21, v9
    v_xor_b32 v14, 0, v10
    v_lshl_add_u32 v14, v14, 4, v9
    v_xor_b32 v15, 2, v10
    v_lshl_add_u32 v15, v15, 4, v9
    v_xor_b32 v16, 4, v10
    v_lshl_add_u32 v16, v16, 4, v9
    v_xor_b32 v17, 6, v10
    v_lshl_add_u32 v17, v17, 4, v9
    v_lshrrev_b32 v9, 3, v1
    v_xor_b32 v10, v18, v9
    v_lshlrev_b32 v9, 7, v9
    v_lshl_add_u32 v9, v10, 4, v9
    v_add_u32 v18, s21, v9
    v_lshrrev_b32 v9, 3, v1
    s_mov_b32 s21, 8320
    v_mul_lo_u32 v9, v9, s21
    v_and_b32 v7, 7, v1
    v_lshl_add_u32 v7, v7, 4, v9
    v_lshrrev_b32 v9, 3, v1
    s_mov_b32 s21, 4224
    v_mul_lo_u32 v9, v9, s21
    v_and_b32 v8, 7, v1
    v_lshl_add_u32 v8, v8, 4, v9
    s_mov_b32 s8, s40
    s_and_b32 s9, s41, 0xffff
    s_mov_b32 s10, 2621440
    s_mov_b32 s11, 0x00020000
    s_mov_b32 s18, 5242880
    s_mov_b32 s19, 0x00020000
    s_mov_b32 s91, 0
    s_mov_b32 s85, 0
    s_mov_b32 s87, s15
    s_mov_b32 s86, 64
    s_cmp_ge_u32 s15, 64
    s_cselect_b32 s88, 192, 64
    s_lshl_b32 s82, s15, 1
    s_mov_b32 s83, 2
Lphase:
    s_barrier
    s_lshr_b32 s92, s87, 6
    s_cmp_eq_u32 s92, 0
    s_cselect_b32 s16, s46, s48
    s_cselect_b32 s17, s47, s49
    s_cmp_eq_u32 s92, 2
    s_cselect_b32 s16, s44, s16
    s_cselect_b32 s17, s45, s17
    s_and_b32 s17, s17, 0xffff
    s_and_b32 s92, s87, 63
    s_lshl_b32 s20, s92, 7
    s_add_u32 m0, s26, 0
    s_add_u32 s21, s20, 0
    buffer_load_dwordx4 v2, s[16:19], s21 offen lds
    s_add_u32 m0, s26, 1024
    s_add_u32 s21, s20, 65536
    buffer_load_dwordx4 v2, s[16:19], s21 offen lds
    s_add_u32 s20, s20, 524288
    s_add_u32 m0, s26, 8192
    s_add_u32 s21, s20, 0
    buffer_load_dwordx4 v2, s[16:19], s21 offen lds
    s_add_u32 m0, s26, 9216
    s_add_u32 s21, s20, 65536
    buffer_load_dwordx4 v2, s[16:19], s21 offen lds
    s_add_u32 s20, s20, 524288
    s_add_u32 m0, s26, 16384
    s_add_u32 s21, s20, 0
    buffer_load_dwordx4 v2, s[16:19], s21 offen lds
    s_add_u32 m0, s26, 17408
    s_add_u32 s21, s20, 65536
    buffer_load_dwordx4 v2, s[16:19], s21 offen lds
    s_add_u32 s20, s20, 524288
    s_add_u32 m0, s26, 24576
    s_add_u32 s21, s20, 0
    buffer_load_dwordx4 v2, s[16:19], s21 offen lds
    s_add_u32 m0, s26, 25600
    s_add_u32 s21, s20, 65536
    buffer_load_dwordx4 v2, s[16:19], s21 offen lds
    s_add_u32 s20, s20, 524288
    s_add_u32 m0, s26, 32768
    s_add_u32 s21, s20, 0
    buffer_load_dwordx4 v2, s[16:19], s21 offen lds
    s_add_u32 m0, s26, 33792
    s_add_u32 s21, s20, 65536
    buffer_load_dwordx4 v2, s[16:19], s21 offen lds
    s_add_u32 s20, s20, 524288
    s_add_u32 m0, s26, 40960
    s_add_u32 s21, s20, 0
    buffer_load_dwordx4 v2, s[16:19], s21 offen lds
    s_add_u32 m0, s26, 41984
    s_add_u32 s21, s20, 65536
    buffer_load_dwordx4 v2, s[16:19], s21 offen lds
    s_add_u32 s20, s20, 524288
    s_add_u32 m0, s26, 49152
    s_add_u32 s21, s20, 0
    buffer_load_dwordx4 v2, s[16:19], s21 offen lds
    s_add_u32 m0, s26, 50176
    s_add_u32 s21, s20, 65536
    buffer_load_dwordx4 v2, s[16:19], s21 offen lds
    s_add_u32 s20, s20, 524288
    s_add_u32 m0, s26, 57344
    s_add_u32 s21, s20, 0
    buffer_load_dwordx4 v2, s[16:19], s21 offen lds
    s_add_u32 m0, s26, 58368
    s_add_u32 s21, s20, 65536
    buffer_load_dwordx4 v2, s[16:19], s21 offen lds
    s_add_u32 s20, s20, 524288
    v_lshrrev_b32 v9, 3, v1
    v_mul_u32_u24 v9, 1280, v9
    v_and_b32 v10, 7, v1
    v_lshrrev_b32 v11, 4, v1
    v_xor_b32 v10, v10, v11
    v_lshl_add_u32 v44, v10, 4, v9
    v_xor_b32 v10, 4, v10
    v_lshl_add_u32 v45, v10, 4, v9
    s_lshl_b32 s23, s14, 14
    s_add_u32 s23, s23, 81920
    v_and_b32 v9, 31, v1
    v_bfe_u32 v10, v1, 1, 3
    v_lshrrev_b32 v11, 5, v1
    v_xor_b32 v10, v10, v11
    v_lshlrev_b32 v9, 7, v9
    v_add_u32 v9, s23, v9
    v_xor_b32 v11, 0, v10
    v_lshl_add_u32 v46, v11, 4, v9
    v_xor_b32 v11, 2, v10
    v_lshl_add_u32 v47, v11, 4, v9
    v_xor_b32 v11, 4, v10
    v_lshl_add_u32 v48, v11, 4, v9
    v_xor_b32 v11, 6, v10
    v_lshl_add_u32 v49, v11, 4, v9
    s_lshl_b32 s22, s85, 2
    s_add_u32 s22, s22, s14
    s_mul_i32 s22, s22, 81920
    s_add_u32 m0, s23, 0
    s_add_u32 s21, s22, 0
    buffer_load_dwordx4 v44, s[8:11], s21 offen lds
    s_add_u32 m0, s23, 1024
    s_add_u32 s21, s22, 10240
    buffer_load_dwordx4 v45, s[8:11], s21 offen lds
    s_add_u32 m0, s23, 2048
    s_add_u32 s21, s22, 20480
    buffer_load_dwordx4 v44, s[8:11], s21 offen lds
    s_add_u32 m0, s23, 3072
    s_add_u32 s21, s22, 30720
    buffer_load_dwordx4 v45, s[8:11], s21 offen lds
    s_add_u32 m0, s23, 4096
    s_add_u32 s21, s22, 40960
    buffer_load_dwordx4 v44, s[8:11], s21 offen lds
    s_add_u32 m0, s23, 5120
    s_add_u32 s21, s22, 51200
    buffer_load_dwordx4 v45, s[8:11], s21 offen lds
    s_add_u32 m0, s23, 6144
    s_add_u32 s21, s22, 61440
    buffer_load_dwordx4 v44, s[8:11], s21 offen lds
    s_add_u32 m0, s23, 7168
    s_add_u32 s21, s22, 71680
    buffer_load_dwordx4 v45, s[8:11], s21 offen lds
    s_add_u32 m0, s23, 8192
    s_add_u32 s21, s22, 128
    buffer_load_dwordx4 v44, s[8:11], s21 offen lds
    s_add_u32 m0, s23, 9216
    s_add_u32 s21, s22, 10368
    buffer_load_dwordx4 v45, s[8:11], s21 offen lds
    s_add_u32 m0, s23, 10240
    s_add_u32 s21, s22, 20608
    buffer_load_dwordx4 v44, s[8:11], s21 offen lds
    s_add_u32 m0, s23, 11264
    s_add_u32 s21, s22, 30848
    buffer_load_dwordx4 v45, s[8:11], s21 offen lds
    s_add_u32 m0, s23, 12288
    s_add_u32 s21, s22, 41088
    buffer_load_dwordx4 v44, s[8:11], s21 offen lds
    s_add_u32 m0, s23, 13312
    s_add_u32 s21, s22, 51328
    buffer_load_dwordx4 v45, s[8:11], s21 offen lds
    s_add_u32 m0, s23, 14336
    s_add_u32 s21, s22, 61568
    buffer_load_dwordx4 v44, s[8:11], s21 offen lds
    s_add_u32 m0, s23, 15360
    s_add_u32 s21, s22, 71808
    buffer_load_dwordx4 v45, s[8:11], s21 offen lds
    s_mov_b32 s27, 1
    s_mov_b32 s89, 999
    s_branch Lunit
Lpois:
    v_lshlrev_b32 v9, 4, v250
    v_mov_b32 v76, -1
    v_mov_b32 v77, -1
    v_mov_b32 v78, -1
    v_mov_b32 v79, -1
    s_cmp_eq_u32 s91, 0
    s_cbranch_scc1 Lpo_82
    v_mov_b32 v10, 36
Lpw_85:
    buffer_load_dword v11, v10, s[96:99], 0 offen sc1
    s_waitcnt vmcnt(0)
    v_readfirstlane_b32 s84, v11
    s_add_u32 s81, s81, 1
    s_cmp_gt_u32 s81, 0x200000
    s_cbranch_scc1 fused_kernel_exit
    s_lshr_b32 s92, s84, 16
    s_cmp_lg_u32 s92, 0xffff
    s_cbranch_scc1 Lpw_85
Lpo_82:
    s_cmp_eq_u32 s83, 0
    s_cbranch_scc1 Lpe_83
    s_cmp_eq_u32 s91, 0
    s_cbranch_scc1 Lp0_84
    s_min_u32 s93, s82, 255
    s_lshr_b32 s92, s93, 7
    s_lshl_b32 s94, s85, 1
    s_add_u32 s92, s92, s94
    s_lshr_b32 s92, s84, s92
    s_and_b32 s92, s92, 1
    s_lshl_b32 s93, s93, 1
    s_add_u32 s93, s93, s92
    s_branch Lp1_86
Lp0_84:
    s_lshl_b32 s93, s82, 1
Lp1_86:
    s_lshl_b32 s93, s93, 13
    s_lshl_b32 s94, s85, 22
    s_add_u32 s93, s93, s94
    s_add_u32 s93, s93, 167772160
    s_add_u32 s92, s93, 4096
    buffer_store_dwordx4 v[76:79], v9, s[4:7], s93 offen sc1
    buffer_store_dwordx4 v[76:79], v9, s[4:7], s92 offen sc1
    s_add_u32 s82, s82, 1
    s_sub_u32 s83, s83, 1
    s_branch Lpo_82
Lpe_83:
    s_cmp_lg_u32 s91, 0
    s_cbranch_scc1 Lunitd
    s_waitcnt vmcnt(0)
    s_barrier
    s_cmp_lg_u32 s14, 0
    s_cbranch_scc1 Lsu_87
    s_cmp_ge_u32 s87, 192
    s_cbranch_scc1 Lsu_87
    s_cmp_ge_u32 s87, 128
    s_cselect_b32 s92, 0x10000, 1
    s_lshl_b32 s93, s85, 2
    s_add_u32 s93, s93, 128
    s_mov_b64 exec, 1
    v_mov_b32 v9, s92
    v_mov_b32 v10, s93
    buffer_atomic_add v9, v10, s[96:99], 0 offen sc1
    s_mov_b64 exec, -1
Lsu_87:
    s_mov_b32 s89, 999
    s_branch Lunitd2
Lunit:
    s_and_b32 s92, s87, 63
    s_lshl_b32 s92, s92, 6
    s_lshl_b32 s93, s85, 2
    s_add_u32 s93, s93, s14
    s_lshl_b32 s93, s93, 6
    s_lshr_b32 s94, s87, 6
    s_cmp_eq_u32 s94, 1
    s_cbranch_scc1 Lunitv
    s_cmp_eq_u32 s94, 0
    s_mov_b32 s90, 0
    s_cselect_b32 s90, s90, 37748736
    s_mul_i32 s93, s93, 8320
    s_lshl_b32 s92, s92, 1
    s_add_u32 s90, s90, s93
    s_add_u32 s90, s90, s92
    s_cmp_lg_u32 s27, 0
    s_cbranch_scc1 Lunitkf
    ds_read_b64_tr_b16 v[20:21], v3 offset:0
    ds_read_b64_tr_b16 v[22:23], v3 offset:512
    ds_read_b64_tr_b16 v[24:25], v4 offset:0
    ds_read_b64_tr_b16 v[26:27], v4 offset:512
    ds_read_b64_tr_b16 v[28:29], v3 offset:2048
    ds_read_b64_tr_b16 v[30:31], v3 offset:2560
    ds_read_b64_tr_b16 v[32:33], v4 offset:2048
    ds_read_b64_tr_b16 v[34:35], v4 offset:2560
    ds_read_b64_tr_b16 v[36:37], v3 offset:4096
    ds_read_b64_tr_b16 v[38:39], v3 offset:4608
    ds_read_b64_tr_b16 v[40:41], v4 offset:4096
    ds_read_b64_tr_b16 v[42:43], v4 offset:4608
    s_waitcnt lgkmcnt(8)
    v_mfma_f32_32x32x16_bf16 v[76:91], v[20:23], a[0:3], 0
    s_add_u32 m0, s26, 65536
    s_add_u32 s21, s20, 0
    buffer_load_dwordx4 v2, s[16:19], s21 offen lds
    s_add_u32 m0, s26, 66560
    s_add_u32 s21, s20, 65536
    buffer_load_dwordx4 v2, s[16:19], s21 offen lds
    s_add_u32 s20, s20, 524288
    v_mfma_f32_32x32x16_bf16 v[92:107], v[24:27], a[0:3], 0
    v_mfma_f32_32x32x16_bf16 v[108:123], v[20:23], a[4:7], 0
    v_mfma_f32_32x32x16_bf16 v[124:139], v[24:27], a[4:7], 0
    ds_read_b64_tr_b16 v[20:21], v3 offset:6144
    ds_read_b64_tr_b16 v[22:23], v3 offset:6656
    ds_read_b64_tr_b16 v[24:25], v4 offset:6144
    ds_read_b64_tr_b16 v[26:27], v4 offset:6656
    s_waitcnt lgkmcnt(8)
    v_mfma_f32_32x32x16_bf16 v[76:91], v[28:31], a[8:11], v[76:91]
    v_mfma_f32_32x32x16_bf16 v[92:107], v[32:35], a[8:11], v[92:107]
    v_mfma_f32_32x32x16_bf16 v[108:123], v[28:31], a[12:15], v[108:123]
    v_mfma_f32_32x32x16_bf16 v[124:139], v[32:35], a[12:15], v[124:139]
    s_waitcnt vmcnt(22)
    s_barrier
    ds_read_b64_tr_b16 v[28:29], v3 offset:8192
    ds_read_b64_tr_b16 v[30:31], v3 offset:8704
    ds_read_b64_tr_b16 v[32:33], v4 offset:8192
    ds_read_b64_tr_b16 v[34:35], v4 offset:8704
    s_waitcnt lgkmcnt(8)
    v_mfma_f32_32x32x16_bf16 v[76:91], v[36:39], a[16:19], v[76:91]
    v_mfma_f32_32x32x16_bf16 v[92:107], v[40:43], a[16:19], v[92:107]
    v_mfma_f32_32x32x16_bf16 v[108:123], v[36:39], a[20:23], v[108:123]
    v_mfma_f32_32x32x16_bf16 v[124:139], v[40:43], a[20:23], v[124:139]
    ds_read_b64_tr_b16 v[36:37], v3 offset:10240
    ds_read_b64_tr_b16 v[38:39], v3 offset:10752
    ds_read_b64_tr_b16 v[40:41], v4 offset:10240
    ds_read_b64_tr_b16 v[42:43], v4 offset:10752
    s_waitcnt lgkmcnt(8)
    v_mfma_f32_32x32x16_bf16 v[76:91], v[20:23], a[24:27], v[76:91]
    v_mfma_f32_32x32x16_bf16 v[92:107], v[24:27], a[24:27], v[92:107]
    v_mfma_f32_32x32x16_bf16 v[108:123], v[20:23], a[28:31], v[108:123]
    v_mfma_f32_32x32x16_bf16 v[124:139], v[24:27], a[28:31], v[124:139]
    ds_read_b64_tr_b16 v[20:21], v3 offset:12288
    ds_read_b64_tr_b16 v[22:23], v3 offset:12800
    ds_read_b64_tr_b16 v[24:25], v4 offset:12288
    ds_read_b64_tr_b16 v[26:27], v4 offset:12800
    s_waitcnt lgkmcnt(8)
    v_mfma_f32_32x32x16_bf16 v[76:91], v[28:31], a[32:35], v[76:91]
    s_add_u32 m0, s26, 73728
    s_add_u32 s21, s20, 0
    buffer_load_dwordx4 v2, s[16:19], s21 offen lds
    s_add_u32 m0, s26, 74752
    s_add_u32 s21, s20, 65536
    buffer_load_dwordx4 v2, s[16:19], s21 offen lds
    s_add_u32 s20, s20, 524288
    v_mfma_f32_32x32x16_bf16 v[92:107], v[32:35], a[32:35], v[92:107]
    v_mfma_f32_32x32x16_bf16 v[108:123], v[28:31], a[36:39], v[108:123]
    v_mfma_f32_32x32x16_bf16 v[124:139], v[32:35], a[36:39], v[124:139]
    ds_read_b64_tr_b16 v[28:29], v3 offset:14336
    ds_read_b64_tr_b16 v[30:31], v3 offset:14848
    ds_read_b64_tr_b16 v[32:33], v4 offset:14336
    ds_read_b64_tr_b16 v[34:35], v4 offset:14848
    s_waitcnt lgkmcnt(8)
    v_mfma_f32_32x32x16_bf16 v[76:91], v[36:39], a[40:43], v[76:91]
    v_mfma_f32_32x32x16_bf16 v[92:107], v[40:43], a[40:43], v[92:107]
    v_mfma_f32_32x32x16_bf16 v[108:123], v[36:39], a[44:47], v[108:123]
    v_mfma_f32_32x32x16_bf16 v[124:139], v[40:43], a[44:47], v[124:139]
    s_waitcnt vmcnt(22)
    s_barrier
    ds_read_b64_tr_b16 v[36:37], v3 offset:16384
    ds_read_b64_tr_b16 v[38:39], v3 offset:16896
    ds_read_b64_tr_b16 v[40:41], v4 offset:16384
    ds_read_b64_tr_b16 v[42:43], v4 offset:16896
    s_waitcnt lgkmcnt(8)
    v_mfma_f32_32x32x16_bf16 v[76:91], v[20:23], a[48:51], v[76:91]
    v_mfma_f32_32x32x16_bf16 v[92:107], v[24:27], a[48:51], v[92:107]
    v_mfma_f32_32x32x16_bf16 v[108:123], v[20:23], a[52:55], v[108:123]
    v_mfma_f32_32x32x16_bf16 v[124:139], v[24:27], a[52:55], v[124:139]
    ds_read_b64_tr_b16 v[20:21], v3 offset:18432
    ds_read_b64_tr_b16 v[22:23], v3 offset:18944
    ds_read_b64_tr_b16 v[24:25], v4 offset:18432
    ds_read_b64_tr_b16 v[26:27], v4 offset:18944
    s_waitcnt lgkmcnt(8)
    v_mfma_f32_32x32x16_bf16 v[76:91], v[28:31], a[56:59], v[76:91]
    v_mfma_f32_32x32x16_bf16 v[92:107], v[32:35], a[56:59], v[92:107]
    v_mfma_f32_32x32x16_bf16 v[108:123], v[28:31], a[60:63], v[108:123]
    v_mfma_f32_32x32x16_bf16 v[124:139], v[32:35], a[60:63], v[124:139]
    ds_read_b64_tr_b16 v[28:29], v3 offset:20480
    ds_read_b64_tr_b16 v[30:31], v3 offset:20992
    ds_read_b64_tr_b16 v[32:33], v4 offset:20480
    ds_read_b64_tr_b16 v[34:35], v4 offset:20992
    s_waitcnt lgkmcnt(8)
    v_mfma_f32_32x32x16_bf16 v[76:91], v[36:39], a[64:67], v[76:91]
    s_add_u32 s93, s87, s86
    s_cmp_lt_u32 s93, s88
    s_cselect_b32 s93, s93, s87
    s_lshr_b32 s92, s93, 6
    s_cmp_eq_u32 s92, 0
    s_cselect_b32 s16, s46, s48
    s_cselect_b32 s17, s47, s49
    s_cmp_eq_u32 s92, 2
    s_cselect_b32 s16, s44, s16
    s_cselect_b32 s17, s45, s17
    s_and_b32 s17, s17, 0xffff
    s_and_b32 s92, s93, 63
    s_lshl_b32 s20, s92, 7
    s_add_u32 m0, s26, 0
    s_add_u32 s21, s20, 0
    buffer_load_dwordx4 v2, s[16:19], s21 offen lds
    s_add_u32 m0, s26, 1024
    s_add_u32 s21, s20, 65536
    buffer_load_dwordx4 v2, s[16:19], s21 offen lds
    s_add_u32 s20, s20, 524288
    v_mfma_f32_32x32x16_bf16 v[92:107], v[40:43], a[64:67], v[92:107]
    v_mfma_f32_32x32x16_bf16 v[108:123], v[36:39], a[68:71], v[108:123]
    v_mfma_f32_32x32x16_bf16 v[124:139], v[40:43], a[68:71], v[124:139]
    ds_read_b64_tr_b16 v[36:37], v3 offset:22528
    ds_read_b64_tr_b16 v[38:39], v3 offset:23040
    ds_read_b64_tr_b16 v[40:41], v4 offset:22528
    ds_read_b64_tr_b16 v[42:43], v4 offset:23040
    s_waitcnt lgkmcnt(8)
    v_mfma_f32_32x32x16_bf16 v[76:91], v[20:23], a[72:75], v[76:91]
    v_mfma_f32_32x32x16_bf16 v[92:107], v[24:27], a[72:75], v[92:107]
    v_mfma_f32_32x32x16_bf16 v[108:123], v[20:23], a[76:79], v[108:123]
    v_mfma_f32_32x32x16_bf16 v[124:139], v[24:27], a[76:79], v[124:139]
    s_waitcnt vmcnt(6)
    s_barrier
    s_cmp_lg_u32 s14, 0
    s_cbranch_scc1 Lsu_88
    s_cmp_ge_u32 s89, 192
    s_cbranch_scc1 Lsu_88
    s_cmp_ge_u32 s89, 128
    s_cselect_b32 s92, 0x10000, 1
    s_lshl_b32 s93, s85, 2
    s_add_u32 s93, s93, 128
    s_mov_b64 exec, 1
    v_mov_b32 v9, s92
    v_mov_b32 v10, s93
    buffer_atomic_add v9, v10, s[96:99], 0 offen sc1
    s_mov_b64 exec, -1
Lsu_88:
    ds_read_b64_tr_b16 v[20:21], v3 offset:24576
    ds_read_b64_tr_b16 v[22:23], v3 offset:25088
    ds_read_b64_tr_b16 v[24:25], v4 offset:24576
    ds_read_b64_tr_b16 v[26:27], v4 offset:25088
    s_waitcnt lgkmcnt(8)
    v_mfma_f32_32x32x16_bf16 v[76:91], v[28:31], a[80:83], v[76:91]
    v_mfma_f32_32x32x16_bf16 v[92:107], v[32:35], a[80:83], v[92:107]
    v_mfma_f32_32x32x16_bf16 v[108:123], v[28:31], a[84:87], v[108:123]
    v_mfma_f32_32x32x16_bf16 v[124:139], v[32:35], a[84:87], v[124:139]
    ds_read_b64_tr_b16 v[28:29], v3 offset:26624
    ds_read_b64_tr_b16 v[30:31], v3 offset:27136
    ds_read_b64_tr_b16 v[32:33], v4 offset:26624
    ds_read_b64_tr_b16 v[34:35], v4 offset:27136
    s_waitcnt lgkmcnt(8)
    v_mfma_f32_32x32x16_bf16 v[76:91], v[36:39], a[88:91], v[76:91]
    v_mfma_f32_32x32x16_bf16 v[92:107], v[40:43], a[88:91], v[92:107]
    v_mfma_f32_32x32x16_bf16 v[108:123], v[36:39], a[92:95], v[108:123]
    v_mfma_f32_32x32x16_bf16 v[124:139], v[40:43], a[92:95], v[124:139]
    ds_read_b64_tr_b16 v[36:37], v3 offset:28672
    ds_read_b64_tr_b16 v[38:39], v3 offset:29184
    ds_read_b64_tr_b16 v[40:41], v4 offset:28672
    ds_read_b64_tr_b16 v[42:43], v4 offset:29184
    s_waitcnt lgkmcnt(8)
    v_mfma_f32_32x32x16_bf16 v[76:91], v[20:23], a[96:99], v[76:91]
    s_add_u32 m0, s26, 8192
    s_add_u32 s21, s20, 0
    buffer_load_dwordx4 v2, s[16:19], s21 offen lds
    s_add_u32 m0, s26, 9216
    s_add_u32 s21, s20, 65536
    buffer_load_dwordx4 v2, s[16:19], s21 offen lds
    s_add_u32 s20, s20, 524288
    v_mfma_f32_32x32x16_bf16 v[92:107], v[24:27], a[96:99], v[92:107]
    v_mfma_f32_32x32x16_bf16 v[108:123], v[20:23], a[100:103], v[108:123]
    v_mfma_f32_32x32x16_bf16 v[124:139], v[24:27], a[100:103], v[124:139]
    ds_read_b64_tr_b16 v[20:21], v3 offset:30720
    ds_read_b64_tr_b16 v[22:23], v3 offset:31232
    ds_read_b64_tr_b16 v[24:25], v4 offset:30720
    ds_read_b64_tr_b16 v[26:27], v4 offset:31232
    s_waitcnt lgkmcnt(8)
    v_mfma_f32_32x32x16_bf16 v[76:91], v[28:31], a[104:107], v[76:91]
    v_mfma_f32_32x32x16_bf16 v[92:107], v[32:35], a[104:107], v[92:107]
    v_mfma_f32_32x32x16_bf16 v[108:123], v[28:31], a[108:111], v[108:123]
    v_mfma_f32_32x32x16_bf16 v[124:139], v[32:35], a[108:111], v[124:139]
    s_waitcnt vmcnt(14)
    s_barrier
    ds_read_b64_tr_b16 v[28:29], v3 offset:32768
    ds_read_b64_tr_b16 v[30:31], v3 offset:33280
    ds_read_b64_tr_b16 v[32:33], v4 offset:32768
    ds_read_b64_tr_b16 v[34:35], v4 offset:33280
    s_waitcnt lgkmcnt(8)
    v_mfma_f32_32x32x16_bf16 v[76:91], v[36:39], a[112:115], v[76:91]
    v_mfma_f32_32x32x16_bf16 v[92:107], v[40:43], a[112:115], v[92:107]
    v_mfma_f32_32x32x16_bf16 v[108:123], v[36:39], a[116:119], v[108:123]
    v_mfma_f32_32x32x16_bf16 v[124:139], v[40:43], a[116:119], v[124:139]
    ds_read_b64_tr_b16 v[36:37], v3 offset:34816
    ds_read_b64_tr_b16 v[38:39], v3 offset:35328
    ds_read_b64_tr_b16 v[40:41], v4 offset:34816
    ds_read_b64_tr_b16 v[42:43], v4 offset:35328
    s_waitcnt lgkmcnt(8)
    v_mfma_f32_32x32x16_bf16 v[76:91], v[20:23], a[120:123], v[76:91]
    v_mfma_f32_32x32x16_bf16 v[92:107], v[24:27], a[120:123], v[92:107]
    v_mfma_f32_32x32x16_bf16 v[108:123], v[20:23], a[124:127], v[108:123]
    v_mfma_f32_32x32x16_bf16 v[124:139], v[24:27], a[124:127], v[124:139]
    ds_read_b64_tr_b16 v[20:21], v3 offset:36864
    ds_read_b64_tr_b16 v[22:23], v3 offset:37376
    ds_read_b64_tr_b16 v[24:25], v4 offset:36864
    ds_read_b64_tr_b16 v[26:27], v4 offset:37376
    s_waitcnt lgkmcnt(8)
    v_mfma_f32_32x32x16_bf16 v[76:91], v[28:31], a[128:131], v[76:91]
    s_add_u32 m0, s26, 16384
    s_add_u32 s21, s20, 0
    buffer_load_dwordx4 v2, s[16:19], s21 offen lds
    s_add_u32 m0, s26, 17408
    s_add_u32 s21, s20, 65536
    buffer_load_dwordx4 v2, s[16:19], s21 offen lds
    s_add_u32 s20, s20, 524288
    v_mfma_f32_32x32x16_bf16 v[92:107], v[32:35], a[128:131], v[92:107]
    v_mfma_f32_32x32x16_bf16 v[108:123], v[28:31], a[132:135], v[108:123]
    v_mfma_f32_32x32x16_bf16 v[124:139], v[32:35], a[132:135], v[124:139]
    ds_read_b64_tr_b16 v[28:29], v3 offset:38912
    ds_read_b64_tr_b16 v[30:31], v3 offset:39424
    ds_read_b64_tr_b16 v[32:33], v4 offset:38912
    ds_read_b64_tr_b16 v[34:35], v4 offset:39424
    s_waitcnt lgkmcnt(8)
    v_mfma_f32_32x32x16_bf16 v[76:91], v[36:39], a[136:139], v[76:91]
    v_mfma_f32_32x32x16_bf16 v[92:107], v[40:43], a[136:139], v[92:107]
    v_mfma_f32_32x32x16_bf16 v[108:123], v[36:39], a[140:143], v[108:123]
    v_mfma_f32_32x32x16_bf16 v[124:139], v[40:43], a[140:143], v[124:139]
    s_waitcnt vmcnt(14)
    s_barrier
    ds_read_b64_tr_b16 v[36:37], v5 offset:0
    ds_read_b64_tr_b16 v[38:39], v5 offset:512
    ds_read_b64_tr_b16 v[40:41], v6 offset:0
    ds_read_b64_tr_b16 v[42:43], v6 offset:512
    s_waitcnt lgkmcnt(8)
    v_mfma_f32_32x32x16_bf16 v[76:91], v[20:23], a[144:147], v[76:91]
    v_mfma_f32_32x32x16_bf16 v[92:107], v[24:27], a[144:147], v[92:107]
    v_mfma_f32_32x32x16_bf16 v[108:123], v[20:23], a[148:151], v[108:123]
    v_mfma_f32_32x32x16_bf16 v[124:139], v[24:27], a[148:151], v[124:139]
    ds_read_b64_tr_b16 v[20:21], v5 offset:2048
    ds_read_b64_tr_b16 v[22:23], v5 offset:2560
    ds_read_b64_tr_b16 v[24:25], v6 offset:2048
    ds_read_b64_tr_b16 v[26:27], v6 offset:2560
    s_waitcnt lgkmcnt(8)
    v_mfma_f32_32x32x16_bf16 v[76:91], v[28:31], a[152:155], v[76:91]
    v_mfma_f32_32x32x16_bf16 v[92:107], v[32:35], a[152:155], v[92:107]
    v_mfma_f32_32x32x16_bf16 v[108:123], v[28:31], a[156:159], v[108:123]
    v_mfma_f32_32x32x16_bf16 v[124:139], v[32:35], a[156:159], v[124:139]
    ds_read_b64_tr_b16 v[28:29], v5 offset:4096
    ds_read_b64_tr_b16 v[30:31], v5 offset:4608
    ds_read_b64_tr_b16 v[32:33], v6 offset:4096
    ds_read_b64_tr_b16 v[34:35], v6 offset:4608
    s_waitcnt lgkmcnt(8)
    v_mfma_f32_32x32x16_bf16 v[76:91], v[36:39], a[160:163], v[76:91]
    s_add_u32 m0, s26, 24576
    s_add_u32 s21, s20, 0
    buffer_load_dwordx4 v2, s[16:19], s21 offen lds
    s_add_u32 m0, s26, 25600
    s_add_u32 s21, s20, 65536
    buffer_load_dwordx4 v2, s[16:19], s21 offen lds
    s_add_u32 s20, s20, 524288
    v_mfma_f32_32x32x16_bf16 v[92:107], v[40:43], a[160:163], v[92:107]
    v_mfma_f32_32x32x16_bf16 v[108:123], v[36:39], a[164:167], v[108:123]
    v_mfma_f32_32x32x16_bf16 v[124:139], v[40:43], a[164:167], v[124:139]
    ds_read_b64_tr_b16 v[36:37], v5 offset:6144
    ds_read_b64_tr_b16 v[38:39], v5 offset:6656
    ds_read_b64_tr_b16 v[40:41], v6 offset:6144
    ds_read_b64_tr_b16 v[42:43], v6 offset:6656
    s_waitcnt lgkmcnt(8)
    v_mfma_f32_32x32x16_bf16 v[76:91], v[20:23], a[168:171], v[76:91]
    v_mfma_f32_32x32x16_bf16 v[92:107], v[24:27], a[168:171], v[92:107]
    v_mfma_f32_32x32x16_bf16 v[108:123], v[20:23], a[172:175], v[108:123]
    v_mfma_f32_32x32x16_bf16 v[124:139], v[24:27], a[172:175], v[124:139]
    s_waitcnt vmcnt(14)
    s_barrier
    ds_read_b64_tr_b16 v[20:21], v5 offset:8192
    ds_read_b64_tr_b16 v[22:23], v5 offset:8704
    ds_read_b64_tr_b16 v[24:25], v6 offset:8192
    ds_read_b64_tr_b16 v[26:27], v6 offset:8704
    s_waitcnt lgkmcnt(8)
    v_mfma_f32_32x32x16_bf16 v[76:91], v[28:31], a[176:179], v[76:91]
    v_mfma_f32_32x32x16_bf16 v[92:107], v[32:35], a[176:179], v[92:107]
    v_mfma_f32_32x32x16_bf16 v[108:123], v[28:31], a[180:183], v[108:123]
    v_mfma_f32_32x32x16_bf16 v[124:139], v[32:35], a[180:183], v[124:139]
    ds_read_b64_tr_b16 v[28:29], v5 offset:10240
    ds_read_b64_tr_b16 v[30:31], v5 offset:10752
    ds_read_b64_tr_b16 v[32:33], v6 offset:10240
    ds_read_b64_tr_b16 v[34:35], v6 offset:10752
    s_waitcnt lgkmcnt(8)
    v_mfma_f32_32x32x16_bf16 v[76:91], v[36:39], a[184:187], v[76:91]
    v_mfma_f32_32x32x16_bf16 v[92:107], v[40:43], a[184:187], v[92:107]
    v_mfma_f32_32x32x16_bf16 v[108:123], v[36:39], a[188:191], v[108:123]
    v_mfma_f32_32x32x16_bf16 v[124:139], v[40:43], a[188:191], v[124:139]
    ds_read_b64_tr_b16 v[36:37], v5 offset:12288
    ds_read_b64_tr_b16 v[38:39], v5 offset:12800
    ds_read_b64_tr_b16 v[40:41], v6 offset:12288
    ds_read_b64_tr_b16 v[42:43], v6 offset:12800
    s_waitcnt lgkmcnt(8)
    v_mfma_f32_32x32x16_bf16 v[76:91], v[20:23], a[192:195], v[76:91]
    s_add_u32 m0, s26, 32768
    s_add_u32 s21, s20, 0
    buffer_load_dwordx4 v2, s[16:19], s21 offen lds
    s_add_u32 m0, s26, 33792
    s_add_u32 s21, s20, 65536
    buffer_load_dwordx4 v2, s[16:19], s21 offen lds
    s_add_u32 s20, s20, 524288
    v_mfma_f32_32x32x16_bf16 v[92:107], v[24:27], a[192:195], v[92:107]
    v_mfma_f32_32x32x16_bf16 v[108:123], v[20:23], a[196:199], v[108:123]
    v_mfma_f32_32x32x16_bf16 v[124:139], v[24:27], a[196:199], v[124:139]
    ds_read_b64_tr_b16 v[20:21], v5 offset:14336
    ds_read_b64_tr_b16 v[22:23], v5 offset:14848
    ds_read_b64_tr_b16 v[24:25], v6 offset:14336
    ds_read_b64_tr_b16 v[26:27], v6 offset:14848
    s_waitcnt lgkmcnt(8)
    v_mfma_f32_32x32x16_bf16 v[76:91], v[28:31], a[200:203], v[76:91]
    v_mfma_f32_32x32x16_bf16 v[92:107], v[32:35], a[200:203], v[92:107]
    v_mfma_f32_32x32x16_bf16 v[108:123], v[28:31], a[204:207], v[108:123]
    v_mfma_f32_32x32x16_bf16 v[124:139], v[32:35], a[204:207], v[124:139]
    s_waitcnt vmcnt(14)
    s_barrier
    ds_read_b64_tr_b16 v[28:29], v5 offset:16384
    ds_read_b64_tr_b16 v[30:31], v5 offset:16896
    ds_read_b64_tr_b16 v[32:33], v6 offset:16384
    ds_read_b64_tr_b16 v[34:35], v6 offset:16896
    s_waitcnt lgkmcnt(8)
    v_mfma_f32_32x32x16_bf16 v[76:91], v[36:39], a[208:211], v[76:91]
    v_mfma_f32_32x32x16_bf16 v[92:107], v[40:43], a[208:211], v[92:107]
    v_mfma_f32_32x32x16_bf16 v[108:123], v[36:39], a[212:215], v[108:123]
    v_mfma_f32_32x32x16_bf16 v[124:139], v[40:43], a[212:215], v[124:139]
    ds_read_b64_tr_b16 v[36:37], v5 offset:18432
    ds_read_b64_tr_b16 v[38:39], v5 offset:18944
    ds_read_b64_tr_b16 v[40:41], v6 offset:18432
    ds_read_b64_tr_b16 v[42:43], v6 offset:18944
    s_waitcnt lgkmcnt(8)
    v_mfma_f32_32x32x16_bf16 v[76:91], v[20:23], a[216:219], v[76:91]
    v_mfma_f32_32x32x16_bf16 v[92:107], v[24:27], a[216:219], v[92:107]
    v_mfma_f32_32x32x16_bf16 v[108:123], v[20:23], a[220:223], v[108:123]
    v_mfma_f32_32x32x16_bf16 v[124:139], v[24:27], a[220:223], v[124:139]
    ds_read_b64_tr_b16 v[20:21], v5 offset:20480
    ds_read_b64_tr_b16 v[22:23], v5 offset:20992
    ds_read_b64_tr_b16 v[24:25], v6 offset:20480
    ds_read_b64_tr_b16 v[26:27], v6 offset:20992
    s_waitcnt lgkmcnt(8)
    v_mfma_f32_32x32x16_bf16 v[76:91], v[28:31], a[224:227], v[76:91]
    s_add_u32 m0, s26, 40960
    s_add_u32 s21, s20, 0
    buffer_load_dwordx4 v2, s[16:19], s21 offen lds
    s_add_u32 m0, s26, 41984
    s_add_u32 s21, s20, 65536
    buffer_load_dwordx4 v2, s[16:19], s21 offen lds
    s_add_u32 s20, s20, 524288
    v_mfma_f32_32x32x16_bf16 v[92:107], v[32:35], a[224:227], v[92:107]
    v_mfma_f32_32x32x16_bf16 v[108:123], v[28:31], a[228:231], v[108:123]
    v_mfma_f32_32x32x16_bf16 v[124:139], v[32:35], a[228:231], v[124:139]
    ds_read_b64_tr_b16 v[28:29], v5 offset:22528
    ds_read_b64_tr_b16 v[30:31], v5 offset:23040
    ds_read_b64_tr_b16 v[32:33], v6 offset:22528
    ds_read_b64_tr_b16 v[34:35], v6 offset:23040
    s_waitcnt lgkmcnt(8)
    v_mfma_f32_32x32x16_bf16 v[76:91], v[36:39], a[232:235], v[76:91]
    v_mfma_f32_32x32x16_bf16 v[92:107], v[40:43], a[232:235], v[92:107]
    v_mfma_f32_32x32x16_bf16 v[108:123], v[36:39], a[236:239], v[108:123]
    v_mfma_f32_32x32x16_bf16 v[124:139], v[40:43], a[236:239], v[124:139]
    s_waitcnt vmcnt(14)
    s_barrier
    ds_read_b64_tr_b16 v[36:37], v5 offset:24576
    ds_read_b64_tr_b16 v[38:39], v5 offset:25088
    ds_read_b64_tr_b16 v[40:41], v6 offset:24576
    ds_read_b64_tr_b16 v[42:43], v6 offset:25088
    s_waitcnt lgkmcnt(8)
    v_mfma_f32_32x32x16_bf16 v[76:91], v[20:23], a[240:243], v[76:91]
    v_mfma_f32_32x32x16_bf16 v[92:107], v[24:27], a[240:243], v[92:107]
    v_mfma_f32_32x32x16_bf16 v[108:123], v[20:23], a[244:247], v[108:123]
    v_mfma_f32_32x32x16_bf16 v[124:139], v[24:27], a[244:247], v[124:139]
    ds_read_b64_tr_b16 v[20:21], v5 offset:26624
    ds_read_b64_tr_b16 v[22:23], v5 offset:27136
    ds_read_b64_tr_b16 v[24:25], v6 offset:26624
    ds_read_b64_tr_b16 v[26:27], v6 offset:27136
    s_waitcnt lgkmcnt(8)
    v_mfma_f32_32x32x16_bf16 v[76:91], v[28:31], a[248:251], v[76:91]
    v_mfma_f32_32x32x16_bf16 v[92:107], v[32:35], a[248:251], v[92:107]
    v_mfma_f32_32x32x16_bf16 v[108:123], v[28:31], a[252:255], v[108:123]
    v_mfma_f32_32x32x16_bf16 v[124:139], v[32:35], a[252:255], v[124:139]
    ds_read_b64_tr_b16 v[28:29], v5 offset:28672
    ds_read_b64_tr_b16 v[30:31], v5 offset:29184
    ds_read_b64_tr_b16 v[32:33], v6 offset:28672
    ds_read_b64_tr_b16 v[34:35], v6 offset:29184
    s_waitcnt lgkmcnt(8)
    v_mfma_f32_32x32x16_bf16 v[76:91], v[36:39], v[140:143], v[76:91]
    s_add_u32 m0, s26, 49152
    s_add_u32 s21, s20, 0
    buffer_load_dwordx4 v2, s[16:19], s21 offen lds
    s_add_u32 m0, s26, 50176
    s_add_u32 s21, s20, 65536
    buffer_load_dwordx4 v2, s[16:19], s21 offen lds
    s_add_u32 s20, s20, 524288
    v_mfma_f32_32x32x16_bf16 v[92:107], v[40:43], v[140:143], v[92:107]
    v_mfma_f32_32x32x16_bf16 v[108:123], v[36:39], v[144:147], v[108:123]
    v_mfma_f32_32x32x16_bf16 v[124:139], v[40:43], v[144:147], v[124:139]
    ds_read_b64_tr_b16 v[36:37], v5 offset:30720
    ds_read_b64_tr_b16 v[38:39], v5 offset:31232
    ds_read_b64_tr_b16 v[40:41], v6 offset:30720
    ds_read_b64_tr_b16 v[42:43], v6 offset:31232
    s_waitcnt lgkmcnt(8)
    v_mfma_f32_32x32x16_bf16 v[76:91], v[20:23], v[148:151], v[76:91]
    v_mfma_f32_32x32x16_bf16 v[92:107], v[24:27], v[148:151], v[92:107]
    v_mfma_f32_32x32x16_bf16 v[108:123], v[20:23], v[152:155], v[108:123]
    v_mfma_f32_32x32x16_bf16 v[124:139], v[24:27], v[152:155], v[124:139]
    s_waitcnt vmcnt(14)
    s_barrier
    ds_read_b64_tr_b16 v[20:21], v5 offset:32768
    ds_read_b64_tr_b16 v[22:23], v5 offset:33280
    ds_read_b64_tr_b16 v[24:25], v6 offset:32768
    ds_read_b64_tr_b16 v[26:27], v6 offset:33280
    s_waitcnt lgkmcnt(8)
    v_mfma_f32_32x32x16_bf16 v[76:91], v[28:31], v[156:159], v[76:91]
    v_mfma_f32_32x32x16_bf16 v[92:107], v[32:35], v[156:159], v[92:107]
    v_mfma_f32_32x32x16_bf16 v[108:123], v[28:31], v[160:163], v[108:123]
    v_mfma_f32_32x32x16_bf16 v[124:139], v[32:35], v[160:163], v[124:139]
    ds_read_b64_tr_b16 v[28:29], v5 offset:34816
    ds_read_b64_tr_b16 v[30:31], v5 offset:35328
    ds_read_b64_tr_b16 v[32:33], v6 offset:34816
    ds_read_b64_tr_b16 v[34:35], v6 offset:35328
    s_waitcnt lgkmcnt(8)
    v_mfma_f32_32x32x16_bf16 v[76:91], v[36:39], v[164:167], v[76:91]
    v_mfma_f32_32x32x16_bf16 v[92:107], v[40:43], v[164:167], v[92:107]
    v_mfma_f32_32x32x16_bf16 v[108:123], v[36:39], v[168:171], v[108:123]
    v_mfma_f32_32x32x16_bf16 v[124:139], v[40:43], v[168:171], v[124:139]
    ds_read_b64_tr_b16 v[36:37], v5 offset:36864
    ds_read_b64_tr_b16 v[38:39], v5 offset:37376
    ds_read_b64_tr_b16 v[40:41], v6 offset:36864
    ds_read_b64_tr_b16 v[42:43], v6 offset:37376
    s_waitcnt lgkmcnt(8)
    v_mfma_f32_32x32x16_bf16 v[76:91], v[20:23], v[172:175], v[76:91]
    s_add_u32 m0, s26, 57344
    s_add_u32 s21, s20, 0
    buffer_load_dwordx4 v2, s[16:19], s21 offen lds
    s_add_u32 m0, s26, 58368
    s_add_u32 s21, s20, 65536
    buffer_load_dwordx4 v2, s[16:19], s21 offen lds
    s_add_u32 s20, s20, 524288
    v_mfma_f32_32x32x16_bf16 v[92:107], v[24:27], v[172:175], v[92:107]
    v_mfma_f32_32x32x16_bf16 v[108:123], v[20:23], v[176:179], v[108:123]
    v_mfma_f32_32x32x16_bf16 v[124:139], v[24:27], v[176:179], v[124:139]
    ds_read_b64_tr_b16 v[20:21], v5 offset:38912
    ds_read_b64_tr_b16 v[22:23], v5 offset:39424
    ds_read_b64_tr_b16 v[24:25], v6 offset:38912
    ds_read_b64_tr_b16 v[26:27], v6 offset:39424
    s_waitcnt lgkmcnt(8)
    v_mfma_f32_32x32x16_bf16 v[76:91], v[28:31], v[180:183], v[76:91]
    v_mfma_f32_32x32x16_bf16 v[92:107], v[32:35], v[180:183], v[92:107]
    v_mfma_f32_32x32x16_bf16 v[108:123], v[28:31], v[184:187], v[108:123]
    v_mfma_f32_32x32x16_bf16 v[124:139], v[32:35], v[184:187], v[124:139]
    s_waitcnt vmcnt(14)
    s_barrier
    s_waitcnt lgkmcnt(4)
    v_mfma_f32_32x32x16_bf16 v[76:91], v[36:39], v[188:191], v[76:91]
    v_mfma_f32_32x32x16_bf16 v[92:107], v[40:43], v[188:191], v[92:107]
    v_mfma_f32_32x32x16_bf16 v[108:123], v[36:39], v[192:195], v[108:123]
    v_mfma_f32_32x32x16_bf16 v[124:139], v[40:43], v[192:195], v[124:139]
    s_waitcnt lgkmcnt(0)
    v_mfma_f32_32x32x16_bf16 v[76:91], v[20:23], v[196:199], v[76:91]
    v_mfma_f32_32x32x16_bf16 v[92:107], v[24:27], v[196:199], v[92:107]
    v_mfma_f32_32x32x16_bf16 v[108:123], v[20:23], v[200:203], v[108:123]
    v_mfma_f32_32x32x16_bf16 v[124:139], v[24:27], v[200:203], v[124:139]
    s_nop 7
    s_nop 3
    v_cvt_pk_bf16_f32 v44, v76, v77
    v_cvt_pk_bf16_f32 v45, v78, v79
    v_cvt_pk_bf16_f32 v46, v80, v81
    v_cvt_pk_bf16_f32 v47, v82, v83
    v_cvt_pk_bf16_f32 v48, v84, v85
    v_cvt_pk_bf16_f32 v49, v86, v87
    v_cvt_pk_bf16_f32 v50, v88, v89
    v_cvt_pk_bf16_f32 v51, v90, v91
    s_nop 1
    v_permlane32_swap_b32 v44, v46
    v_permlane32_swap_b32 v45, v47
    v_permlane32_swap_b32 v48, v50
    v_permlane32_swap_b32 v49, v51
    ds_write_b128 v14, v[44:47] offset:0
    ds_write_b128 v15, v[48:51] offset:0
    v_cvt_pk_bf16_f32 v52, v92, v93
    v_cvt_pk_bf16_f32 v53, v94, v95
    v_cvt_pk_bf16_f32 v54, v96, v97
    v_cvt_pk_bf16_f32 v55, v98, v99
    v_cvt_pk_bf16_f32 v56, v100, v101
    v_cvt_pk_bf16_f32 v57, v102, v103
    v_cvt_pk_bf16_f32 v58, v104, v105
    v_cvt_pk_bf16_f32 v59, v106, v107
    s_nop 1
    v_permlane32_swap_b32 v52, v54
    v_permlane32_swap_b32 v53, v55
    v_permlane32_swap_b32 v56, v58
    v_permlane32_swap_b32 v57, v59
    ds_write_b128 v16, v[52:55] offset:0
    ds_write_b128 v17, v[56:59] offset:0
    v_cvt_pk_bf16_f32 v60, v108, v109
    v_cvt_pk_bf16_f32 v61, v110, v111
    v_cvt_pk_bf16_f32 v62, v112, v113
    v_cvt_pk_bf16_f32 v63, v114, v115
    v_cvt_pk_bf16_f32 v64, v116, v117
    v_cvt_pk_bf16_f32 v65, v118, v119
    v_cvt_pk_bf16_f32 v66, v120, v121
    v_cvt_pk_bf16_f32 v67, v122, v123
    s_nop 1
    v_permlane32_swap_b32 v60, v62
    v_permlane32_swap_b32 v61, v63
    v_permlane32_swap_b32 v64, v66
    v_permlane32_swap_b32 v65, v67
    ds_write_b128 v14, v[60:63] offset:4096
    ds_write_b128 v15, v[64:67] offset:4096
    v_cvt_pk_bf16_f32 v68, v124, v125
    v_cvt_pk_bf16_f32 v69, v126, v127
    v_cvt_pk_bf16_f32 v70, v128, v129
    v_cvt_pk_bf16_f32 v71, v130, v131
    v_cvt_pk_bf16_f32 v72, v132, v133
    v_cvt_pk_bf16_f32 v73, v134, v135
    v_cvt_pk_bf16_f32 v74, v136, v137
    v_cvt_pk_bf16_f32 v75, v138, v139
    s_nop 1
    v_permlane32_swap_b32 v68, v70
    v_permlane32_swap_b32 v69, v71
    v_permlane32_swap_b32 v72, v74
    v_permlane32_swap_b32 v73, v75
    ds_write_b128 v16, v[68:71] offset:4096
    ds_write_b128 v17, v[72:75] offset:4096
    s_waitcnt lgkmcnt(0)
    ds_read_b128 v[44:47], v18 offset:0
    ds_read_b128 v[48:51], v18 offset:1024
    ds_read_b128 v[52:55], v18 offset:2048
    ds_read_b128 v[56:59], v18 offset:3072
    ds_read_b128 v[60:63], v18 offset:4096
    ds_read_b128 v[64:67], v18 offset:5120
    ds_read_b128 v[68:71], v18 offset:6144
    ds_read_b128 v[72:75], v18 offset:7168
    s_add_u32 s21, s90, 0
    s_waitcnt lgkmcnt(7)
    buffer_store_dwordx4 v[44:47], v7, s[4:7], s21 offen sc1
    s_add_u32 s21, s90, 66560
    s_waitcnt lgkmcnt(6)
    buffer_store_dwordx4 v[48:51], v7, s[4:7], s21 offen sc1
    s_add_u32 s21, s90, 133120
    s_waitcnt lgkmcnt(5)
    buffer_store_dwordx4 v[52:55], v7, s[4:7], s21 offen sc1
    s_add_u32 s21, s90, 199680
    s_waitcnt lgkmcnt(4)
    buffer_store_dwordx4 v[56:59], v7, s[4:7], s21 offen sc1
    s_add_u32 s21, s90, 266240
    s_waitcnt lgkmcnt(3)
    buffer_store_dwordx4 v[60:63], v7, s[4:7], s21 offen sc1
    s_add_u32 s21, s90, 332800
    s_waitcnt lgkmcnt(2)
    buffer_store_dwordx4 v[64:67], v7, s[4:7], s21 offen sc1
    s_add_u32 s21, s90, 399360
    s_waitcnt lgkmcnt(1)
    buffer_store_dwordx4 v[68:71], v7, s[4:7], s21 offen sc1
    s_add_u32 s21, s90, 465920
    s_waitcnt lgkmcnt(0)
    buffer_store_dwordx4 v[72:75], v7, s[4:7], s21 offen sc1
    s_branch Lunitd
Lunitkf:
    s_waitcnt vmcnt(8)
    s_barrier
    ds_read_b128 a[0:3], v46 offset:0
    ds_read_b128 a[4:7], v46 offset:4096
    ds_read_b128 a[8:11], v47 offset:0
    ds_read_b128 a[12:15], v47 offset:4096
    ds_read_b128 a[16:19], v48 offset:0
    ds_read_b128 a[20:23], v48 offset:4096
    ds_read_b128 a[24:27], v49 offset:0
    ds_read_b128 a[28:31], v49 offset:4096
    s_waitcnt lgkmcnt(0)
    ds_read_b64_tr_b16 v[20:21], v3 offset:0
    ds_read_b64_tr_b16 v[22:23], v3 offset:512
    ds_read_b64_tr_b16 v[24:25], v4 offset:0
    ds_read_b64_tr_b16 v[26:27], v4 offset:512
    ds_read_b64_tr_b16 v[28:29], v3 offset:2048
    ds_read_b64_tr_b16 v[30:31], v3 offset:2560
    ds_read_b64_tr_b16 v[32:33], v4 offset:2048
    ds_read_b64_tr_b16 v[34:35], v4 offset:2560
    ds_read_b64_tr_b16 v[36:37], v3 offset:4096
    ds_read_b64_tr_b16 v[38:39], v3 offset:4608
    ds_read_b64_tr_b16 v[40:41], v4 offset:4096
    ds_read_b64_tr_b16 v[42:43], v4 offset:4608
    s_waitcnt lgkmcnt(8)
    v_mfma_f32_32x32x16_bf16 v[76:91], v[20:23], a[0:3], 0
    s_add_u32 m0, s26, 65536
    s_add_u32 s21, s20, 0
    buffer_load_dwordx4 v2, s[16:19], s21 offen lds
    s_add_u32 m0, s26, 66560
    s_add_u32 s21, s20, 65536
    buffer_load_dwordx4 v2, s[16:19], s21 offen lds
    s_add_u32 s20, s20, 524288
    s_add_u32 m0, s23, 0
    s_add_u32 s21, s22, 256
    buffer_load_dwordx4 v44, s[8:11], s21 offen lds
    s_add_u32 m0, s23, 1024
    s_add_u32 s21, s22, 10496
    buffer_load_dwordx4 v45, s[8:11], s21 offen lds
    s_add_u32 m0, s23, 2048
    s_add_u32 s21, s22, 20736
    buffer_load_dwordx4 v44, s[8:11], s21 offen lds
    s_add_u32 m0, s23, 3072
    s_add_u32 s21, s22, 30976
    buffer_load_dwordx4 v45, s[8:11], s21 offen lds
    s_add_u32 m0, s23, 4096
    s_add_u32 s21, s22, 41216
    buffer_load_dwordx4 v44, s[8:11], s21 offen lds
    s_add_u32 m0, s23, 5120
    s_add_u32 s21, s22, 51456
    buffer_load_dwordx4 v45, s[8:11], s21 offen lds
    s_add_u32 m0, s23, 6144
    s_add_u32 s21, s22, 61696
    buffer_load_dwordx4 v44, s[8:11], s21 offen lds
    s_add_u32 m0, s23, 7168
    s_add_u32 s21, s22, 71936
    buffer_load_dwordx4 v45, s[8:11], s21 offen lds
    v_mfma_f32_32x32x16_bf16 v[92:107], v[24:27], a[0:3], 0
    v_mfma_f32_32x32x16_bf16 v[108:123], v[20:23], a[4:7], 0
    v_mfma_f32_32x32x16_bf16 v[124:139], v[24:27], a[4:7], 0
    ds_read_b64_tr_b16 v[20:21], v3 offset:6144
    ds_read_b64_tr_b16 v[22:23], v3 offset:6656
    ds_read_b64_tr_b16 v[24:25], v4 offset:6144
    ds_read_b64_tr_b16 v[26:27], v4 offset:6656
    s_waitcnt lgkmcnt(8)
    v_mfma_f32_32x32x16_bf16 v[76:91], v[28:31], a[8:11], v[76:91]
    v_mfma_f32_32x32x16_bf16 v[92:107], v[32:35], a[8:11], v[92:107]
    v_mfma_f32_32x32x16_bf16 v[108:123], v[28:31], a[12:15], v[108:123]
    v_mfma_f32_32x32x16_bf16 v[124:139], v[32:35], a[12:15], v[124:139]
    s_barrier
    s_waitcnt vmcnt(10)
    ds_read_b128 a[32:35], v46 offset:8192
    ds_read_b128 a[36:39], v46 offset:12288
    ds_read_b128 a[40:43], v47 offset:8192
    ds_read_b128 a[44:47], v47 offset:12288
    ds_read_b128 a[48:51], v48 offset:8192
    ds_read_b128 a[52:55], v48 offset:12288
    ds_read_b128 a[56:59], v49 offset:8192
    ds_read_b128 a[60:63], v49 offset:12288
    ds_read_b64_tr_b16 v[28:29], v3 offset:8192
    ds_read_b64_tr_b16 v[30:31], v3 offset:8704
    ds_read_b64_tr_b16 v[32:33], v4 offset:8192
    ds_read_b64_tr_b16 v[34:35], v4 offset:8704
    s_waitcnt lgkmcnt(8)
    v_mfma_f32_32x32x16_bf16 v[76:91], v[36:39], a[16:19], v[76:91]
    v_mfma_f32_32x32x16_bf16 v[92:107], v[40:43], a[16:19], v[92:107]
    v_mfma_f32_32x32x16_bf16 v[108:123], v[36:39], a[20:23], v[108:123]
    v_mfma_f32_32x32x16_bf16 v[124:139], v[40:43], a[20:23], v[124:139]
    ds_read_b64_tr_b16 v[36:37], v3 offset:10240
    ds_read_b64_tr_b16 v[38:39], v3 offset:10752
    ds_read_b64_tr_b16 v[40:41], v4 offset:10240
    ds_read_b64_tr_b16 v[42:43], v4 offset:10752
    s_waitcnt lgkmcnt(8)
    v_mfma_f32_32x32x16_bf16 v[76:91], v[20:23], a[24:27], v[76:91]
    v_mfma_f32_32x32x16_bf16 v[92:107], v[24:27], a[24:27], v[92:107]
    v_mfma_f32_32x32x16_bf16 v[108:123], v[20:23], a[28:31], v[108:123]
    v_mfma_f32_32x32x16_bf16 v[124:139], v[24:27], a[28:31], v[124:139]
    ds_read_b64_tr_b16 v[20:21], v3 offset:12288
    ds_read_b64_tr_b16 v[22:23], v3 offset:12800
    ds_read_b64_tr_b16 v[24:25], v4 offset:12288
    ds_read_b64_tr_b16 v[26:27], v4 offset:12800
    s_waitcnt lgkmcnt(8)
    v_mfma_f32_32x32x16_bf16 v[76:91], v[28:31], a[32:35], v[76:91]
    s_add_u32 m0, s26, 73728
    s_add_u32 s21, s20, 0
    buffer_load_dwordx4 v2, s[16:19], s21 offen lds
    s_add_u32 m0, s26, 74752
    s_add_u32 s21, s20, 65536
    buffer_load_dwordx4 v2, s[16:19], s21 offen lds
    s_add_u32 s20, s20, 524288
    s_add_u32 m0, s23, 8192
    s_add_u32 s21, s22, 384
    buffer_load_dwordx4 v44, s[8:11], s21 offen lds
    s_add_u32 m0, s23, 9216
    s_add_u32 s21, s22, 10624
    buffer_load_dwordx4 v45, s[8:11], s21 offen lds
    s_add_u32 m0, s23, 10240
    s_add_u32 s21, s22, 20864
    buffer_load_dwordx4 v44, s[8:11], s21 offen lds
    s_add_u32 m0, s23, 11264
    s_add_u32 s21, s22, 31104
    buffer_load_dwordx4 v45, s[8:11], s21 offen lds
    s_add_u32 m0, s23, 12288
    s_add_u32 s21, s22, 41344
    buffer_load_dwordx4 v44, s[8:11], s21 offen lds
    s_add_u32 m0, s23, 13312
    s_add_u32 s21, s22, 51584
    buffer_load_dwordx4 v45, s[8:11], s21 offen lds
    s_add_u32 m0, s23, 14336
    s_add_u32 s21, s22, 61824
    buffer_load_dwordx4 v44, s[8:11], s21 offen lds
    s_add_u32 m0, s23, 15360
    s_add_u32 s21, s22, 72064
    buffer_load_dwordx4 v45, s[8:11], s21 offen lds
    v_mfma_f32_32x32x16_bf16 v[92:107], v[32:35], a[32:35], v[92:107]
    v_mfma_f32_32x32x16_bf16 v[108:123], v[28:31], a[36:39], v[108:123]
    v_mfma_f32_32x32x16_bf16 v[124:139], v[32:35], a[36:39], v[124:139]
    ds_read_b64_tr_b16 v[28:29], v3 offset:14336
    ds_read_b64_tr_b16 v[30:31], v3 offset:14848
    ds_read_b64_tr_b16 v[32:33], v4 offset:14336
    ds_read_b64_tr_b16 v[34:35], v4 offset:14848
    s_waitcnt lgkmcnt(8)
    v_mfma_f32_32x32x16_bf16 v[76:91], v[36:39], a[40:43], v[76:91]
    v_mfma_f32_32x32x16_bf16 v[92:107], v[40:43], a[40:43], v[92:107]
    v_mfma_f32_32x32x16_bf16 v[108:123], v[36:39], a[44:47], v[108:123]
    v_mfma_f32_32x32x16_bf16 v[124:139], v[40:43], a[44:47], v[124:139]
    s_barrier
    s_waitcnt vmcnt(10)
    ds_read_b128 a[64:67], v46 offset:0
    ds_read_b128 a[68:71], v46 offset:4096
    ds_read_b128 a[72:75], v47 offset:0
    ds_read_b128 a[76:79], v47 offset:4096
    ds_read_b128 a[80:83], v48 offset:0
    ds_read_b128 a[84:87], v48 offset:4096
    ds_read_b128 a[88:91], v49 offset:0
    ds_read_b128 a[92:95], v49 offset:4096
    ds_read_b64_tr_b16 v[36:37], v3 offset:16384
    ds_read_b64_tr_b16 v[38:39], v3 offset:16896
    ds_read_b64_tr_b16 v[40:41], v4 offset:16384
    ds_read_b64_tr_b16 v[42:43], v4 offset:16896
    s_waitcnt lgkmcnt(8)
    v_mfma_f32_32x32x16_bf16 v[76:91], v[20:23], a[48:51], v[76:91]
    v_mfma_f32_32x32x16_bf16 v[92:107], v[24:27], a[48:51], v[92:107]
    v_mfma_f32_32x32x16_bf16 v[108:123], v[20:23], a[52:55], v[108:123]
    v_mfma_f32_32x32x16_bf16 v[124:139], v[24:27], a[52:55], v[124:139]
    ds_read_b64_tr_b16 v[20:21], v3 offset:18432
    ds_read_b64_tr_b16 v[22:23], v3 offset:18944
    ds_read_b64_tr_b16 v[24:25], v4 offset:18432
    ds_read_b64_tr_b16 v[26:27], v4 offset:18944
    s_waitcnt lgkmcnt(8)
    v_mfma_f32_32x32x16_bf16 v[76:91], v[28:31], a[56:59], v[76:91]
    v_mfma_f32_32x32x16_bf16 v[92:107], v[32:35], a[56:59], v[92:107]
    v_mfma_f32_32x32x16_bf16 v[108:123], v[28:31], a[60:63], v[108:123]
    v_mfma_f32_32x32x16_bf16 v[124:139], v[32:35], a[60:63], v[124:139]
    ds_read_b64_tr_b16 v[28:29], v3 offset:20480
    ds_read_b64_tr_b16 v[30:31], v3 offset:20992
    ds_read_b64_tr_b16 v[32:33], v4 offset:20480
    ds_read_b64_tr_b16 v[34:35], v4 offset:20992
    s_waitcnt lgkmcnt(8)
    v_mfma_f32_32x32x16_bf16 v[76:91], v[36:39], a[64:67], v[76:91]
    s_add_u32 s93, s87, s86
    s_cmp_lt_u32 s93, s88
    s_cselect_b32 s93, s93, s87
    s_lshr_b32 s92, s93, 6
    s_cmp_eq_u32 s92, 0
    s_cselect_b32 s16, s46, s48
    s_cselect_b32 s17, s47, s49
    s_cmp_eq_u32 s92, 2
    s_cselect_b32 s16, s44, s16
    s_cselect_b32 s17, s45, s17
    s_and_b32 s17, s17, 0xffff
    s_and_b32 s92, s93, 63
    s_lshl_b32 s20, s92, 7
    s_add_u32 m0, s26, 0
    s_add_u32 s21, s20, 0
    buffer_load_dwordx4 v2, s[16:19], s21 offen lds
    s_add_u32 m0, s26, 1024
    s_add_u32 s21, s20, 65536
    buffer_load_dwordx4 v2, s[16:19], s21 offen lds
    s_add_u32 s20, s20, 524288
    s_add_u32 m0, s23, 0
    s_add_u32 s21, s22, 512
    buffer_load_dwordx4 v44, s[8:11], s21 offen lds
    s_add_u32 m0, s23, 1024
    s_add_u32 s21, s22, 10752
    buffer_load_dwordx4 v45, s[8:11], s21 offen lds
    s_add_u32 m0, s23, 2048
    s_add_u32 s21, s22, 20992
    buffer_load_dwordx4 v44, s[8:11], s21 offen lds
    s_add_u32 m0, s23, 3072
    s_add_u32 s21, s22, 31232
    buffer_load_dwordx4 v45, s[8:11], s21 offen lds
    s_add_u32 m0, s23, 4096
    s_add_u32 s21, s22, 41472
    buffer_load_dwordx4 v44, s[8:11], s21 offen lds
    s_add_u32 m0, s23, 5120
    s_add_u32 s21, s22, 51712
    buffer_load_dwordx4 v45, s[8:11], s21 offen lds
    s_add_u32 m0, s23, 6144
    s_add_u32 s21, s22, 61952
    buffer_load_dwordx4 v44, s[8:11], s21 offen lds
    s_add_u32 m0, s23, 7168
    s_add_u32 s21, s22, 72192
    buffer_load_dwordx4 v45, s[8:11], s21 offen lds
    v_mfma_f32_32x32x16_bf16 v[92:107], v[40:43], a[64:67], v[92:107]
    v_mfma_f32_32x32x16_bf16 v[108:123], v[36:39], a[68:71], v[108:123]
    v_mfma_f32_32x32x16_bf16 v[124:139], v[40:43], a[68:71], v[124:139]
    ds_read_b64_tr_b16 v[36:37], v3 offset:22528
    ds_read_b64_tr_b16 v[38:39], v3 offset:23040
    ds_read_b64_tr_b16 v[40:41], v4 offset:22528
    ds_read_b64_tr_b16 v[42:43], v4 offset:23040
    s_waitcnt lgkmcnt(8)
    v_mfma_f32_32x32x16_bf16 v[76:91], v[20:23], a[72:75], v[76:91]
    v_mfma_f32_32x32x16_bf16 v[92:107], v[24:27], a[72:75], v[92:107]
    v_mfma_f32_32x32x16_bf16 v[108:123], v[20:23], a[76:79], v[108:123]
    v_mfma_f32_32x32x16_bf16 v[124:139], v[24:27], a[76:79], v[124:139]
    s_barrier
    s_waitcnt vmcnt(10)
    ds_read_b128 a[96:99], v46 offset:8192
    ds_read_b128 a[100:103], v46 offset:12288
    ds_read_b128 a[104:107], v47 offset:8192
    ds_read_b128 a[108:111], v47 offset:12288
    ds_read_b128 a[112:115], v48 offset:8192
    ds_read_b128 a[116:119], v48 offset:12288
    ds_read_b128 a[120:123], v49 offset:8192
    ds_read_b128 a[124:127], v49 offset:12288
    ds_read_b64_tr_b16 v[20:21], v3 offset:24576
    ds_read_b64_tr_b16 v[22:23], v3 offset:25088
    ds_read_b64_tr_b16 v[24:25], v4 offset:24576
    ds_read_b64_tr_b16 v[26:27], v4 offset:25088
    s_waitcnt lgkmcnt(8)
    v_mfma_f32_32x32x16_bf16 v[76:91], v[28:31], a[80:83], v[76:91]
    v_mfma_f32_32x32x16_bf16 v[92:107], v[32:35], a[80:83], v[92:107]
    v_mfma_f32_32x32x16_bf16 v[108:123], v[28:31], a[84:87], v[108:123]
    v_mfma_f32_32x32x16_bf16 v[124:139], v[32:35], a[84:87], v[124:139]
    ds_read_b64_tr_b16 v[28:29], v3 offset:26624
    ds_read_b64_tr_b16 v[30:31], v3 offset:27136
    ds_read_b64_tr_b16 v[32:33], v4 offset:26624
    ds_read_b64_tr_b16 v[34:35], v4 offset:27136
    s_waitcnt lgkmcnt(8)
    v_mfma_f32_32x32x16_bf16 v[76:91], v[36:39], a[88:91], v[76:91]
    v_mfma_f32_32x32x16_bf16 v[92:107], v[40:43], a[88:91], v[92:107]
    v_mfma_f32_32x32x16_bf16 v[108:123], v[36:39], a[92:95], v[108:123]
    v_mfma_f32_32x32x16_bf16 v[124:139], v[40:43], a[92:95], v[124:139]
    ds_read_b64_tr_b16 v[36:37], v3 offset:28672
    ds_read_b64_tr_b16 v[38:39], v3 offset:29184
    ds_read_b64_tr_b16 v[40:41], v4 offset:28672
    ds_read_b64_tr_b16 v[42:43], v4 offset:29184
    s_waitcnt lgkmcnt(8)
    v_mfma_f32_32x32x16_bf16 v[76:91], v[20:23], a[96:99], v[76:91]
    s_add_u32 m0, s26, 8192
    s_add_u32 s21, s20, 0
    buffer_load_dwordx4 v2, s[16:19], s21 offen lds
    s_add_u32 m0, s26, 9216
    s_add_u32 s21, s20, 65536
    buffer_load_dwordx4 v2, s[16:19], s21 offen lds
    s_add_u32 s20, s20, 524288
    s_add_u32 m0, s23, 8192
    s_add_u32 s21, s22, 640
    buffer_load_dwordx4 v44, s[8:11], s21 offen lds
    s_add_u32 m0, s23, 9216
    s_add_u32 s21, s22, 10880
    buffer_load_dwordx4 v45, s[8:11], s21 offen lds
    s_add_u32 m0, s23, 10240
    s_add_u32 s21, s22, 21120
    buffer_load_dwordx4 v44, s[8:11], s21 offen lds
    s_add_u32 m0, s23, 11264
    s_add_u32 s21, s22, 31360
    buffer_load_dwordx4 v45, s[8:11], s21 offen lds
    s_add_u32 m0, s23, 12288
    s_add_u32 s21, s22, 41600
    buffer_load_dwordx4 v44, s[8:11], s21 offen lds
    s_add_u32 m0, s23, 13312
    s_add_u32 s21, s22, 51840
    buffer_load_dwordx4 v45, s[8:11], s21 offen lds
    s_add_u32 m0, s23, 14336
    s_add_u32 s21, s22, 62080
    buffer_load_dwordx4 v44, s[8:11], s21 offen lds
    s_add_u32 m0, s23, 15360
    s_add_u32 s21, s22, 72320
    buffer_load_dwordx4 v45, s[8:11], s21 offen lds
    v_mfma_f32_32x32x16_bf16 v[92:107], v[24:27], a[96:99], v[92:107]
    v_mfma_f32_32x32x16_bf16 v[108:123], v[20:23], a[100:103], v[108:123]
    v_mfma_f32_32x32x16_bf16 v[124:139], v[24:27], a[100:103], v[124:139]
    ds_read_b64_tr_b16 v[20:21], v3 offset:30720
    ds_read_b64_tr_b16 v[22:23], v3 offset:31232
    ds_read_b64_tr_b16 v[24:25], v4 offset:30720
    ds_read_b64_tr_b16 v[26:27], v4 offset:31232
    s_waitcnt lgkmcnt(8)
    v_mfma_f32_32x32x16_bf16 v[76:91], v[28:31], a[104:107], v[76:91]
    v_mfma_f32_32x32x16_bf16 v[92:107], v[32:35], a[104:107], v[92:107]
    v_mfma_f32_32x32x16_bf16 v[108:123], v[28:31], a[108:111], v[108:123]
    v_mfma_f32_32x32x16_bf16 v[124:139], v[32:35], a[108:111], v[124:139]
    s_barrier
    s_waitcnt vmcnt(10)
    ds_read_b128 a[128:131], v46 offset:0
    ds_read_b128 a[132:135], v46 offset:4096
    ds_read_b128 a[136:139], v47 offset:0
    ds_read_b128 a[140:143], v47 offset:4096
    ds_read_b128 a[144:147], v48 offset:0
    ds_read_b128 a[148:151], v48 offset:4096
    ds_read_b128 a[152:155], v49 offset:0
    ds_read_b128 a[156:159], v49 offset:4096
    ds_read_b64_tr_b16 v[28:29], v3 offset:32768
    ds_read_b64_tr_b16 v[30:31], v3 offset:33280
    ds_read_b64_tr_b16 v[32:33], v4 offset:32768
    ds_read_b64_tr_b16 v[34:35], v4 offset:33280
    s_waitcnt lgkmcnt(8)
    v_mfma_f32_32x32x16_bf16 v[76:91], v[36:39], a[112:115], v[76:91]
    v_mfma_f32_32x32x16_bf16 v[92:107], v[40:43], a[112:115], v[92:107]
    v_mfma_f32_32x32x16_bf16 v[108:123], v[36:39], a[116:119], v[108:123]
    v_mfma_f32_32x32x16_bf16 v[124:139], v[40:43], a[116:119], v[124:139]
    ds_read_b64_tr_b16 v[36:37], v3 offset:34816
    ds_read_b64_tr_b16 v[38:39], v3 offset:35328
    ds_read_b64_tr_b16 v[40:41], v4 offset:34816
    ds_read_b64_tr_b16 v[42:43], v4 offset:35328
    s_waitcnt lgkmcnt(8)
    v_mfma_f32_32x32x16_bf16 v[76:91], v[20:23], a[120:123], v[76:91]
    v_mfma_f32_32x32x16_bf16 v[92:107], v[24:27], a[120:123], v[92:107]
    v_mfma_f32_32x32x16_bf16 v[108:123], v[20:23], a[124:127], v[108:123]
    v_mfma_f32_32x32x16_bf16 v[124:139], v[24:27], a[124:127], v[124:139]
    ds_read_b64_tr_b16 v[20:21], v3 offset:36864
    ds_read_b64_tr_b16 v[22:23], v3 offset:37376
    ds_read_b64_tr_b16 v[24:25], v4 offset:36864
    ds_read_b64_tr_b16 v[26:27], v4 offset:37376
    s_waitcnt lgkmcnt(8)
    v_mfma_f32_32x32x16_bf16 v[76:91], v[28:31], a[128:131], v[76:91]
    s_add_u32 m0, s26, 16384
    s_add_u32 s21, s20, 0
    buffer_load_dwordx4 v2, s[16:19], s21 offen lds
    s_add_u32 m0, s26, 17408
    s_add_u32 s21, s20, 65536
    buffer_load_dwordx4 v2, s[16:19], s21 offen lds
    s_add_u32 s20, s20, 524288
    s_add_u32 m0, s23, 0
    s_add_u32 s21, s22, 768
    buffer_load_dwordx4 v44, s[8:11], s21 offen lds
    s_add_u32 m0, s23, 1024
    s_add_u32 s21, s22, 11008
    buffer_load_dwordx4 v45, s[8:11], s21 offen lds
    s_add_u32 m0, s23, 2048
    s_add_u32 s21, s22, 21248
    buffer_load_dwordx4 v44, s[8:11], s21 offen lds
    s_add_u32 m0, s23, 3072
    s_add_u32 s21, s22, 31488
    buffer_load_dwordx4 v45, s[8:11], s21 offen lds
    s_add_u32 m0, s23, 4096
    s_add_u32 s21, s22, 41728
    buffer_load_dwordx4 v44, s[8:11], s21 offen lds
    s_add_u32 m0, s23, 5120
    s_add_u32 s21, s22, 51968
    buffer_load_dwordx4 v45, s[8:11], s21 offen lds
    s_add_u32 m0, s23, 6144
    s_add_u32 s21, s22, 62208
    buffer_load_dwordx4 v44, s[8:11], s21 offen lds
    s_add_u32 m0, s23, 7168
    s_add_u32 s21, s22, 72448
    buffer_load_dwordx4 v45, s[8:11], s21 offen lds
    v_mfma_f32_32x32x16_bf16 v[92:107], v[32:35], a[128:131], v[92:107]
    v_mfma_f32_32x32x16_bf16 v[108:123], v[28:31], a[132:135], v[108:123]
    v_mfma_f32_32x32x16_bf16 v[124:139], v[32:35], a[132:135], v[124:139]
    ds_read_b64_tr_b16 v[28:29], v3 offset:38912
    ds_read_b64_tr_b16 v[30:31], v3 offset:39424
    ds_read_b64_tr_b16 v[32:33], v4 offset:38912
    ds_read_b64_tr_b16 v[34:35], v4 offset:39424
    s_waitcnt lgkmcnt(8)
    v_mfma_f32_32x32x16_bf16 v[76:91], v[36:39], a[136:139], v[76:91]
    v_mfma_f32_32x32x16_bf16 v[92:107], v[40:43], a[136:139], v[92:107]
    v_mfma_f32_32x32x16_bf16 v[108:123], v[36:39], a[140:143], v[108:123]
    v_mfma_f32_32x32x16_bf16 v[124:139], v[40:43], a[140:143], v[124:139]
    s_barrier
    s_waitcnt vmcnt(10)
    ds_read_b128 a[160:163], v46 offset:8192
    ds_read_b128 a[164:167], v46 offset:12288
    ds_read_b128 a[168:171], v47 offset:8192
    ds_read_b128 a[172:175], v47 offset:12288
    ds_read_b128 a[176:179], v48 offset:8192
    ds_read_b128 a[180:183], v48 offset:12288
    ds_read_b128 a[184:187], v49 offset:8192
    ds_read_b128 a[188:191], v49 offset:12288
    ds_read_b64_tr_b16 v[36:37], v5 offset:0
    ds_read_b64_tr_b16 v[38:39], v5 offset:512
    ds_read_b64_tr_b16 v[40:41], v6 offset:0
    ds_read_b64_tr_b16 v[42:43], v6 offset:512
    s_waitcnt lgkmcnt(8)
    v_mfma_f32_32x32x16_bf16 v[76:91], v[20:23], a[144:147], v[76:91]
    v_mfma_f32_32x32x16_bf16 v[92:107], v[24:27], a[144:147], v[92:107]
    v_mfma_f32_32x32x16_bf16 v[108:123], v[20:23], a[148:151], v[108:123]
    v_mfma_f32_32x32x16_bf16 v[124:139], v[24:27], a[148:151], v[124:139]
    ds_read_b64_tr_b16 v[20:21], v5 offset:2048
    ds_read_b64_tr_b16 v[22:23], v5 offset:2560
    ds_read_b64_tr_b16 v[24:25], v6 offset:2048
    ds_read_b64_tr_b16 v[26:27], v6 offset:2560
    s_waitcnt lgkmcnt(8)
    v_mfma_f32_32x32x16_bf16 v[76:91], v[28:31], a[152:155], v[76:91]
    v_mfma_f32_32x32x16_bf16 v[92:107], v[32:35], a[152:155], v[92:107]
    v_mfma_f32_32x32x16_bf16 v[108:123], v[28:31], a[156:159], v[108:123]
    v_mfma_f32_32x32x16_bf16 v[124:139], v[32:35], a[156:159], v[124:139]
    ds_read_b64_tr_b16 v[28:29], v5 offset:4096
    ds_read_b64_tr_b16 v[30:31], v5 offset:4608
    ds_read_b64_tr_b16 v[32:33], v6 offset:4096
    ds_read_b64_tr_b16 v[34:35], v6 offset:4608
    s_waitcnt lgkmcnt(8)
    v_mfma_f32_32x32x16_bf16 v[76:91], v[36:39], a[160:163], v[76:91]
    s_add_u32 m0, s26, 24576
    s_add_u32 s21, s20, 0
    buffer_load_dwordx4 v2, s[16:19], s21 offen lds
    s_add_u32 m0, s26, 25600
    s_add_u32 s21, s20, 65536
    buffer_load_dwordx4 v2, s[16:19], s21 offen lds
    s_add_u32 s20, s20, 524288
    s_add_u32 m0, s23, 8192
    s_add_u32 s21, s22, 896
    buffer_load_dwordx4 v44, s[8:11], s21 offen lds
    s_add_u32 m0, s23, 9216
    s_add_u32 s21, s22, 11136
    buffer_load_dwordx4 v45, s[8:11], s21 offen lds
    s_add_u32 m0, s23, 10240
    s_add_u32 s21, s22, 21376
    buffer_load_dwordx4 v44, s[8:11], s21 offen lds
    s_add_u32 m0, s23, 11264
    s_add_u32 s21, s22, 31616
    buffer_load_dwordx4 v45, s[8:11], s21 offen lds
    s_add_u32 m0, s23, 12288
    s_add_u32 s21, s22, 41856
    buffer_load_dwordx4 v44, s[8:11], s21 offen lds
    s_add_u32 m0, s23, 13312
    s_add_u32 s21, s22, 52096
    buffer_load_dwordx4 v45, s[8:11], s21 offen lds
    s_add_u32 m0, s23, 14336
    s_add_u32 s21, s22, 62336
    buffer_load_dwordx4 v44, s[8:11], s21 offen lds
    s_add_u32 m0, s23, 15360
    s_add_u32 s21, s22, 72576
    buffer_load_dwordx4 v45, s[8:11], s21 offen lds
    v_mfma_f32_32x32x16_bf16 v[92:107], v[40:43], a[160:163], v[92:107]
    v_mfma_f32_32x32x16_bf16 v[108:123], v[36:39], a[164:167], v[108:123]
    v_mfma_f32_32x32x16_bf16 v[124:139], v[40:43], a[164:167], v[124:139]
    ds_read_b64_tr_b16 v[36:37], v5 offset:6144
    ds_read_b64_tr_b16 v[38:39], v5 offset:6656
    ds_read_b64_tr_b16 v[40:41], v6 offset:6144
    ds_read_b64_tr_b16 v[42:43], v6 offset:6656
    s_waitcnt lgkmcnt(8)
    v_mfma_f32_32x32x16_bf16 v[76:91], v[20:23], a[168:171], v[76:91]
    v_mfma_f32_32x32x16_bf16 v[92:107], v[24:27], a[168:171], v[92:107]
    v_mfma_f32_32x32x16_bf16 v[108:123], v[20:23], a[172:175], v[108:123]
    v_mfma_f32_32x32x16_bf16 v[124:139], v[24:27], a[172:175], v[124:139]
    s_barrier
    s_waitcnt vmcnt(10)
    ds_read_b128 a[192:195], v46 offset:0
    ds_read_b128 a[196:199], v46 offset:4096
    ds_read_b128 a[200:203], v47 offset:0
    ds_read_b128 a[204:207], v47 offset:4096
    ds_read_b128 a[208:211], v48 offset:0
    ds_read_b128 a[212:215], v48 offset:4096
    ds_read_b128 a[216:219], v49 offset:0
    ds_read_b128 a[220:223], v49 offset:4096
    ds_read_b64_tr_b16 v[20:21], v5 offset:8192
    ds_read_b64_tr_b16 v[22:23], v5 offset:8704
    ds_read_b64_tr_b16 v[24:25], v6 offset:8192
    ds_read_b64_tr_b16 v[26:27], v6 offset:8704
    s_waitcnt lgkmcnt(8)
    v_mfma_f32_32x32x16_bf16 v[76:91], v[28:31], a[176:179], v[76:91]
    v_mfma_f32_32x32x16_bf16 v[92:107], v[32:35], a[176:179], v[92:107]
    v_mfma_f32_32x32x16_bf16 v[108:123], v[28:31], a[180:183], v[108:123]
    v_mfma_f32_32x32x16_bf16 v[124:139], v[32:35], a[180:183], v[124:139]
    ds_read_b64_tr_b16 v[28:29], v5 offset:10240
    ds_read_b64_tr_b16 v[30:31], v5 offset:10752
    ds_read_b64_tr_b16 v[32:33], v6 offset:10240
    ds_read_b64_tr_b16 v[34:35], v6 offset:10752
    s_waitcnt lgkmcnt(8)
    v_mfma_f32_32x32x16_bf16 v[76:91], v[36:39], a[184:187], v[76:91]
    v_mfma_f32_32x32x16_bf16 v[92:107], v[40:43], a[184:187], v[92:107]
    v_mfma_f32_32x32x16_bf16 v[108:123], v[36:39], a[188:191], v[108:123]
    v_mfma_f32_32x32x16_bf16 v[124:139], v[40:43], a[188:191], v[124:139]
    ds_read_b64_tr_b16 v[36:37], v5 offset:12288
    ds_read_b64_tr_b16 v[38:39], v5 offset:12800
    ds_read_b64_tr_b16 v[40:41], v6 offset:12288
    ds_read_b64_tr_b16 v[42:43], v6 offset:12800
    s_waitcnt lgkmcnt(8)
    v_mfma_f32_32x32x16_bf16 v[76:91], v[20:23], a[192:195], v[76:91]
    s_add_u32 m0, s26, 32768
    s_add_u32 s21, s20, 0
    buffer_load_dwordx4 v2, s[16:19], s21 offen lds
    s_add_u32 m0, s26, 33792
    s_add_u32 s21, s20, 65536
    buffer_load_dwordx4 v2, s[16:19], s21 offen lds
    s_add_u32 s20, s20, 524288
    s_add_u32 m0, s23, 0
    s_add_u32 s21, s22, 1024
    buffer_load_dwordx4 v44, s[8:11], s21 offen lds
    s_add_u32 m0, s23, 1024
    s_add_u32 s21, s22, 11264
    buffer_load_dwordx4 v45, s[8:11], s21 offen lds
    s_add_u32 m0, s23, 2048
    s_add_u32 s21, s22, 21504
    buffer_load_dwordx4 v44, s[8:11], s21 offen lds
    s_add_u32 m0, s23, 3072
    s_add_u32 s21, s22, 31744
    buffer_load_dwordx4 v45, s[8:11], s21 offen lds
    s_add_u32 m0, s23, 4096
    s_add_u32 s21, s22, 41984
    buffer_load_dwordx4 v44, s[8:11], s21 offen lds
    s_add_u32 m0, s23, 5120
    s_add_u32 s21, s22, 52224
    buffer_load_dwordx4 v45, s[8:11], s21 offen lds
    s_add_u32 m0, s23, 6144
    s_add_u32 s21, s22, 62464
    buffer_load_dwordx4 v44, s[8:11], s21 offen lds
    s_add_u32 m0, s23, 7168
    s_add_u32 s21, s22, 72704
    buffer_load_dwordx4 v45, s[8:11], s21 offen lds
    v_mfma_f32_32x32x16_bf16 v[92:107], v[24:27], a[192:195], v[92:107]
    v_mfma_f32_32x32x16_bf16 v[108:123], v[20:23], a[196:199], v[108:123]
    v_mfma_f32_32x32x16_bf16 v[124:139], v[24:27], a[196:199], v[124:139]
    ds_read_b64_tr_b16 v[20:21], v5 offset:14336
    ds_read_b64_tr_b16 v[22:23], v5 offset:14848
    ds_read_b64_tr_b16 v[24:25], v6 offset:14336
    ds_read_b64_tr_b16 v[26:27], v6 offset:14848
    s_waitcnt lgkmcnt(8)
    v_mfma_f32_32x32x16_bf16 v[76:91], v[28:31], a[200:203], v[76:91]
    v_mfma_f32_32x32x16_bf16 v[92:107], v[32:35], a[200:203], v[92:107]
    v_mfma_f32_32x32x16_bf16 v[108:123], v[28:31], a[204:207], v[108:123]
    v_mfma_f32_32x32x16_bf16 v[124:139], v[32:35], a[204:207], v[124:139]
    s_barrier
    s_waitcnt vmcnt(10)
    ds_read_b128 a[224:227], v46 offset:8192
    ds_read_b128 a[228:231], v46 offset:12288
    ds_read_b128 a[232:235], v47 offset:8192
    ds_read_b128 a[236:239], v47 offset:12288
    ds_read_b128 a[240:243], v48 offset:8192
    ds_read_b128 a[244:247], v48 offset:12288
    ds_read_b128 a[248:251], v49 offset:8192
    ds_read_b128 a[252:255], v49 offset:12288
    ds_read_b64_tr_b16 v[28:29], v5 offset:16384
    ds_read_b64_tr_b16 v[30:31], v5 offset:16896
    ds_read_b64_tr_b16 v[32:33], v6 offset:16384
    ds_read_b64_tr_b16 v[34:35], v6 offset:16896
    s_waitcnt lgkmcnt(8)
    v_mfma_f32_32x32x16_bf16 v[76:91], v[36:39], a[208:211], v[76:91]
    v_mfma_f32_32x32x16_bf16 v[92:107], v[40:43], a[208:211], v[92:107]
    v_mfma_f32_32x32x16_bf16 v[108:123], v[36:39], a[212:215], v[108:123]
    v_mfma_f32_32x32x16_bf16 v[124:139], v[40:43], a[212:215], v[124:139]
    ds_read_b64_tr_b16 v[36:37], v5 offset:18432
    ds_read_b64_tr_b16 v[38:39], v5 offset:18944
    ds_read_b64_tr_b16 v[40:41], v6 offset:18432
    ds_read_b64_tr_b16 v[42:43], v6 offset:18944
    s_waitcnt lgkmcnt(8)
    v_mfma_f32_32x32x16_bf16 v[76:91], v[20:23], a[216:219], v[76:91]
    v_mfma_f32_32x32x16_bf16 v[92:107], v[24:27], a[216:219], v[92:107]
    v_mfma_f32_32x32x16_bf16 v[108:123], v[20:23], a[220:223], v[108:123]
    v_mfma_f32_32x32x16_bf16 v[124:139], v[24:27], a[220:223], v[124:139]
    ds_read_b64_tr_b16 v[20:21], v5 offset:20480
    ds_read_b64_tr_b16 v[22:23], v5 offset:20992
    ds_read_b64_tr_b16 v[24:25], v6 offset:20480
    ds_read_b64_tr_b16 v[26:27], v6 offset:20992
    s_waitcnt lgkmcnt(8)
    v_mfma_f32_32x32x16_bf16 v[76:91], v[28:31], a[224:227], v[76:91]
    s_add_u32 m0, s26, 40960
    s_add_u32 s21, s20, 0
    buffer_load_dwordx4 v2, s[16:19], s21 offen lds
    s_add_u32 m0, s26, 41984
    s_add_u32 s21, s20, 65536
    buffer_load_dwordx4 v2, s[16:19], s21 offen lds
    s_add_u32 s20, s20, 524288
    s_add_u32 m0, s23, 8192
    s_add_u32 s21, s22, 1152
    buffer_load_dwordx4 v44, s[8:11], s21 offen lds
    s_add_u32 m0, s23, 9216
    s_add_u32 s21, s22, 11392
    buffer_load_dwordx4 v45, s[8:11], s21 offen lds
    s_add_u32 m0, s23, 10240
    s_add_u32 s21, s22, 21632
    buffer_load_dwordx4 v44, s[8:11], s21 offen lds
    s_add_u32 m0, s23, 11264
    s_add_u32 s21, s22, 31872
    buffer_load_dwordx4 v45, s[8:11], s21 offen lds
    s_add_u32 m0, s23, 12288
    s_add_u32 s21, s22, 42112
    buffer_load_dwordx4 v44, s[8:11], s21 offen lds
    s_add_u32 m0, s23, 13312
    s_add_u32 s21, s22, 52352
    buffer_load_dwordx4 v45, s[8:11], s21 offen lds
    s_add_u32 m0, s23, 14336
    s_add_u32 s21, s22, 62592
    buffer_load_dwordx4 v44, s[8:11], s21 offen lds
    s_add_u32 m0, s23, 15360
    s_add_u32 s21, s22, 72832
    buffer_load_dwordx4 v45, s[8:11], s21 offen lds
    v_mfma_f32_32x32x16_bf16 v[92:107], v[32:35], a[224:227], v[92:107]
    v_mfma_f32_32x32x16_bf16 v[108:123], v[28:31], a[228:231], v[108:123]
    v_mfma_f32_32x32x16_bf16 v[124:139], v[32:35], a[228:231], v[124:139]
    ds_read_b64_tr_b16 v[28:29], v5 offset:22528
    ds_read_b64_tr_b16 v[30:31], v5 offset:23040
    ds_read_b64_tr_b16 v[32:33], v6 offset:22528
    ds_read_b64_tr_b16 v[34:35], v6 offset:23040
    s_waitcnt lgkmcnt(8)
    v_mfma_f32_32x32x16_bf16 v[76:91], v[36:39], a[232:235], v[76:91]
    v_mfma_f32_32x32x16_bf16 v[92:107], v[40:43], a[232:235], v[92:107]
    v_mfma_f32_32x32x16_bf16 v[108:123], v[36:39], a[236:239], v[108:123]
    v_mfma_f32_32x32x16_bf16 v[124:139], v[40:43], a[236:239], v[124:139]
    s_barrier
    s_waitcnt vmcnt(10)
    ds_read_b128 v[140:143], v46 offset:0
    ds_read_b128 v[144:147], v46 offset:4096
    ds_read_b128 v[148:151], v47 offset:0
    ds_read_b128 v[152:155], v47 offset:4096
    ds_read_b128 v[156:159], v48 offset:0
    ds_read_b128 v[160:163], v48 offset:4096
    ds_read_b128 v[164:167], v49 offset:0
    ds_read_b128 v[168:171], v49 offset:4096
    ds_read_b64_tr_b16 v[36:37], v5 offset:24576
    ds_read_b64_tr_b16 v[38:39], v5 offset:25088
    ds_read_b64_tr_b16 v[40:41], v6 offset:24576
    ds_read_b64_tr_b16 v[42:43], v6 offset:25088
    s_waitcnt lgkmcnt(8)
    v_mfma_f32_32x32x16_bf16 v[76:91], v[20:23], a[240:243], v[76:91]
    v_mfma_f32_32x32x16_bf16 v[92:107], v[24:27], a[240:243], v[92:107]
    v_mfma_f32_32x32x16_bf16 v[108:123], v[20:23], a[244:247], v[108:123]
    v_mfma_f32_32x32x16_bf16 v[124:139], v[24:27], a[244:247], v[124:139]
    ds_read_b64_tr_b16 v[20:21], v5 offset:26624
    ds_read_b64_tr_b16 v[22:23], v5 offset:27136
    ds_read_b64_tr_b16 v[24:25], v6 offset:26624
    ds_read_b64_tr_b16 v[26:27], v6 offset:27136
    s_waitcnt lgkmcnt(8)
    v_mfma_f32_32x32x16_bf16 v[76:91], v[28:31], a[248:251], v[76:91]
    v_mfma_f32_32x32x16_bf16 v[92:107], v[32:35], a[248:251], v[92:107]
    v_mfma_f32_32x32x16_bf16 v[108:123], v[28:31], a[252:255], v[108:123]
    v_mfma_f32_32x32x16_bf16 v[124:139], v[32:35], a[252:255], v[124:139]
    ds_read_b64_tr_b16 v[28:29], v5 offset:28672
    ds_read_b64_tr_b16 v[30:31], v5 offset:29184
    ds_read_b64_tr_b16 v[32:33], v6 offset:28672
    ds_read_b64_tr_b16 v[34:35], v6 offset:29184
    s_waitcnt lgkmcnt(8)
    v_mfma_f32_32x32x16_bf16 v[76:91], v[36:39], v[140:143], v[76:91]
    s_add_u32 m0, s26, 49152
    s_add_u32 s21, s20, 0
    buffer_load_dwordx4 v2, s[16:19], s21 offen lds
    s_add_u32 m0, s26, 50176
    s_add_u32 s21, s20, 65536
    buffer_load_dwordx4 v2, s[16:19], s21 offen lds
    s_add_u32 s20, s20, 524288
    v_mfma_f32_32x32x16_bf16 v[92:107], v[40:43], v[140:143], v[92:107]
    v_mfma_f32_32x32x16_bf16 v[108:123], v[36:39], v[144:147], v[108:123]
    v_mfma_f32_32x32x16_bf16 v[124:139], v[40:43], v[144:147], v[124:139]
    ds_read_b64_tr_b16 v[36:37], v5 offset:30720
    ds_read_b64_tr_b16 v[38:39], v5 offset:31232
    ds_read_b64_tr_b16 v[40:41], v6 offset:30720
    ds_read_b64_tr_b16 v[42:43], v6 offset:31232
    s_waitcnt lgkmcnt(8)
    v_mfma_f32_32x32x16_bf16 v[76:91], v[20:23], v[148:151], v[76:91]
    v_mfma_f32_32x32x16_bf16 v[92:107], v[24:27], v[148:151], v[92:107]
    v_mfma_f32_32x32x16_bf16 v[108:123], v[20:23], v[152:155], v[108:123]
    v_mfma_f32_32x32x16_bf16 v[124:139], v[24:27], v[152:155], v[124:139]
    s_barrier
    s_waitcnt vmcnt(2)
    ds_read_b128 v[172:175], v46 offset:8192
    ds_read_b128 v[176:179], v46 offset:12288
    ds_read_b128 v[180:183], v47 offset:8192
    ds_read_b128 v[184:187], v47 offset:12288
    ds_read_b128 v[188:191], v48 offset:8192
    ds_read_b128 v[192:195], v48 offset:12288
    ds_read_b128 v[196:199], v49 offset:8192
    ds_read_b128 v[200:203], v49 offset:12288
    ds_read_b64_tr_b16 v[20:21], v5 offset:32768
    ds_read_b64_tr_b16 v[22:23], v5 offset:33280
    ds_read_b64_tr_b16 v[24:25], v6 offset:32768
    ds_read_b64_tr_b16 v[26:27], v6 offset:33280
    s_waitcnt lgkmcnt(8)
    v_mfma_f32_32x32x16_bf16 v[76:91], v[28:31], v[156:159], v[76:91]
    v_mfma_f32_32x32x16_bf16 v[92:107], v[32:35], v[156:159], v[92:107]
    v_mfma_f32_32x32x16_bf16 v[108:123], v[28:31], v[160:163], v[108:123]
    v_mfma_f32_32x32x16_bf16 v[124:139], v[32:35], v[160:163], v[124:139]
    ds_read_b64_tr_b16 v[28:29], v5 offset:34816
    ds_read_b64_tr_b16 v[30:31], v5 offset:35328
    ds_read_b64_tr_b16 v[32:33], v6 offset:34816
    ds_read_b64_tr_b16 v[34:35], v6 offset:35328
    s_waitcnt lgkmcnt(8)
    v_mfma_f32_32x32x16_bf16 v[76:91], v[36:39], v[164:167], v[76:91]
    v_mfma_f32_32x32x16_bf16 v[92:107], v[40:43], v[164:167], v[92:107]
    v_mfma_f32_32x32x16_bf16 v[108:123], v[36:39], v[168:171], v[108:123]
    v_mfma_f32_32x32x16_bf16 v[124:139], v[40:43], v[168:171], v[124:139]
    ds_read_b64_tr_b16 v[36:37], v5 offset:36864
    ds_read_b64_tr_b16 v[38:39], v5 offset:37376
    ds_read_b64_tr_b16 v[40:41], v6 offset:36864
    ds_read_b64_tr_b16 v[42:43], v6 offset:37376
    s_waitcnt lgkmcnt(8)
    v_mfma_f32_32x32x16_bf16 v[76:91], v[20:23], v[172:175], v[76:91]
    s_add_u32 m0, s26, 57344
    s_add_u32 s21, s20, 0
    buffer_load_dwordx4 v2, s[16:19], s21 offen lds
    s_add_u32 m0, s26, 58368
    s_add_u32 s21, s20, 65536
    buffer_load_dwordx4 v2, s[16:19], s21 offen lds
    s_add_u32 s20, s20, 524288
    v_mfma_f32_32x32x16_bf16 v[92:107], v[24:27], v[172:175], v[92:107]
    v_mfma_f32_32x32x16_bf16 v[108:123], v[20:23], v[176:179], v[108:123]
    v_mfma_f32_32x32x16_bf16 v[124:139], v[24:27], v[176:179], v[124:139]
    ds_read_b64_tr_b16 v[20:21], v5 offset:38912
    ds_read_b64_tr_b16 v[22:23], v5 offset:39424
    ds_read_b64_tr_b16 v[24:25], v6 offset:38912
    ds_read_b64_tr_b16 v[26:27], v6 offset:39424
    s_waitcnt lgkmcnt(8)
    v_mfma_f32_32x32x16_bf16 v[76:91], v[28:31], v[180:183], v[76:91]
    v_mfma_f32_32x32x16_bf16 v[92:107], v[32:35], v[180:183], v[92:107]
    v_mfma_f32_32x32x16_bf16 v[108:123], v[28:31], v[184:187], v[108:123]
    v_mfma_f32_32x32x16_bf16 v[124:139], v[32:35], v[184:187], v[124:139]
    s_barrier
    s_waitcnt lgkmcnt(4)
    v_mfma_f32_32x32x16_bf16 v[76:91], v[36:39], v[188:191], v[76:91]
    v_mfma_f32_32x32x16_bf16 v[92:107], v[40:43], v[188:191], v[92:107]
    v_mfma_f32_32x32x16_bf16 v[108:123], v[36:39], v[192:195], v[108:123]
    v_mfma_f32_32x32x16_bf16 v[124:139], v[40:43], v[192:195], v[124:139]
    s_waitcnt lgkmcnt(0)
    v_mfma_f32_32x32x16_bf16 v[76:91], v[20:23], v[196:199], v[76:91]
    v_mfma_f32_32x32x16_bf16 v[92:107], v[24:27], v[196:199], v[92:107]
    v_mfma_f32_32x32x16_bf16 v[108:123], v[20:23], v[200:203], v[108:123]
    v_mfma_f32_32x32x16_bf16 v[124:139], v[24:27], v[200:203], v[124:139]
    s_barrier
    s_nop 7
    s_nop 3
    v_cvt_pk_bf16_f32 v44, v76, v77
    v_cvt_pk_bf16_f32 v45, v78, v79
    v_cvt_pk_bf16_f32 v46, v80, v81
    v_cvt_pk_bf16_f32 v47, v82, v83
    v_cvt_pk_bf16_f32 v48, v84, v85
    v_cvt_pk_bf16_f32 v49, v86, v87
    v_cvt_pk_bf16_f32 v50, v88, v89
    v_cvt_pk_bf16_f32 v51, v90, v91
    s_nop 1
    v_permlane32_swap_b32 v44, v46
    v_permlane32_swap_b32 v45, v47
    v_permlane32_swap_b32 v48, v50
    v_permlane32_swap_b32 v49, v51
    ds_write_b128 v14, v[44:47] offset:0
    ds_write_b128 v15, v[48:51] offset:0
    v_cvt_pk_bf16_f32 v52, v92, v93
    v_cvt_pk_bf16_f32 v53, v94, v95
    v_cvt_pk_bf16_f32 v54, v96, v97
    v_cvt_pk_bf16_f32 v55, v98, v99
    v_cvt_pk_bf16_f32 v56, v100, v101
    v_cvt_pk_bf16_f32 v57, v102, v103
    v_cvt_pk_bf16_f32 v58, v104, v105
    v_cvt_pk_bf16_f32 v59, v106, v107
    s_nop 1
    v_permlane32_swap_b32 v52, v54
    v_permlane32_swap_b32 v53, v55
    v_permlane32_swap_b32 v56, v58
    v_permlane32_swap_b32 v57, v59
    ds_write_b128 v16, v[52:55] offset:0
    ds_write_b128 v17, v[56:59] offset:0
    v_cvt_pk_bf16_f32 v60, v108, v109
    v_cvt_pk_bf16_f32 v61, v110, v111
    v_cvt_pk_bf16_f32 v62, v112, v113
    v_cvt_pk_bf16_f32 v63, v114, v115
    v_cvt_pk_bf16_f32 v64, v116, v117
    v_cvt_pk_bf16_f32 v65, v118, v119
    v_cvt_pk_bf16_f32 v66, v120, v121
    v_cvt_pk_bf16_f32 v67, v122, v123
    s_nop 1
    v_permlane32_swap_b32 v60, v62
    v_permlane32_swap_b32 v61, v63
    v_permlane32_swap_b32 v64, v66
    v_permlane32_swap_b32 v65, v67
    ds_write_b128 v14, v[60:63] offset:4096
    ds_write_b128 v15, v[64:67] offset:4096
    v_cvt_pk_bf16_f32 v68, v124, v125
    v_cvt_pk_bf16_f32 v69, v126, v127
    v_cvt_pk_bf16_f32 v70, v128, v129
    v_cvt_pk_bf16_f32 v71, v130, v131
    v_cvt_pk_bf16_f32 v72, v132, v133
    v_cvt_pk_bf16_f32 v73, v134, v135
    v_cvt_pk_bf16_f32 v74, v136, v137
    v_cvt_pk_bf16_f32 v75, v138, v139
    s_nop 1
    v_permlane32_swap_b32 v68, v70
    v_permlane32_swap_b32 v69, v71
    v_permlane32_swap_b32 v72, v74
    v_permlane32_swap_b32 v73, v75
    ds_write_b128 v16, v[68:71] offset:4096
    ds_write_b128 v17, v[72:75] offset:4096
    s_waitcnt lgkmcnt(0)
    ds_read_b128 v[44:47], v18 offset:0
    ds_read_b128 v[48:51], v18 offset:1024
    ds_read_b128 v[52:55], v18 offset:2048
    ds_read_b128 v[56:59], v18 offset:3072
    ds_read_b128 v[60:63], v18 offset:4096
    ds_read_b128 v[64:67], v18 offset:5120
    ds_read_b128 v[68:71], v18 offset:6144
    ds_read_b128 v[72:75], v18 offset:7168
    s_add_u32 s21, s90, 0
    s_waitcnt lgkmcnt(7)
    buffer_store_dwordx4 v[44:47], v7, s[4:7], s21 offen sc1
    s_add_u32 s21, s90, 66560
    s_waitcnt lgkmcnt(6)
    buffer_store_dwordx4 v[48:51], v7, s[4:7], s21 offen sc1
    s_add_u32 s21, s90, 133120
    s_waitcnt lgkmcnt(5)
    buffer_store_dwordx4 v[52:55], v7, s[4:7], s21 offen sc1
    s_add_u32 s21, s90, 199680
    s_waitcnt lgkmcnt(4)
    buffer_store_dwordx4 v[56:59], v7, s[4:7], s21 offen sc1
    s_add_u32 s21, s90, 266240
    s_waitcnt lgkmcnt(3)
    buffer_store_dwordx4 v[60:63], v7, s[4:7], s21 offen sc1
    s_add_u32 s21, s90, 332800
    s_waitcnt lgkmcnt(2)
    buffer_store_dwordx4 v[64:67], v7, s[4:7], s21 offen sc1
    s_add_u32 s21, s90, 399360
    s_waitcnt lgkmcnt(1)
    buffer_store_dwordx4 v[68:71], v7, s[4:7], s21 offen sc1
    s_add_u32 s21, s90, 465920
    s_waitcnt lgkmcnt(0)
    buffer_store_dwordx4 v[72:75], v7, s[4:7], s21 offen sc1
    s_mov_b32 s27, 0
    s_branch Lpois
Lunitv:
    s_mul_i32 s92, s92, 4224
    s_lshl_b32 s93, s93, 1
    s_add_u32 s90, s92, s93
    s_add_u32 s90, s90, 18874368
    s_cmp_lg_u32 s27, 0
    s_cbranch_scc1 Lunitvf
    ds_read_b64_tr_b16 v[20:21], v3 offset:0
    ds_read_b64_tr_b16 v[22:23], v3 offset:512
    ds_read_b64_tr_b16 v[24:25], v4 offset:0
    ds_read_b64_tr_b16 v[26:27], v4 offset:512
    ds_read_b64_tr_b16 v[28:29], v3 offset:2048
    ds_read_b64_tr_b16 v[30:31], v3 offset:2560
    ds_read_b64_tr_b16 v[32:33], v4 offset:2048
    ds_read_b64_tr_b16 v[34:35], v4 offset:2560
    ds_read_b64_tr_b16 v[36:37], v3 offset:4096
    ds_read_b64_tr_b16 v[38:39], v3 offset:4608
    ds_read_b64_tr_b16 v[40:41], v4 offset:4096
    ds_read_b64_tr_b16 v[42:43], v4 offset:4608
    s_waitcnt lgkmcnt(8)
    v_mfma_f32_32x32x16_bf16 v[76:91], a[0:3], v[20:23], 0
    s_add_u32 m0, s26, 65536
    s_add_u32 s21, s20, 0
    buffer_load_dwordx4 v2, s[16:19], s21 offen lds
    s_add_u32 m0, s26, 66560
    s_add_u32 s21, s20, 65536
    buffer_load_dwordx4 v2, s[16:19], s21 offen lds
    s_add_u32 s20, s20, 524288
    v_mfma_f32_32x32x16_bf16 v[92:107], a[0:3], v[24:27], 0
    v_mfma_f32_32x32x16_bf16 v[108:123], a[4:7], v[20:23], 0
    v_mfma_f32_32x32x16_bf16 v[124:139], a[4:7], v[24:27], 0
    ds_read_b64_tr_b16 v[20:21], v3 offset:6144
    ds_read_b64_tr_b16 v[22:23], v3 offset:6656
    ds_read_b64_tr_b16 v[24:25], v4 offset:6144
    ds_read_b64_tr_b16 v[26:27], v4 offset:6656
    s_waitcnt lgkmcnt(8)
    v_mfma_f32_32x32x16_bf16 v[76:91], a[8:11], v[28:31], v[76:91]
    v_mfma_f32_32x32x16_bf16 v[92:107], a[8:11], v[32:35], v[92:107]
    v_mfma_f32_32x32x16_bf16 v[108:123], a[12:15], v[28:31], v[108:123]
    v_mfma_f32_32x32x16_bf16 v[124:139], a[12:15], v[32:35], v[124:139]
    s_waitcnt vmcnt(22)
    s_barrier
    ds_read_b64_tr_b16 v[28:29], v3 offset:8192
    ds_read_b64_tr_b16 v[30:31], v3 offset:8704
    ds_read_b64_tr_b16 v[32:33], v4 offset:8192
    ds_read_b64_tr_b16 v[34:35], v4 offset:8704
    s_waitcnt lgkmcnt(8)
    v_mfma_f32_32x32x16_bf16 v[76:91], a[16:19], v[36:39], v[76:91]
    v_mfma_f32_32x32x16_bf16 v[92:107], a[16:19], v[40:43], v[92:107]
    v_mfma_f32_32x32x16_bf16 v[108:123], a[20:23], v[36:39], v[108:123]
    v_mfma_f32_32x32x16_bf16 v[124:139], a[20:23], v[40:43], v[124:139]
    ds_read_b64_tr_b16 v[36:37], v3 offset:10240
    ds_read_b64_tr_b16 v[38:39], v3 offset:10752
    ds_read_b64_tr_b16 v[40:41], v4 offset:10240
    ds_read_b64_tr_b16 v[42:43], v4 offset:10752
    s_waitcnt lgkmcnt(8)
    v_mfma_f32_32x32x16_bf16 v[76:91], a[24:27], v[20:23], v[76:91]
    v_mfma_f32_32x32x16_bf16 v[92:107], a[24:27], v[24:27], v[92:107]
    v_mfma_f32_32x32x16_bf16 v[108:123], a[28:31], v[20:23], v[108:123]
    v_mfma_f32_32x32x16_bf16 v[124:139], a[28:31], v[24:27], v[124:139]
    ds_read_b64_tr_b16 v[20:21], v3 offset:12288
    ds_read_b64_tr_b16 v[22:23], v3 offset:12800
    ds_read_b64_tr_b16 v[24:25], v4 offset:12288
    ds_read_b64_tr_b16 v[26:27], v4 offset:12800
    s_waitcnt lgkmcnt(8)
    v_mfma_f32_32x32x16_bf16 v[76:91], a[32:35], v[28:31], v[76:91]
    s_add_u32 m0, s26, 73728
    s_add_u32 s21, s20, 0
    buffer_load_dwordx4 v2, s[16:19], s21 offen lds
    s_add_u32 m0, s26, 74752
    s_add_u32 s21, s20, 65536
    buffer_load_dwordx4 v2, s[16:19], s21 offen lds
    s_add_u32 s20, s20, 524288
    v_mfma_f32_32x32x16_bf16 v[92:107], a[32:35], v[32:35], v[92:107]
    v_mfma_f32_32x32x16_bf16 v[108:123], a[36:39], v[28:31], v[108:123]
    v_mfma_f32_32x32x16_bf16 v[124:139], a[36:39], v[32:35], v[124:139]
    ds_read_b64_tr_b16 v[28:29], v3 offset:14336
    ds_read_b64_tr_b16 v[30:31], v3 offset:14848
    ds_read_b64_tr_b16 v[32:33], v4 offset:14336
    ds_read_b64_tr_b16 v[34:35], v4 offset:14848
    s_waitcnt lgkmcnt(8)
    v_mfma_f32_32x32x16_bf16 v[76:91], a[40:43], v[36:39], v[76:91]
    v_mfma_f32_32x32x16_bf16 v[92:107], a[40:43], v[40:43], v[92:107]
    v_mfma_f32_32x32x16_bf16 v[108:123], a[44:47], v[36:39], v[108:123]
    v_mfma_f32_32x32x16_bf16 v[124:139], a[44:47], v[40:43], v[124:139]
    s_waitcnt vmcnt(22)
    s_barrier
    ds_read_b64_tr_b16 v[36:37], v3 offset:16384
    ds_read_b64_tr_b16 v[38:39], v3 offset:16896
    ds_read_b64_tr_b16 v[40:41], v4 offset:16384
    ds_read_b64_tr_b16 v[42:43], v4 offset:16896
    s_waitcnt lgkmcnt(8)
    v_mfma_f32_32x32x16_bf16 v[76:91], a[48:51], v[20:23], v[76:91]
    v_mfma_f32_32x32x16_bf16 v[92:107], a[48:51], v[24:27], v[92:107]
    v_mfma_f32_32x32x16_bf16 v[108:123], a[52:55], v[20:23], v[108:123]
    v_mfma_f32_32x32x16_bf16 v[124:139], a[52:55], v[24:27], v[124:139]
    ds_read_b64_tr_b16 v[20:21], v3 offset:18432
    ds_read_b64_tr_b16 v[22:23], v3 offset:18944
    ds_read_b64_tr_b16 v[24:25], v4 offset:18432
    ds_read_b64_tr_b16 v[26:27], v4 offset:18944
    s_waitcnt lgkmcnt(8)
    v_mfma_f32_32x32x16_bf16 v[76:91], a[56:59], v[28:31], v[76:91]
    v_mfma_f32_32x32x16_bf16 v[92:107], a[56:59], v[32:35], v[92:107]
    v_mfma_f32_32x32x16_bf16 v[108:123], a[60:63], v[28:31], v[108:123]
    v_mfma_f32_32x32x16_bf16 v[124:139], a[60:63], v[32:35], v[124:139]
    ds_read_b64_tr_b16 v[28:29], v3 offset:20480
    ds_read_b64_tr_b16 v[30:31], v3 offset:20992
    ds_read_b64_tr_b16 v[32:33], v4 offset:20480
    ds_read_b64_tr_b16 v[34:35], v4 offset:20992
    s_waitcnt lgkmcnt(8)
    v_mfma_f32_32x32x16_bf16 v[76:91], a[64:67], v[36:39], v[76:91]
    s_add_u32 s93, s87, s86
    s_cmp_lt_u32 s93, s88
    s_cselect_b32 s93, s93, s87
    s_lshr_b32 s92, s93, 6
    s_cmp_eq_u32 s92, 0
    s_cselect_b32 s16, s46, s48
    s_cselect_b32 s17, s47, s49
    s_cmp_eq_u32 s92, 2
    s_cselect_b32 s16, s44, s16
    s_cselect_b32 s17, s45, s17
    s_and_b32 s17, s17, 0xffff
    s_and_b32 s92, s93, 63
    s_lshl_b32 s20, s92, 7
    s_add_u32 m0, s26, 0
    s_add_u32 s21, s20, 0
    buffer_load_dwordx4 v2, s[16:19], s21 offen lds
    s_add_u32 m0, s26, 1024
    s_add_u32 s21, s20, 65536
    buffer_load_dwordx4 v2, s[16:19], s21 offen lds
    s_add_u32 s20, s20, 524288
    v_mfma_f32_32x32x16_bf16 v[92:107], a[64:67], v[40:43], v[92:107]
    v_mfma_f32_32x32x16_bf16 v[108:123], a[68:71], v[36:39], v[108:123]
    v_mfma_f32_32x32x16_bf16 v[124:139], a[68:71], v[40:43], v[124:139]
    ds_read_b64_tr_b16 v[36:37], v3 offset:22528
    ds_read_b64_tr_b16 v[38:39], v3 offset:23040
    ds_read_b64_tr_b16 v[40:41], v4 offset:22528
    ds_read_b64_tr_b16 v[42:43], v4 offset:23040
    s_waitcnt lgkmcnt(8)
    v_mfma_f32_32x32x16_bf16 v[76:91], a[72:75], v[20:23], v[76:91]
    v_mfma_f32_32x32x16_bf16 v[92:107], a[72:75], v[24:27], v[92:107]
    v_mfma_f32_32x32x16_bf16 v[108:123], a[76:79], v[20:23], v[108:123]
    v_mfma_f32_32x32x16_bf16 v[124:139], a[76:79], v[24:27], v[124:139]
    s_waitcnt vmcnt(6)
    s_barrier
    s_cmp_lg_u32 s14, 0
    s_cbranch_scc1 Lsu_89
    s_cmp_ge_u32 s89, 192
    s_cbranch_scc1 Lsu_89
    s_cmp_ge_u32 s89, 128
    s_cselect_b32 s92, 0x10000, 1
    s_lshl_b32 s93, s85, 2
    s_add_u32 s93, s93, 128
    s_mov_b64 exec, 1
    v_mov_b32 v9, s92
    v_mov_b32 v10, s93
    buffer_atomic_add v9, v10, s[96:99], 0 offen sc1
    s_mov_b64 exec, -1
Lsu_89:
    ds_read_b64_tr_b16 v[20:21], v3 offset:24576
    ds_read_b64_tr_b16 v[22:23], v3 offset:25088
    ds_read_b64_tr_b16 v[24:25], v4 offset:24576
    ds_read_b64_tr_b16 v[26:27], v4 offset:25088
    s_waitcnt lgkmcnt(8)
    v_mfma_f32_32x32x16_bf16 v[76:91], a[80:83], v[28:31], v[76:91]
    v_mfma_f32_32x32x16_bf16 v[92:107], a[80:83], v[32:35], v[92:107]
    v_mfma_f32_32x32x16_bf16 v[108:123], a[84:87], v[28:31], v[108:123]
    v_mfma_f32_32x32x16_bf16 v[124:139], a[84:87], v[32:35], v[124:139]
    ds_read_b64_tr_b16 v[28:29], v3 offset:26624
    ds_read_b64_tr_b16 v[30:31], v3 offset:27136
    ds_read_b64_tr_b16 v[32:33], v4 offset:26624
    ds_read_b64_tr_b16 v[34:35], v4 offset:27136
    s_waitcnt lgkmcnt(8)
    v_mfma_f32_32x32x16_bf16 v[76:91], a[88:91], v[36:39], v[76:91]
    v_mfma_f32_32x32x16_bf16 v[92:107], a[88:91], v[40:43], v[92:107]
    v_mfma_f32_32x32x16_bf16 v[108:123], a[92:95], v[36:39], v[108:123]
    v_mfma_f32_32x32x16_bf16 v[124:139], a[92:95], v[40:43], v[124:139]
    ds_read_b64_tr_b16 v[36:37], v3 offset:28672
    ds_read_b64_tr_b16 v[38:39], v3 offset:29184
    ds_read_b64_tr_b16 v[40:41], v4 offset:28672
    ds_read_b64_tr_b16 v[42:43], v4 offset:29184
    s_waitcnt lgkmcnt(8)
    v_mfma_f32_32x32x16_bf16 v[76:91], a[96:99], v[20:23], v[76:91]
    s_add_u32 m0, s26, 8192
    s_add_u32 s21, s20, 0
    buffer_load_dwordx4 v2, s[16:19], s21 offen lds
    s_add_u32 m0, s26, 9216
    s_add_u32 s21, s20, 65536
    buffer_load_dwordx4 v2, s[16:19], s21 offen lds
    s_add_u32 s20, s20, 524288
    v_mfma_f32_32x32x16_bf16 v[92:107], a[96:99], v[24:27], v[92:107]
    v_mfma_f32_32x32x16_bf16 v[108:123], a[100:103], v[20:23], v[108:123]
    v_mfma_f32_32x32x16_bf16 v[124:139], a[100:103], v[24:27], v[124:139]
    ds_read_b64_tr_b16 v[20:21], v3 offset:30720
    ds_read_b64_tr_b16 v[22:23], v3 offset:31232
    ds_read_b64_tr_b16 v[24:25], v4 offset:30720
    ds_read_b64_tr_b16 v[26:27], v4 offset:31232
    s_waitcnt lgkmcnt(8)
    v_mfma_f32_32x32x16_bf16 v[76:91], a[104:107], v[28:31], v[76:91]
    v_mfma_f32_32x32x16_bf16 v[92:107], a[104:107], v[32:35], v[92:107]
    v_mfma_f32_32x32x16_bf16 v[108:123], a[108:111], v[28:31], v[108:123]
    v_mfma_f32_32x32x16_bf16 v[124:139], a[108:111], v[32:35], v[124:139]
    s_waitcnt vmcnt(14)
    s_barrier
    ds_read_b64_tr_b16 v[28:29], v3 offset:32768
    ds_read_b64_tr_b16 v[30:31], v3 offset:33280
    ds_read_b64_tr_b16 v[32:33], v4 offset:32768
    ds_read_b64_tr_b16 v[34:35], v4 offset:33280
    s_waitcnt lgkmcnt(8)
    v_mfma_f32_32x32x16_bf16 v[76:91], a[112:115], v[36:39], v[76:91]
    v_mfma_f32_32x32x16_bf16 v[92:107], a[112:115], v[40:43], v[92:107]
    v_mfma_f32_32x32x16_bf16 v[108:123], a[116:119], v[36:39], v[108:123]
    v_mfma_f32_32x32x16_bf16 v[124:139], a[116:119], v[40:43], v[124:139]
    ds_read_b64_tr_b16 v[36:37], v3 offset:34816
    ds_read_b64_tr_b16 v[38:39], v3 offset:35328
    ds_read_b64_tr_b16 v[40:41], v4 offset:34816
    ds_read_b64_tr_b16 v[42:43], v4 offset:35328
    s_waitcnt lgkmcnt(8)
    v_mfma_f32_32x32x16_bf16 v[76:91], a[120:123], v[20:23], v[76:91]
    v_mfma_f32_32x32x16_bf16 v[92:107], a[120:123], v[24:27], v[92:107]
    v_mfma_f32_32x32x16_bf16 v[108:123], a[124:127], v[20:23], v[108:123]
    v_mfma_f32_32x32x16_bf16 v[124:139], a[124:127], v[24:27], v[124:139]
    ds_read_b64_tr_b16 v[20:21], v3 offset:36864
    ds_read_b64_tr_b16 v[22:23], v3 offset:37376
    ds_read_b64_tr_b16 v[24:25], v4 offset:36864
    ds_read_b64_tr_b16 v[26:27], v4 offset:37376
    s_waitcnt lgkmcnt(8)
    v_mfma_f32_32x32x16_bf16 v[76:91], a[128:131], v[28:31], v[76:91]
    s_add_u32 m0, s26, 16384
    s_add_u32 s21, s20, 0
    buffer_load_dwordx4 v2, s[16:19], s21 offen lds
    s_add_u32 m0, s26, 17408
    s_add_u32 s21, s20, 65536
    buffer_load_dwordx4 v2, s[16:19], s21 offen lds
    s_add_u32 s20, s20, 524288
    v_mfma_f32_32x32x16_bf16 v[92:107], a[128:131], v[32:35], v[92:107]
    v_mfma_f32_32x32x16_bf16 v[108:123], a[132:135], v[28:31], v[108:123]
    v_mfma_f32_32x32x16_bf16 v[124:139], a[132:135], v[32:35], v[124:139]
    ds_read_b64_tr_b16 v[28:29], v3 offset:38912
    ds_read_b64_tr_b16 v[30:31], v3 offset:39424
    ds_read_b64_tr_b16 v[32:33], v4 offset:38912
    ds_read_b64_tr_b16 v[34:35], v4 offset:39424
    s_waitcnt lgkmcnt(8)
    v_mfma_f32_32x32x16_bf16 v[76:91], a[136:139], v[36:39], v[76:91]
    v_mfma_f32_32x32x16_bf16 v[92:107], a[136:139], v[40:43], v[92:107]
    v_mfma_f32_32x32x16_bf16 v[108:123], a[140:143], v[36:39], v[108:123]
    v_mfma_f32_32x32x16_bf16 v[124:139], a[140:143], v[40:43], v[124:139]
    s_waitcnt vmcnt(14)
    s_barrier
    ds_read_b64_tr_b16 v[36:37], v5 offset:0
    ds_read_b64_tr_b16 v[38:39], v5 offset:512
    ds_read_b64_tr_b16 v[40:41], v6 offset:0
    ds_read_b64_tr_b16 v[42:43], v6 offset:512
    s_waitcnt lgkmcnt(8)
    v_mfma_f32_32x32x16_bf16 v[76:91], a[144:147], v[20:23], v[76:91]
    v_mfma_f32_32x32x16_bf16 v[92:107], a[144:147], v[24:27], v[92:107]
    v_mfma_f32_32x32x16_bf16 v[108:123], a[148:151], v[20:23], v[108:123]
    v_mfma_f32_32x32x16_bf16 v[124:139], a[148:151], v[24:27], v[124:139]
    ds_read_b64_tr_b16 v[20:21], v5 offset:2048
    ds_read_b64_tr_b16 v[22:23], v5 offset:2560
    ds_read_b64_tr_b16 v[24:25], v6 offset:2048
    ds_read_b64_tr_b16 v[26:27], v6 offset:2560
    s_waitcnt lgkmcnt(8)
    v_mfma_f32_32x32x16_bf16 v[76:91], a[152:155], v[28:31], v[76:91]
    v_mfma_f32_32x32x16_bf16 v[92:107], a[152:155], v[32:35], v[92:107]
    v_mfma_f32_32x32x16_bf16 v[108:123], a[156:159], v[28:31], v[108:123]
    v_mfma_f32_32x32x16_bf16 v[124:139], a[156:159], v[32:35], v[124:139]
    ds_read_b64_tr_b16 v[28:29], v5 offset:4096
    ds_read_b64_tr_b16 v[30:31], v5 offset:4608
    ds_read_b64_tr_b16 v[32:33], v6 offset:4096
    ds_read_b64_tr_b16 v[34:35], v6 offset:4608
    s_waitcnt lgkmcnt(8)
    v_mfma_f32_32x32x16_bf16 v[76:91], a[160:163], v[36:39], v[76:91]
    s_add_u32 m0, s26, 24576
    s_add_u32 s21, s20, 0
    buffer_load_dwordx4 v2, s[16:19], s21 offen lds
    s_add_u32 m0, s26, 25600
    s_add_u32 s21, s20, 65536
    buffer_load_dwordx4 v2, s[16:19], s21 offen lds
    s_add_u32 s20, s20, 524288
    v_mfma_f32_32x32x16_bf16 v[92:107], a[160:163], v[40:43], v[92:107]
    v_mfma_f32_32x32x16_bf16 v[108:123], a[164:167], v[36:39], v[108:123]
    v_mfma_f32_32x32x16_bf16 v[124:139], a[164:167], v[40:43], v[124:139]
    ds_read_b64_tr_b16 v[36:37], v5 offset:6144
    ds_read_b64_tr_b16 v[38:39], v5 offset:6656
    ds_read_b64_tr_b16 v[40:41], v6 offset:6144
    ds_read_b64_tr_b16 v[42:43], v6 offset:6656
    s_waitcnt lgkmcnt(8)
    v_mfma_f32_32x32x16_bf16 v[76:91], a[168:171], v[20:23], v[76:91]
    v_mfma_f32_32x32x16_bf16 v[92:107], a[168:171], v[24:27], v[92:107]
    v_mfma_f32_32x32x16_bf16 v[108:123], a[172:175], v[20:23], v[108:123]
    v_mfma_f32_32x32x16_bf16 v[124:139], a[172:175], v[24:27], v[124:139]
    s_waitcnt vmcnt(14)
    s_barrier
    ds_read_b64_tr_b16 v[20:21], v5 offset:8192
    ds_read_b64_tr_b16 v[22:23], v5 offset:8704
    ds_read_b64_tr_b16 v[24:25], v6 offset:8192
    ds_read_b64_tr_b16 v[26:27], v6 offset:8704
    s_waitcnt lgkmcnt(8)
    v_mfma_f32_32x32x16_bf16 v[76:91], a[176:179], v[28:31], v[76:91]
    v_mfma_f32_32x32x16_bf16 v[92:107], a[176:179], v[32:35], v[92:107]
    v_mfma_f32_32x32x16_bf16 v[108:123], a[180:183], v[28:31], v[108:123]
    v_mfma_f32_32x32x16_bf16 v[124:139], a[180:183], v[32:35], v[124:139]
    ds_read_b64_tr_b16 v[28:29], v5 offset:10240
    ds_read_b64_tr_b16 v[30:31], v5 offset:10752
    ds_read_b64_tr_b16 v[32:33], v6 offset:10240
    ds_read_b64_tr_b16 v[34:35], v6 offset:10752
    s_waitcnt lgkmcnt(8)
    v_mfma_f32_32x32x16_bf16 v[76:91], a[184:187], v[36:39], v[76:91]
    v_mfma_f32_32x32x16_bf16 v[92:107], a[184:187], v[40:43], v[92:107]
    v_mfma_f32_32x32x16_bf16 v[108:123], a[188:191], v[36:39], v[108:123]
    v_mfma_f32_32x32x16_bf16 v[124:139], a[188:191], v[40:43], v[124:139]
    ds_read_b64_tr_b16 v[36:37], v5 offset:12288
    ds_read_b64_tr_b16 v[38:39], v5 offset:12800
    ds_read_b64_tr_b16 v[40:41], v6 offset:12288
    ds_read_b64_tr_b16 v[42:43], v6 offset:12800
    s_waitcnt lgkmcnt(8)
    v_mfma_f32_32x32x16_bf16 v[76:91], a[192:195], v[20:23], v[76:91]
    s_add_u32 m0, s26, 32768
    s_add_u32 s21, s20, 0
    buffer_load_dwordx4 v2, s[16:19], s21 offen lds
    s_add_u32 m0, s26, 33792
    s_add_u32 s21, s20, 65536
    buffer_load_dwordx4 v2, s[16:19], s21 offen lds
    s_add_u32 s20, s20, 524288
    v_mfma_f32_32x32x16_bf16 v[92:107], a[192:195], v[24:27], v[92:107]
    v_mfma_f32_32x32x16_bf16 v[108:123], a[196:199], v[20:23], v[108:123]
    v_mfma_f32_32x32x16_bf16 v[124:139], a[196:199], v[24:27], v[124:139]
    ds_read_b64_tr_b16 v[20:21], v5 offset:14336
    ds_read_b64_tr_b16 v[22:23], v5 offset:14848
    ds_read_b64_tr_b16 v[24:25], v6 offset:14336
    ds_read_b64_tr_b16 v[26:27], v6 offset:14848
    s_waitcnt lgkmcnt(8)
    v_mfma_f32_32x32x16_bf16 v[76:91], a[200:203], v[28:31], v[76:91]
    v_mfma_f32_32x32x16_bf16 v[92:107], a[200:203], v[32:35], v[92:107]
    v_mfma_f32_32x32x16_bf16 v[108:123], a[204:207], v[28:31], v[108:123]
    v_mfma_f32_32x32x16_bf16 v[124:139], a[204:207], v[32:35], v[124:139]
    s_waitcnt vmcnt(14)
    s_barrier
    ds_read_b64_tr_b16 v[28:29], v5 offset:16384
    ds_read_b64_tr_b16 v[30:31], v5 offset:16896
    ds_read_b64_tr_b16 v[32:33], v6 offset:16384
    ds_read_b64_tr_b16 v[34:35], v6 offset:16896
    s_waitcnt lgkmcnt(8)
    v_mfma_f32_32x32x16_bf16 v[76:91], a[208:211], v[36:39], v[76:91]
    v_mfma_f32_32x32x16_bf16 v[92:107], a[208:211], v[40:43], v[92:107]
    v_mfma_f32_32x32x16_bf16 v[108:123], a[212:215], v[36:39], v[108:123]
    v_mfma_f32_32x32x16_bf16 v[124:139], a[212:215], v[40:43], v[124:139]
    ds_read_b64_tr_b16 v[36:37], v5 offset:18432
    ds_read_b64_tr_b16 v[38:39], v5 offset:18944
    ds_read_b64_tr_b16 v[40:41], v6 offset:18432
    ds_read_b64_tr_b16 v[42:43], v6 offset:18944
    s_waitcnt lgkmcnt(8)
    v_mfma_f32_32x32x16_bf16 v[76:91], a[216:219], v[20:23], v[76:91]
    v_mfma_f32_32x32x16_bf16 v[92:107], a[216:219], v[24:27], v[92:107]
    v_mfma_f32_32x32x16_bf16 v[108:123], a[220:223], v[20:23], v[108:123]
    v_mfma_f32_32x32x16_bf16 v[124:139], a[220:223], v[24:27], v[124:139]
    ds_read_b64_tr_b16 v[20:21], v5 offset:20480
    ds_read_b64_tr_b16 v[22:23], v5 offset:20992
    ds_read_b64_tr_b16 v[24:25], v6 offset:20480
    ds_read_b64_tr_b16 v[26:27], v6 offset:20992
    s_waitcnt lgkmcnt(8)
    v_mfma_f32_32x32x16_bf16 v[76:91], a[224:227], v[28:31], v[76:91]
    s_add_u32 m0, s26, 40960
    s_add_u32 s21, s20, 0
    buffer_load_dwordx4 v2, s[16:19], s21 offen lds
    s_add_u32 m0, s26, 41984
    s_add_u32 s21, s20, 65536
    buffer_load_dwordx4 v2, s[16:19], s21 offen lds
    s_add_u32 s20, s20, 524288
    v_mfma_f32_32x32x16_bf16 v[92:107], a[224:227], v[32:35], v[92:107]
    v_mfma_f32_32x32x16_bf16 v[108:123], a[228:231], v[28:31], v[108:123]
    v_mfma_f32_32x32x16_bf16 v[124:139], a[228:231], v[32:35], v[124:139]
    ds_read_b64_tr_b16 v[28:29], v5 offset:22528
    ds_read_b64_tr_b16 v[30:31], v5 offset:23040
    ds_read_b64_tr_b16 v[32:33], v6 offset:22528
    ds_read_b64_tr_b16 v[34:35], v6 offset:23040
    s_waitcnt lgkmcnt(8)
    v_mfma_f32_32x32x16_bf16 v[76:91], a[232:235], v[36:39], v[76:91]
    v_mfma_f32_32x32x16_bf16 v[92:107], a[232:235], v[40:43], v[92:107]
    v_mfma_f32_32x32x16_bf16 v[108:123], a[236:239], v[36:39], v[108:123]
    v_mfma_f32_32x32x16_bf16 v[124:139], a[236:239], v[40:43], v[124:139]
    s_waitcnt vmcnt(14)
    s_barrier
    ds_read_b64_tr_b16 v[36:37], v5 offset:24576
    ds_read_b64_tr_b16 v[38:39], v5 offset:25088
    ds_read_b64_tr_b16 v[40:41], v6 offset:24576
    ds_read_b64_tr_b16 v[42:43], v6 offset:25088
    s_waitcnt lgkmcnt(8)
    v_mfma_f32_32x32x16_bf16 v[76:91], a[240:243], v[20:23], v[76:91]
    v_mfma_f32_32x32x16_bf16 v[92:107], a[240:243], v[24:27], v[92:107]
    v_mfma_f32_32x32x16_bf16 v[108:123], a[244:247], v[20:23], v[108:123]
    v_mfma_f32_32x32x16_bf16 v[124:139], a[244:247], v[24:27], v[124:139]
    ds_read_b64_tr_b16 v[20:21], v5 offset:26624
    ds_read_b64_tr_b16 v[22:23], v5 offset:27136
    ds_read_b64_tr_b16 v[24:25], v6 offset:26624
    ds_read_b64_tr_b16 v[26:27], v6 offset:27136
    s_waitcnt lgkmcnt(8)
    v_mfma_f32_32x32x16_bf16 v[76:91], a[248:251], v[28:31], v[76:91]
    v_mfma_f32_32x32x16_bf16 v[92:107], a[248:251], v[32:35], v[92:107]
    v_mfma_f32_32x32x16_bf16 v[108:123], a[252:255], v[28:31], v[108:123]
    v_mfma_f32_32x32x16_bf16 v[124:139], a[252:255], v[32:35], v[124:139]
    ds_read_b64_tr_b16 v[28:29], v5 offset:28672
    ds_read_b64_tr_b16 v[30:31], v5 offset:29184
    ds_read_b64_tr_b16 v[32:33], v6 offset:28672
    ds_read_b64_tr_b16 v[34:35], v6 offset:29184
    s_waitcnt lgkmcnt(8)
    v_mfma_f32_32x32x16_bf16 v[76:91], v[140:143], v[36:39], v[76:91]
    s_add_u32 m0, s26, 49152
    s_add_u32 s21, s20, 0
    buffer_load_dwordx4 v2, s[16:19], s21 offen lds
    s_add_u32 m0, s26, 50176
    s_add_u32 s21, s20, 65536
    buffer_load_dwordx4 v2, s[16:19], s21 offen lds
    s_add_u32 s20, s20, 524288
    v_mfma_f32_32x32x16_bf16 v[92:107], v[140:143], v[40:43], v[92:107]
    v_mfma_f32_32x32x16_bf16 v[108:123], v[144:147], v[36:39], v[108:123]
    v_mfma_f32_32x32x16_bf16 v[124:139], v[144:147], v[40:43], v[124:139]
    ds_read_b64_tr_b16 v[36:37], v5 offset:30720
    ds_read_b64_tr_b16 v[38:39], v5 offset:31232
    ds_read_b64_tr_b16 v[40:41], v6 offset:30720
    ds_read_b64_tr_b16 v[42:43], v6 offset:31232
    s_waitcnt lgkmcnt(8)
    v_mfma_f32_32x32x16_bf16 v[76:91], v[148:151], v[20:23], v[76:91]
    v_mfma_f32_32x32x16_bf16 v[92:107], v[148:151], v[24:27], v[92:107]
    v_mfma_f32_32x32x16_bf16 v[108:123], v[152:155], v[20:23], v[108:123]
    v_mfma_f32_32x32x16_bf16 v[124:139], v[152:155], v[24:27], v[124:139]
    s_waitcnt vmcnt(14)
    s_barrier
    ds_read_b64_tr_b16 v[20:21], v5 offset:32768
    ds_read_b64_tr_b16 v[22:23], v5 offset:33280
    ds_read_b64_tr_b16 v[24:25], v6 offset:32768
    ds_read_b64_tr_b16 v[26:27], v6 offset:33280
    s_waitcnt lgkmcnt(8)
    v_mfma_f32_32x32x16_bf16 v[76:91], v[156:159], v[28:31], v[76:91]
    v_mfma_f32_32x32x16_bf16 v[92:107], v[156:159], v[32:35], v[92:107]
    v_mfma_f32_32x32x16_bf16 v[108:123], v[160:163], v[28:31], v[108:123]
    v_mfma_f32_32x32x16_bf16 v[124:139], v[160:163], v[32:35], v[124:139]
    ds_read_b64_tr_b16 v[28:29], v5 offset:34816
    ds_read_b64_tr_b16 v[30:31], v5 offset:35328
    ds_read_b64_tr_b16 v[32:33], v6 offset:34816
    ds_read_b64_tr_b16 v[34:35], v6 offset:35328
    s_waitcnt lgkmcnt(8)
    v_mfma_f32_32x32x16_bf16 v[76:91], v[164:167], v[36:39], v[76:91]
    v_mfma_f32_32x32x16_bf16 v[92:107], v[164:167], v[40:43], v[92:107]
    v_mfma_f32_32x32x16_bf16 v[108:123], v[168:171], v[36:39], v[108:123]
    v_mfma_f32_32x32x16_bf16 v[124:139], v[168:171], v[40:43], v[124:139]
    ds_read_b64_tr_b16 v[36:37], v5 offset:36864
    ds_read_b64_tr_b16 v[38:39], v5 offset:37376
    ds_read_b64_tr_b16 v[40:41], v6 offset:36864
    ds_read_b64_tr_b16 v[42:43], v6 offset:37376
    s_waitcnt lgkmcnt(8)
    v_mfma_f32_32x32x16_bf16 v[76:91], v[172:175], v[20:23], v[76:91]
    s_add_u32 m0, s26, 57344
    s_add_u32 s21, s20, 0
    buffer_load_dwordx4 v2, s[16:19], s21 offen lds
    s_add_u32 m0, s26, 58368
    s_add_u32 s21, s20, 65536
    buffer_load_dwordx4 v2, s[16:19], s21 offen lds
    s_add_u32 s20, s20, 524288
    v_mfma_f32_32x32x16_bf16 v[92:107], v[172:175], v[24:27], v[92:107]
    v_mfma_f32_32x32x16_bf16 v[108:123], v[176:179], v[20:23], v[108:123]
    v_mfma_f32_32x32x16_bf16 v[124:139], v[176:179], v[24:27], v[124:139]
    ds_read_b64_tr_b16 v[20:21], v5 offset:38912
    ds_read_b64_tr_b16 v[22:23], v5 offset:39424
    ds_read_b64_tr_b16 v[24:25], v6 offset:38912
    ds_read_b64_tr_b16 v[26:27], v6 offset:39424
    s_waitcnt lgkmcnt(8)
    v_mfma_f32_32x32x16_bf16 v[76:91], v[180:183], v[28:31], v[76:91]
    v_mfma_f32_32x32x16_bf16 v[92:107], v[180:183], v[32:35], v[92:107]
    v_mfma_f32_32x32x16_bf16 v[108:123], v[184:187], v[28:31], v[108:123]
    v_mfma_f32_32x32x16_bf16 v[124:139], v[184:187], v[32:35], v[124:139]
    s_waitcnt vmcnt(14)
    s_barrier
    s_waitcnt lgkmcnt(4)
    v_mfma_f32_32x32x16_bf16 v[76:91], v[188:191], v[36:39], v[76:91]
    v_mfma_f32_32x32x16_bf16 v[92:107], v[188:191], v[40:43], v[92:107]
    v_mfma_f32_32x32x16_bf16 v[108:123], v[192:195], v[36:39], v[108:123]
    v_mfma_f32_32x32x16_bf16 v[124:139], v[192:195], v[40:43], v[124:139]
    s_waitcnt lgkmcnt(0)
    v_mfma_f32_32x32x16_bf16 v[76:91], v[196:199], v[20:23], v[76:91]
    v_mfma_f32_32x32x16_bf16 v[92:107], v[196:199], v[24:27], v[92:107]
    v_mfma_f32_32x32x16_bf16 v[108:123], v[200:203], v[20:23], v[108:123]
    v_mfma_f32_32x32x16_bf16 v[124:139], v[200:203], v[24:27], v[124:139]
    s_nop 7
    s_nop 3
    v_cvt_pk_bf16_f32 v44, v76, v77
    v_cvt_pk_bf16_f32 v45, v78, v79
    v_cvt_pk_bf16_f32 v46, v80, v81
    v_cvt_pk_bf16_f32 v47, v82, v83
    v_cvt_pk_bf16_f32 v48, v84, v85
    v_cvt_pk_bf16_f32 v49, v86, v87
    v_cvt_pk_bf16_f32 v50, v88, v89
    v_cvt_pk_bf16_f32 v51, v90, v91
    s_nop 1
    v_permlane32_swap_b32 v44, v46
    v_permlane32_swap_b32 v45, v47
    v_permlane32_swap_b32 v48, v50
    v_permlane32_swap_b32 v49, v51
    ds_write_b128 v14, v[44:47] offset:0
    ds_write_b128 v15, v[48:51] offset:0
    v_cvt_pk_bf16_f32 v52, v92, v93
    v_cvt_pk_bf16_f32 v53, v94, v95
    v_cvt_pk_bf16_f32 v54, v96, v97
    v_cvt_pk_bf16_f32 v55, v98, v99
    v_cvt_pk_bf16_f32 v56, v100, v101
    v_cvt_pk_bf16_f32 v57, v102, v103
    v_cvt_pk_bf16_f32 v58, v104, v105
    v_cvt_pk_bf16_f32 v59, v106, v107
    s_nop 1
    v_permlane32_swap_b32 v52, v54
    v_permlane32_swap_b32 v53, v55
    v_permlane32_swap_b32 v56, v58
    v_permlane32_swap_b32 v57, v59
    ds_write_b128 v14, v[52:55] offset:4096
    ds_write_b128 v15, v[56:59] offset:4096
    v_cvt_pk_bf16_f32 v60, v108, v109
    v_cvt_pk_bf16_f32 v61, v110, v111
    v_cvt_pk_bf16_f32 v62, v112, v113
    v_cvt_pk_bf16_f32 v63, v114, v115
    v_cvt_pk_bf16_f32 v64, v116, v117
    v_cvt_pk_bf16_f32 v65, v118, v119
    v_cvt_pk_bf16_f32 v66, v120, v121
    v_cvt_pk_bf16_f32 v67, v122, v123
    s_nop 1
    v_permlane32_swap_b32 v60, v62
    v_permlane32_swap_b32 v61, v63
    v_permlane32_swap_b32 v64, v66
    v_permlane32_swap_b32 v65, v67
    ds_write_b128 v16, v[60:63] offset:0
    ds_write_b128 v17, v[64:67] offset:0
    v_cvt_pk_bf16_f32 v68, v124, v125
    v_cvt_pk_bf16_f32 v69, v126, v127
    v_cvt_pk_bf16_f32 v70, v128, v129
    v_cvt_pk_bf16_f32 v71, v130, v131
    v_cvt_pk_bf16_f32 v72, v132, v133
    v_cvt_pk_bf16_f32 v73, v134, v135
    v_cvt_pk_bf16_f32 v74, v136, v137
    v_cvt_pk_bf16_f32 v75, v138, v139
    s_nop 1
    v_permlane32_swap_b32 v68, v70
    v_permlane32_swap_b32 v69, v71
    v_permlane32_swap_b32 v72, v74
    v_permlane32_swap_b32 v73, v75
    ds_write_b128 v16, v[68:71] offset:4096
    ds_write_b128 v17, v[72:75] offset:4096
    s_waitcnt lgkmcnt(0)
    ds_read_b128 v[44:47], v18 offset:0
    ds_read_b128 v[48:51], v18 offset:1024
    ds_read_b128 v[52:55], v18 offset:2048
    ds_read_b128 v[56:59], v18 offset:3072
    ds_read_b128 v[60:63], v18 offset:4096
    ds_read_b128 v[64:67], v18 offset:5120
    ds_read_b128 v[68:71], v18 offset:6144
    ds_read_b128 v[72:75], v18 offset:7168
    s_add_u32 s21, s90, 0
    s_waitcnt lgkmcnt(7)
    buffer_store_dwordx4 v[44:47], v8, s[4:7], s21 offen sc1
    s_add_u32 s21, s90, 33792
    s_waitcnt lgkmcnt(6)
    buffer_store_dwordx4 v[48:51], v8, s[4:7], s21 offen sc1
    s_add_u32 s21, s90, 67584
    s_waitcnt lgkmcnt(5)
    buffer_store_dwordx4 v[52:55], v8, s[4:7], s21 offen sc1
    s_add_u32 s21, s90, 101376
    s_waitcnt lgkmcnt(4)
    buffer_store_dwordx4 v[56:59], v8, s[4:7], s21 offen sc1
    s_add_u32 s21, s90, 135168
    s_waitcnt lgkmcnt(3)
    buffer_store_dwordx4 v[60:63], v8, s[4:7], s21 offen sc1
    s_add_u32 s21, s90, 168960
    s_waitcnt lgkmcnt(2)
    buffer_store_dwordx4 v[64:67], v8, s[4:7], s21 offen sc1
    s_add_u32 s21, s90, 202752
    s_waitcnt lgkmcnt(1)
    buffer_store_dwordx4 v[68:71], v8, s[4:7], s21 offen sc1
    s_add_u32 s21, s90, 236544
    s_waitcnt lgkmcnt(0)
    buffer_store_dwordx4 v[72:75], v8, s[4:7], s21 offen sc1
    s_branch Lunitd
Lunitvf:
    s_waitcnt vmcnt(8)
    s_barrier
    ds_read_b128 a[0:3], v46 offset:0
    ds_read_b128 a[4:7], v46 offset:4096
    ds_read_b128 a[8:11], v47 offset:0
    ds_read_b128 a[12:15], v47 offset:4096
    ds_read_b128 a[16:19], v48 offset:0
    ds_read_b128 a[20:23], v48 offset:4096
    ds_read_b128 a[24:27], v49 offset:0
    ds_read_b128 a[28:31], v49 offset:4096
    s_waitcnt lgkmcnt(0)
    ds_read_b64_tr_b16 v[20:21], v3 offset:0
    ds_read_b64_tr_b16 v[22:23], v3 offset:512
    ds_read_b64_tr_b16 v[24:25], v4 offset:0
    ds_read_b64_tr_b16 v[26:27], v4 offset:512
    ds_read_b64_tr_b16 v[28:29], v3 offset:2048
    ds_read_b64_tr_b16 v[30:31], v3 offset:2560
    ds_read_b64_tr_b16 v[32:33], v4 offset:2048
    ds_read_b64_tr_b16 v[34:35], v4 offset:2560
    ds_read_b64_tr_b16 v[36:37], v3 offset:4096
    ds_read_b64_tr_b16 v[38:39], v3 offset:4608
    ds_read_b64_tr_b16 v[40:41], v4 offset:4096
    ds_read_b64_tr_b16 v[42:43], v4 offset:4608
    s_waitcnt lgkmcnt(8)
    v_mfma_f32_32x32x16_bf16 v[76:91], a[0:3], v[20:23], 0
    s_add_u32 m0, s26, 65536
    s_add_u32 s21, s20, 0
    buffer_load_dwordx4 v2, s[16:19], s21 offen lds
    s_add_u32 m0, s26, 66560
    s_add_u32 s21, s20, 65536
    buffer_load_dwordx4 v2, s[16:19], s21 offen lds
    s_add_u32 s20, s20, 524288
    s_add_u32 m0, s23, 0
    s_add_u32 s21, s22, 256
    buffer_load_dwordx4 v44, s[8:11], s21 offen lds
    s_add_u32 m0, s23, 1024
    s_add_u32 s21, s22, 10496
    buffer_load_dwordx4 v45, s[8:11], s21 offen lds
    s_add_u32 m0, s23, 2048
    s_add_u32 s21, s22, 20736
    buffer_load_dwordx4 v44, s[8:11], s21 offen lds
    s_add_u32 m0, s23, 3072
    s_add_u32 s21, s22, 30976
    buffer_load_dwordx4 v45, s[8:11], s21 offen lds
    s_add_u32 m0, s23, 4096
    s_add_u32 s21, s22, 41216
    buffer_load_dwordx4 v44, s[8:11], s21 offen lds
    s_add_u32 m0, s23, 5120
    s_add_u32 s21, s22, 51456
    buffer_load_dwordx4 v45, s[8:11], s21 offen lds
    s_add_u32 m0, s23, 6144
    s_add_u32 s21, s22, 61696
    buffer_load_dwordx4 v44, s[8:11], s21 offen lds
    s_add_u32 m0, s23, 7168
    s_add_u32 s21, s22, 71936
    buffer_load_dwordx4 v45, s[8:11], s21 offen lds
    v_mfma_f32_32x32x16_bf16 v[92:107], a[0:3], v[24:27], 0
    v_mfma_f32_32x32x16_bf16 v[108:123], a[4:7], v[20:23], 0
    v_mfma_f32_32x32x16_bf16 v[124:139], a[4:7], v[24:27], 0
    ds_read_b64_tr_b16 v[20:21], v3 offset:6144
    ds_read_b64_tr_b16 v[22:23], v3 offset:6656
    ds_read_b64_tr_b16 v[24:25], v4 offset:6144
    ds_read_b64_tr_b16 v[26:27], v4 offset:6656
    s_waitcnt lgkmcnt(8)
    v_mfma_f32_32x32x16_bf16 v[76:91], a[8:11], v[28:31], v[76:91]
    v_mfma_f32_32x32x16_bf16 v[92:107], a[8:11], v[32:35], v[92:107]
    v_mfma_f32_32x32x16_bf16 v[108:123], a[12:15], v[28:31], v[108:123]
    v_mfma_f32_32x32x16_bf16 v[124:139], a[12:15], v[32:35], v[124:139]
    s_barrier
    s_waitcnt vmcnt(10)
    ds_read_b128 a[32:35], v46 offset:8192
    ds_read_b128 a[36:39], v46 offset:12288
    ds_read_b128 a[40:43], v47 offset:8192
    ds_read_b128 a[44:47], v47 offset:12288
    ds_read_b128 a[48:51], v48 offset:8192
    ds_read_b128 a[52:55], v48 offset:12288
    ds_read_b128 a[56:59], v49 offset:8192
    ds_read_b128 a[60:63], v49 offset:12288
    ds_read_b64_tr_b16 v[28:29], v3 offset:8192
    ds_read_b64_tr_b16 v[30:31], v3 offset:8704
    ds_read_b64_tr_b16 v[32:33], v4 offset:8192
    ds_read_b64_tr_b16 v[34:35], v4 offset:8704
    s_waitcnt lgkmcnt(8)
    v_mfma_f32_32x32x16_bf16 v[76:91], a[16:19], v[36:39], v[76:91]
    v_mfma_f32_32x32x16_bf16 v[92:107], a[16:19], v[40:43], v[92:107]
    v_mfma_f32_32x32x16_bf16 v[108:123], a[20:23], v[36:39], v[108:123]
    v_mfma_f32_32x32x16_bf16 v[124:139], a[20:23], v[40:43], v[124:139]
    ds_read_b64_tr_b16 v[36:37], v3 offset:10240
    ds_read_b64_tr_b16 v[38:39], v3 offset:10752
    ds_read_b64_tr_b16 v[40:41], v4 offset:10240
    ds_read_b64_tr_b16 v[42:43], v4 offset:10752
    s_waitcnt lgkmcnt(8)
    v_mfma_f32_32x32x16_bf16 v[76:91], a[24:27], v[20:23], v[76:91]
    v_mfma_f32_32x32x16_bf16 v[92:107], a[24:27], v[24:27], v[92:107]
    v_mfma_f32_32x32x16_bf16 v[108:123], a[28:31], v[20:23], v[108:123]
    v_mfma_f32_32x32x16_bf16 v[124:139], a[28:31], v[24:27], v[124:139]
    ds_read_b64_tr_b16 v[20:21], v3 offset:12288
    ds_read_b64_tr_b16 v[22:23], v3 offset:12800
    ds_read_b64_tr_b16 v[24:25], v4 offset:12288
    ds_read_b64_tr_b16 v[26:27], v4 offset:12800
    s_waitcnt lgkmcnt(8)
    v_mfma_f32_32x32x16_bf16 v[76:91], a[32:35], v[28:31], v[76:91]
    s_add_u32 m0, s26, 73728
    s_add_u32 s21, s20, 0
    buffer_load_dwordx4 v2, s[16:19], s21 offen lds
    s_add_u32 m0, s26, 74752
    s_add_u32 s21, s20, 65536
    buffer_load_dwordx4 v2, s[16:19], s21 offen lds
    s_add_u32 s20, s20, 524288
    s_add_u32 m0, s23, 8192
    s_add_u32 s21, s22, 384
    buffer_load_dwordx4 v44, s[8:11], s21 offen lds
    s_add_u32 m0, s23, 9216
    s_add_u32 s21, s22, 10624
    buffer_load_dwordx4 v45, s[8:11], s21 offen lds
    s_add_u32 m0, s23, 10240
    s_add_u32 s21, s22, 20864
    buffer_load_dwordx4 v44, s[8:11], s21 offen lds
    s_add_u32 m0, s23, 11264
    s_add_u32 s21, s22, 31104
    buffer_load_dwordx4 v45, s[8:11], s21 offen lds
    s_add_u32 m0, s23, 12288
    s_add_u32 s21, s22, 41344
    buffer_load_dwordx4 v44, s[8:11], s21 offen lds
    s_add_u32 m0, s23, 13312
    s_add_u32 s21, s22, 51584
    buffer_load_dwordx4 v45, s[8:11], s21 offen lds
    s_add_u32 m0, s23, 14336
    s_add_u32 s21, s22, 61824
    buffer_load_dwordx4 v44, s[8:11], s21 offen lds
    s_add_u32 m0, s23, 15360
    s_add_u32 s21, s22, 72064
    buffer_load_dwordx4 v45, s[8:11], s21 offen lds
    v_mfma_f32_32x32x16_bf16 v[92:107], a[32:35], v[32:35], v[92:107]
    v_mfma_f32_32x32x16_bf16 v[108:123], a[36:39], v[28:31], v[108:123]
    v_mfma_f32_32x32x16_bf16 v[124:139], a[36:39], v[32:35], v[124:139]
    ds_read_b64_tr_b16 v[28:29], v3 offset:14336
    ds_read_b64_tr_b16 v[30:31], v3 offset:14848
    ds_read_b64_tr_b16 v[32:33], v4 offset:14336
    ds_read_b64_tr_b16 v[34:35], v4 offset:14848
    s_waitcnt lgkmcnt(8)
    v_mfma_f32_32x32x16_bf16 v[76:91], a[40:43], v[36:39], v[76:91]
    v_mfma_f32_32x32x16_bf16 v[92:107], a[40:43], v[40:43], v[92:107]
    v_mfma_f32_32x32x16_bf16 v[108:123], a[44:47], v[36:39], v[108:123]
    v_mfma_f32_32x32x16_bf16 v[124:139], a[44:47], v[40:43], v[124:139]
    s_barrier
    s_waitcnt vmcnt(10)
    ds_read_b128 a[64:67], v46 offset:0
    ds_read_b128 a[68:71], v46 offset:4096
    ds_read_b128 a[72:75], v47 offset:0
    ds_read_b128 a[76:79], v47 offset:4096
    ds_read_b128 a[80:83], v48 offset:0
    ds_read_b128 a[84:87], v48 offset:4096
    ds_read_b128 a[88:91], v49 offset:0
    ds_read_b128 a[92:95], v49 offset:4096
    ds_read_b64_tr_b16 v[36:37], v3 offset:16384
    ds_read_b64_tr_b16 v[38:39], v3 offset:16896
    ds_read_b64_tr_b16 v[40:41], v4 offset:16384
    ds_read_b64_tr_b16 v[42:43], v4 offset:16896
    s_waitcnt lgkmcnt(8)
    v_mfma_f32_32x32x16_bf16 v[76:91], a[48:51], v[20:23], v[76:91]
    v_mfma_f32_32x32x16_bf16 v[92:107], a[48:51], v[24:27], v[92:107]
    v_mfma_f32_32x32x16_bf16 v[108:123], a[52:55], v[20:23], v[108:123]
    v_mfma_f32_32x32x16_bf16 v[124:139], a[52:55], v[24:27], v[124:139]
    ds_read_b64_tr_b16 v[20:21], v3 offset:18432
    ds_read_b64_tr_b16 v[22:23], v3 offset:18944
    ds_read_b64_tr_b16 v[24:25], v4 offset:18432
    ds_read_b64_tr_b16 v[26:27], v4 offset:18944
    s_waitcnt lgkmcnt(8)
    v_mfma_f32_32x32x16_bf16 v[76:91], a[56:59], v[28:31], v[76:91]
    v_mfma_f32_32x32x16_bf16 v[92:107], a[56:59], v[32:35], v[92:107]
    v_mfma_f32_32x32x16_bf16 v[108:123], a[60:63], v[28:31], v[108:123]
    v_mfma_f32_32x32x16_bf16 v[124:139], a[60:63], v[32:35], v[124:139]
    ds_read_b64_tr_b16 v[28:29], v3 offset:20480
    ds_read_b64_tr_b16 v[30:31], v3 offset:20992
    ds_read_b64_tr_b16 v[32:33], v4 offset:20480
    ds_read_b64_tr_b16 v[34:35], v4 offset:20992
    s_waitcnt lgkmcnt(8)
    v_mfma_f32_32x32x16_bf16 v[76:91], a[64:67], v[36:39], v[76:91]
    s_add_u32 s93, s87, s86
    s_cmp_lt_u32 s93, s88
    s_cselect_b32 s93, s93, s87
    s_lshr_b32 s92, s93, 6
    s_cmp_eq_u32 s92, 0
    s_cselect_b32 s16, s46, s48
    s_cselect_b32 s17, s47, s49
    s_cmp_eq_u32 s92, 2
    s_cselect_b32 s16, s44, s16
    s_cselect_b32 s17, s45, s17
    s_and_b32 s17, s17, 0xffff
    s_and_b32 s92, s93, 63
    s_lshl_b32 s20, s92, 7
    s_add_u32 m0, s26, 0
    s_add_u32 s21, s20, 0
    buffer_load_dwordx4 v2, s[16:19], s21 offen lds
    s_add_u32 m0, s26, 1024
    s_add_u32 s21, s20, 65536
    buffer_load_dwordx4 v2, s[16:19], s21 offen lds
    s_add_u32 s20, s20, 524288
    s_add_u32 m0, s23, 0
    s_add_u32 s21, s22, 512
    buffer_load_dwordx4 v44, s[8:11], s21 offen lds
    s_add_u32 m0, s23, 1024
    s_add_u32 s21, s22, 10752
    buffer_load_dwordx4 v45, s[8:11], s21 offen lds
    s_add_u32 m0, s23, 2048
    s_add_u32 s21, s22, 20992
    buffer_load_dwordx4 v44, s[8:11], s21 offen lds
    s_add_u32 m0, s23, 3072
    s_add_u32 s21, s22, 31232
    buffer_load_dwordx4 v45, s[8:11], s21 offen lds
    s_add_u32 m0, s23, 4096
    s_add_u32 s21, s22, 41472
    buffer_load_dwordx4 v44, s[8:11], s21 offen lds
    s_add_u32 m0, s23, 5120
    s_add_u32 s21, s22, 51712
    buffer_load_dwordx4 v45, s[8:11], s21 offen lds
    s_add_u32 m0, s23, 6144
    s_add_u32 s21, s22, 61952
    buffer_load_dwordx4 v44, s[8:11], s21 offen lds
    s_add_u32 m0, s23, 7168
    s_add_u32 s21, s22, 72192
    buffer_load_dwordx4 v45, s[8:11], s21 offen lds
    v_mfma_f32_32x32x16_bf16 v[92:107], a[64:67], v[40:43], v[92:107]
    v_mfma_f32_32x32x16_bf16 v[108:123], a[68:71], v[36:39], v[108:123]
    v_mfma_f32_32x32x16_bf16 v[124:139], a[68:71], v[40:43], v[124:139]
    ds_read_b64_tr_b16 v[36:37], v3 offset:22528
    ds_read_b64_tr_b16 v[38:39], v3 offset:23040
    ds_read_b64_tr_b16 v[40:41], v4 offset:22528
    ds_read_b64_tr_b16 v[42:43], v4 offset:23040
    s_waitcnt lgkmcnt(8)
    v_mfma_f32_32x32x16_bf16 v[76:91], a[72:75], v[20:23], v[76:91]
    v_mfma_f32_32x32x16_bf16 v[92:107], a[72:75], v[24:27], v[92:107]
    v_mfma_f32_32x32x16_bf16 v[108:123], a[76:79], v[20:23], v[108:123]
    v_mfma_f32_32x32x16_bf16 v[124:139], a[76:79], v[24:27], v[124:139]
    s_barrier
    s_waitcnt vmcnt(10)
    ds_read_b128 a[96:99], v46 offset:8192
    ds_read_b128 a[100:103], v46 offset:12288
    ds_read_b128 a[104:107], v47 offset:8192
    ds_read_b128 a[108:111], v47 offset:12288
    ds_read_b128 a[112:115], v48 offset:8192
    ds_read_b128 a[116:119], v48 offset:12288
    ds_read_b128 a[120:123], v49 offset:8192
    ds_read_b128 a[124:127], v49 offset:12288
    ds_read_b64_tr_b16 v[20:21], v3 offset:24576
    ds_read_b64_tr_b16 v[22:23], v3 offset:25088
    ds_read_b64_tr_b16 v[24:25], v4 offset:24576
    ds_read_b64_tr_b16 v[26:27], v4 offset:25088
    s_waitcnt lgkmcnt(8)
    v_mfma_f32_32x32x16_bf16 v[76:91], a[80:83], v[28:31], v[76:91]
    v_mfma_f32_32x32x16_bf16 v[92:107], a[80:83], v[32:35], v[92:107]
    v_mfma_f32_32x32x16_bf16 v[108:123], a[84:87], v[28:31], v[108:123]
    v_mfma_f32_32x32x16_bf16 v[124:139], a[84:87], v[32:35], v[124:139]
    ds_read_b64_tr_b16 v[28:29], v3 offset:26624
    ds_read_b64_tr_b16 v[30:31], v3 offset:27136
    ds_read_b64_tr_b16 v[32:33], v4 offset:26624
    ds_read_b64_tr_b16 v[34:35], v4 offset:27136
    s_waitcnt lgkmcnt(8)
    v_mfma_f32_32x32x16_bf16 v[76:91], a[88:91], v[36:39], v[76:91]
    v_mfma_f32_32x32x16_bf16 v[92:107], a[88:91], v[40:43], v[92:107]
    v_mfma_f32_32x32x16_bf16 v[108:123], a[92:95], v[36:39], v[108:123]
    v_mfma_f32_32x32x16_bf16 v[124:139], a[92:95], v[40:43], v[124:139]
    ds_read_b64_tr_b16 v[36:37], v3 offset:28672
    ds_read_b64_tr_b16 v[38:39], v3 offset:29184
    ds_read_b64_tr_b16 v[40:41], v4 offset:28672
    ds_read_b64_tr_b16 v[42:43], v4 offset:29184
    s_waitcnt lgkmcnt(8)
    v_mfma_f32_32x32x16_bf16 v[76:91], a[96:99], v[20:23], v[76:91]
    s_add_u32 m0, s26, 8192
    s_add_u32 s21, s20, 0
    buffer_load_dwordx4 v2, s[16:19], s21 offen lds
    s_add_u32 m0, s26, 9216
    s_add_u32 s21, s20, 65536
    buffer_load_dwordx4 v2, s[16:19], s21 offen lds
    s_add_u32 s20, s20, 524288
    s_add_u32 m0, s23, 8192
    s_add_u32 s21, s22, 640
    buffer_load_dwordx4 v44, s[8:11], s21 offen lds
    s_add_u32 m0, s23, 9216
    s_add_u32 s21, s22, 10880
    buffer_load_dwordx4 v45, s[8:11], s21 offen lds
    s_add_u32 m0, s23, 10240
    s_add_u32 s21, s22, 21120
    buffer_load_dwordx4 v44, s[8:11], s21 offen lds
    s_add_u32 m0, s23, 11264
    s_add_u32 s21, s22, 31360
    buffer_load_dwordx4 v45, s[8:11], s21 offen lds
    s_add_u32 m0, s23, 12288
    s_add_u32 s21, s22, 41600
    buffer_load_dwordx4 v44, s[8:11], s21 offen lds
    s_add_u32 m0, s23, 13312
    s_add_u32 s21, s22, 51840
    buffer_load_dwordx4 v45, s[8:11], s21 offen lds
    s_add_u32 m0, s23, 14336
    s_add_u32 s21, s22, 62080
    buffer_load_dwordx4 v44, s[8:11], s21 offen lds
    s_add_u32 m0, s23, 15360
    s_add_u32 s21, s22, 72320
    buffer_load_dwordx4 v45, s[8:11], s21 offen lds
    v_mfma_f32_32x32x16_bf16 v[92:107], a[96:99], v[24:27], v[92:107]
    v_mfma_f32_32x32x16_bf16 v[108:123], a[100:103], v[20:23], v[108:123]
    v_mfma_f32_32x32x16_bf16 v[124:139], a[100:103], v[24:27], v[124:139]
    ds_read_b64_tr_b16 v[20:21], v3 offset:30720
    ds_read_b64_tr_b16 v[22:23], v3 offset:31232
    ds_read_b64_tr_b16 v[24:25], v4 offset:30720
    ds_read_b64_tr_b16 v[26:27], v4 offset:31232
    s_waitcnt lgkmcnt(8)
    v_mfma_f32_32x32x16_bf16 v[76:91], a[104:107], v[28:31], v[76:91]
    v_mfma_f32_32x32x16_bf16 v[92:107], a[104:107], v[32:35], v[92:107]
    v_mfma_f32_32x32x16_bf16 v[108:123], a[108:111], v[28:31], v[108:123]
    v_mfma_f32_32x32x16_bf16 v[124:139], a[108:111], v[32:35], v[124:139]
    s_barrier
    s_waitcnt vmcnt(10)
    ds_read_b128 a[128:131], v46 offset:0
    ds_read_b128 a[132:135], v46 offset:4096
    ds_read_b128 a[136:139], v47 offset:0
    ds_read_b128 a[140:143], v47 offset:4096
    ds_read_b128 a[144:147], v48 offset:0
    ds_read_b128 a[148:151], v48 offset:4096
    ds_read_b128 a[152:155], v49 offset:0
    ds_read_b128 a[156:159], v49 offset:4096
    ds_read_b64_tr_b16 v[28:29], v3 offset:32768
    ds_read_b64_tr_b16 v[30:31], v3 offset:33280
    ds_read_b64_tr_b16 v[32:33], v4 offset:32768
    ds_read_b64_tr_b16 v[34:35], v4 offset:33280
    s_waitcnt lgkmcnt(8)
    v_mfma_f32_32x32x16_bf16 v[76:91], a[112:115], v[36:39], v[76:91]
    v_mfma_f32_32x32x16_bf16 v[92:107], a[112:115], v[40:43], v[92:107]
    v_mfma_f32_32x32x16_bf16 v[108:123], a[116:119], v[36:39], v[108:123]
    v_mfma_f32_32x32x16_bf16 v[124:139], a[116:119], v[40:43], v[124:139]
    ds_read_b64_tr_b16 v[36:37], v3 offset:34816
    ds_read_b64_tr_b16 v[38:39], v3 offset:35328
    ds_read_b64_tr_b16 v[40:41], v4 offset:34816
    ds_read_b64_tr_b16 v[42:43], v4 offset:35328
    s_waitcnt lgkmcnt(8)
    v_mfma_f32_32x32x16_bf16 v[76:91], a[120:123], v[20:23], v[76:91]
    v_mfma_f32_32x32x16_bf16 v[92:107], a[120:123], v[24:27], v[92:107]
    v_mfma_f32_32x32x16_bf16 v[108:123], a[124:127], v[20:23], v[108:123]
    v_mfma_f32_32x32x16_bf16 v[124:139], a[124:127], v[24:27], v[124:139]
    ds_read_b64_tr_b16 v[20:21], v3 offset:36864
    ds_read_b64_tr_b16 v[22:23], v3 offset:37376
    ds_read_b64_tr_b16 v[24:25], v4 offset:36864
    ds_read_b64_tr_b16 v[26:27], v4 offset:37376
    s_waitcnt lgkmcnt(8)
    v_mfma_f32_32x32x16_bf16 v[76:91], a[128:131], v[28:31], v[76:91]
    s_add_u32 m0, s26, 16384
    s_add_u32 s21, s20, 0
    buffer_load_dwordx4 v2, s[16:19], s21 offen lds
    s_add_u32 m0, s26, 17408
    s_add_u32 s21, s20, 65536
    buffer_load_dwordx4 v2, s[16:19], s21 offen lds
    s_add_u32 s20, s20, 524288
    s_add_u32 m0, s23, 0
    s_add_u32 s21, s22, 768
    buffer_load_dwordx4 v44, s[8:11], s21 offen lds
    s_add_u32 m0, s23, 1024
    s_add_u32 s21, s22, 11008
    buffer_load_dwordx4 v45, s[8:11], s21 offen lds
    s_add_u32 m0, s23, 2048
    s_add_u32 s21, s22, 21248
    buffer_load_dwordx4 v44, s[8:11], s21 offen lds
    s_add_u32 m0, s23, 3072
    s_add_u32 s21, s22, 31488
    buffer_load_dwordx4 v45, s[8:11], s21 offen lds
    s_add_u32 m0, s23, 4096
    s_add_u32 s21, s22, 41728
    buffer_load_dwordx4 v44, s[8:11], s21 offen lds
    s_add_u32 m0, s23, 5120
    s_add_u32 s21, s22, 51968
    buffer_load_dwordx4 v45, s[8:11], s21 offen lds
    s_add_u32 m0, s23, 6144
    s_add_u32 s21, s22, 62208
    buffer_load_dwordx4 v44, s[8:11], s21 offen lds
    s_add_u32 m0, s23, 7168
    s_add_u32 s21, s22, 72448
    buffer_load_dwordx4 v45, s[8:11], s21 offen lds
    v_mfma_f32_32x32x16_bf16 v[92:107], a[128:131], v[32:35], v[92:107]
    v_mfma_f32_32x32x16_bf16 v[108:123], a[132:135], v[28:31], v[108:123]
    v_mfma_f32_32x32x16_bf16 v[124:139], a[132:135], v[32:35], v[124:139]
    ds_read_b64_tr_b16 v[28:29], v3 offset:38912
    ds_read_b64_tr_b16 v[30:31], v3 offset:39424
    ds_read_b64_tr_b16 v[32:33], v4 offset:38912
    ds_read_b64_tr_b16 v[34:35], v4 offset:39424
    s_waitcnt lgkmcnt(8)
    v_mfma_f32_32x32x16_bf16 v[76:91], a[136:139], v[36:39], v[76:91]
    v_mfma_f32_32x32x16_bf16 v[92:107], a[136:139], v[40:43], v[92:107]
    v_mfma_f32_32x32x16_bf16 v[108:123], a[140:143], v[36:39], v[108:123]
    v_mfma_f32_32x32x16_bf16 v[124:139], a[140:143], v[40:43], v[124:139]
    s_barrier
    s_waitcnt vmcnt(10)
    ds_read_b128 a[160:163], v46 offset:8192
    ds_read_b128 a[164:167], v46 offset:12288
    ds_read_b128 a[168:171], v47 offset:8192
    ds_read_b128 a[172:175], v47 offset:12288
    ds_read_b128 a[176:179], v48 offset:8192
    ds_read_b128 a[180:183], v48 offset:12288
    ds_read_b128 a[184:187], v49 offset:8192
    ds_read_b128 a[188:191], v49 offset:12288
    ds_read_b64_tr_b16 v[36:37], v5 offset:0
    ds_read_b64_tr_b16 v[38:39], v5 offset:512
    ds_read_b64_tr_b16 v[40:41], v6 offset:0
    ds_read_b64_tr_b16 v[42:43], v6 offset:512
    s_waitcnt lgkmcnt(8)
    v_mfma_f32_32x32x16_bf16 v[76:91], a[144:147], v[20:23], v[76:91]
    v_mfma_f32_32x32x16_bf16 v[92:107], a[144:147], v[24:27], v[92:107]
    v_mfma_f32_32x32x16_bf16 v[108:123], a[148:151], v[20:23], v[108:123]
    v_mfma_f32_32x32x16_bf16 v[124:139], a[148:151], v[24:27], v[124:139]
    ds_read_b64_tr_b16 v[20:21], v5 offset:2048
    ds_read_b64_tr_b16 v[22:23], v5 offset:2560
    ds_read_b64_tr_b16 v[24:25], v6 offset:2048
    ds_read_b64_tr_b16 v[26:27], v6 offset:2560
    s_waitcnt lgkmcnt(8)
    v_mfma_f32_32x32x16_bf16 v[76:91], a[152:155], v[28:31], v[76:91]
    v_mfma_f32_32x32x16_bf16 v[92:107], a[152:155], v[32:35], v[92:107]
    v_mfma_f32_32x32x16_bf16 v[108:123], a[156:159], v[28:31], v[108:123]
    v_mfma_f32_32x32x16_bf16 v[124:139], a[156:159], v[32:35], v[124:139]
    ds_read_b64_tr_b16 v[28:29], v5 offset:4096
    ds_read_b64_tr_b16 v[30:31], v5 offset:4608
    ds_read_b64_tr_b16 v[32:33], v6 offset:4096
    ds_read_b64_tr_b16 v[34:35], v6 offset:4608
    s_waitcnt lgkmcnt(8)
    v_mfma_f32_32x32x16_bf16 v[76:91], a[160:163], v[36:39], v[76:91]
    s_add_u32 m0, s26, 24576
    s_add_u32 s21, s20, 0
    buffer_load_dwordx4 v2, s[16:19], s21 offen lds
    s_add_u32 m0, s26, 25600
    s_add_u32 s21, s20, 65536
    buffer_load_dwordx4 v2, s[16:19], s21 offen lds
    s_add_u32 s20, s20, 524288
    s_add_u32 m0, s23, 8192
    s_add_u32 s21, s22, 896
    buffer_load_dwordx4 v44, s[8:11], s21 offen lds
    s_add_u32 m0, s23, 9216
    s_add_u32 s21, s22, 11136
    buffer_load_dwordx4 v45, s[8:11], s21 offen lds
    s_add_u32 m0, s23, 10240
    s_add_u32 s21, s22, 21376
    buffer_load_dwordx4 v44, s[8:11], s21 offen lds
    s_add_u32 m0, s23, 11264
    s_add_u32 s21, s22, 31616
    buffer_load_dwordx4 v45, s[8:11], s21 offen lds
    s_add_u32 m0, s23, 12288
    s_add_u32 s21, s22, 41856
    buffer_load_dwordx4 v44, s[8:11], s21 offen lds
    s_add_u32 m0, s23, 13312
    s_add_u32 s21, s22, 52096
    buffer_load_dwordx4 v45, s[8:11], s21 offen lds
    s_add_u32 m0, s23, 14336
    s_add_u32 s21, s22, 62336
    buffer_load_dwordx4 v44, s[8:11], s21 offen lds
    s_add_u32 m0, s23, 15360
    s_add_u32 s21, s22, 72576
    buffer_load_dwordx4 v45, s[8:11], s21 offen lds
    v_mfma_f32_32x32x16_bf16 v[92:107], a[160:163], v[40:43], v[92:107]
    v_mfma_f32_32x32x16_bf16 v[108:123], a[164:167], v[36:39], v[108:123]
    v_mfma_f32_32x32x16_bf16 v[124:139], a[164:167], v[40:43], v[124:139]
    ds_read_b64_tr_b16 v[36:37], v5 offset:6144
    ds_read_b64_tr_b16 v[38:39], v5 offset:6656
    ds_read_b64_tr_b16 v[40:41], v6 offset:6144
    ds_read_b64_tr_b16 v[42:43], v6 offset:6656
    s_waitcnt lgkmcnt(8)
    v_mfma_f32_32x32x16_bf16 v[76:91], a[168:171], v[20:23], v[76:91]
    v_mfma_f32_32x32x16_bf16 v[92:107], a[168:171], v[24:27], v[92:107]
    v_mfma_f32_32x32x16_bf16 v[108:123], a[172:175], v[20:23], v[108:123]
    v_mfma_f32_32x32x16_bf16 v[124:139], a[172:175], v[24:27], v[124:139]
    s_barrier
    s_waitcnt vmcnt(10)
    ds_read_b128 a[192:195], v46 offset:0
    ds_read_b128 a[196:199], v46 offset:4096
    ds_read_b128 a[200:203], v47 offset:0
    ds_read_b128 a[204:207], v47 offset:4096
    ds_read_b128 a[208:211], v48 offset:0
    ds_read_b128 a[212:215], v48 offset:4096
    ds_read_b128 a[216:219], v49 offset:0
    ds_read_b128 a[220:223], v49 offset:4096
    ds_read_b64_tr_b16 v[20:21], v5 offset:8192
    ds_read_b64_tr_b16 v[22:23], v5 offset:8704
    ds_read_b64_tr_b16 v[24:25], v6 offset:8192
    ds_read_b64_tr_b16 v[26:27], v6 offset:8704
    s_waitcnt lgkmcnt(8)
    v_mfma_f32_32x32x16_bf16 v[76:91], a[176:179], v[28:31], v[76:91]
    v_mfma_f32_32x32x16_bf16 v[92:107], a[176:179], v[32:35], v[92:107]
    v_mfma_f32_32x32x16_bf16 v[108:123], a[180:183], v[28:31], v[108:123]
    v_mfma_f32_32x32x16_bf16 v[124:139], a[180:183], v[32:35], v[124:139]
    ds_read_b64_tr_b16 v[28:29], v5 offset:10240
    ds_read_b64_tr_b16 v[30:31], v5 offset:10752
    ds_read_b64_tr_b16 v[32:33], v6 offset:10240
    ds_read_b64_tr_b16 v[34:35], v6 offset:10752
    s_waitcnt lgkmcnt(8)
    v_mfma_f32_32x32x16_bf16 v[76:91], a[184:187], v[36:39], v[76:91]
    v_mfma_f32_32x32x16_bf16 v[92:107], a[184:187], v[40:43], v[92:107]
    v_mfma_f32_32x32x16_bf16 v[108:123], a[188:191], v[36:39], v[108:123]
    v_mfma_f32_32x32x16_bf16 v[124:139], a[188:191], v[40:43], v[124:139]
    ds_read_b64_tr_b16 v[36:37], v5 offset:12288
    ds_read_b64_tr_b16 v[38:39], v5 offset:12800
    ds_read_b64_tr_b16 v[40:41], v6 offset:12288
    ds_read_b64_tr_b16 v[42:43], v6 offset:12800
    s_waitcnt lgkmcnt(8)
    v_mfma_f32_32x32x16_bf16 v[76:91], a[192:195], v[20:23], v[76:91]
    s_add_u32 m0, s26, 32768
    s_add_u32 s21, s20, 0
    buffer_load_dwordx4 v2, s[16:19], s21 offen lds
    s_add_u32 m0, s26, 33792
    s_add_u32 s21, s20, 65536
    buffer_load_dwordx4 v2, s[16:19], s21 offen lds
    s_add_u32 s20, s20, 524288
    s_add_u32 m0, s23, 0
    s_add_u32 s21, s22, 1024
    buffer_load_dwordx4 v44, s[8:11], s21 offen lds
    s_add_u32 m0, s23, 1024
    s_add_u32 s21, s22, 11264
    buffer_load_dwordx4 v45, s[8:11], s21 offen lds
    s_add_u32 m0, s23, 2048
    s_add_u32 s21, s22, 21504
    buffer_load_dwordx4 v44, s[8:11], s21 offen lds
    s_add_u32 m0, s23, 3072
    s_add_u32 s21, s22, 31744
    buffer_load_dwordx4 v45, s[8:11], s21 offen lds
    s_add_u32 m0, s23, 4096
    s_add_u32 s21, s22, 41984
    buffer_load_dwordx4 v44, s[8:11], s21 offen lds
    s_add_u32 m0, s23, 5120
    s_add_u32 s21, s22, 52224
    buffer_load_dwordx4 v45, s[8:11], s21 offen lds
    s_add_u32 m0, s23, 6144
    s_add_u32 s21, s22, 62464
    buffer_load_dwordx4 v44, s[8:11], s21 offen lds
    s_add_u32 m0, s23, 7168
    s_add_u32 s21, s22, 72704
    buffer_load_dwordx4 v45, s[8:11], s21 offen lds
    v_mfma_f32_32x32x16_bf16 v[92:107], a[192:195], v[24:27], v[92:107]
    v_mfma_f32_32x32x16_bf16 v[108:123], a[196:199], v[20:23], v[108:123]
    v_mfma_f32_32x32x16_bf16 v[124:139], a[196:199], v[24:27], v[124:139]
    ds_read_b64_tr_b16 v[20:21], v5 offset:14336
    ds_read_b64_tr_b16 v[22:23], v5 offset:14848
    ds_read_b64_tr_b16 v[24:25], v6 offset:14336
    ds_read_b64_tr_b16 v[26:27], v6 offset:14848
    s_waitcnt lgkmcnt(8)
    v_mfma_f32_32x32x16_bf16 v[76:91], a[200:203], v[28:31], v[76:91]
    v_mfma_f32_32x32x16_bf16 v[92:107], a[200:203], v[32:35], v[92:107]
    v_mfma_f32_32x32x16_bf16 v[108:123], a[204:207], v[28:31], v[108:123]
    v_mfma_f32_32x32x16_bf16 v[124:139], a[204:207], v[32:35], v[124:139]
    s_barrier
    s_waitcnt vmcnt(10)
    ds_read_b128 a[224:227], v46 offset:8192
    ds_read_b128 a[228:231], v46 offset:12288
    ds_read_b128 a[232:235], v47 offset:8192
    ds_read_b128 a[236:239], v47 offset:12288
    ds_read_b128 a[240:243], v48 offset:8192
    ds_read_b128 a[244:247], v48 offset:12288
    ds_read_b128 a[248:251], v49 offset:8192
    ds_read_b128 a[252:255], v49 offset:12288
    ds_read_b64_tr_b16 v[28:29], v5 offset:16384
    ds_read_b64_tr_b16 v[30:31], v5 offset:16896
    ds_read_b64_tr_b16 v[32:33], v6 offset:16384
    ds_read_b64_tr_b16 v[34:35], v6 offset:16896
    s_waitcnt lgkmcnt(8)
    v_mfma_f32_32x32x16_bf16 v[76:91], a[208:211], v[36:39], v[76:91]
    v_mfma_f32_32x32x16_bf16 v[92:107], a[208:211], v[40:43], v[92:107]
    v_mfma_f32_32x32x16_bf16 v[108:123], a[212:215], v[36:39], v[108:123]
    v_mfma_f32_32x32x16_bf16 v[124:139], a[212:215], v[40:43], v[124:139]
    ds_read_b64_tr_b16 v[36:37], v5 offset:18432
    ds_read_b64_tr_b16 v[38:39], v5 offset:18944
    ds_read_b64_tr_b16 v[40:41], v6 offset:18432
    ds_read_b64_tr_b16 v[42:43], v6 offset:18944
    s_waitcnt lgkmcnt(8)
    v_mfma_f32_32x32x16_bf16 v[76:91], a[216:219], v[20:23], v[76:91]
    v_mfma_f32_32x32x16_bf16 v[92:107], a[216:219], v[24:27], v[92:107]
    v_mfma_f32_32x32x16_bf16 v[108:123], a[220:223], v[20:23], v[108:123]
    v_mfma_f32_32x32x16_bf16 v[124:139], a[220:223], v[24:27], v[124:139]
    ds_read_b64_tr_b16 v[20:21], v5 offset:20480
    ds_read_b64_tr_b16 v[22:23], v5 offset:20992
    ds_read_b64_tr_b16 v[24:25], v6 offset:20480
    ds_read_b64_tr_b16 v[26:27], v6 offset:20992
    s_waitcnt lgkmcnt(8)
    v_mfma_f32_32x32x16_bf16 v[76:91], a[224:227], v[28:31], v[76:91]
    s_add_u32 m0, s26, 40960
    s_add_u32 s21, s20, 0
    buffer_load_dwordx4 v2, s[16:19], s21 offen lds
    s_add_u32 m0, s26, 41984
    s_add_u32 s21, s20, 65536
    buffer_load_dwordx4 v2, s[16:19], s21 offen lds
    s_add_u32 s20, s20, 524288
    s_add_u32 m0, s23, 8192
    s_add_u32 s21, s22, 1152
    buffer_load_dwordx4 v44, s[8:11], s21 offen lds
    s_add_u32 m0, s23, 9216
    s_add_u32 s21, s22, 11392
    buffer_load_dwordx4 v45, s[8:11], s21 offen lds
    s_add_u32 m0, s23, 10240
    s_add_u32 s21, s22, 21632
    buffer_load_dwordx4 v44, s[8:11], s21 offen lds
    s_add_u32 m0, s23, 11264
    s_add_u32 s21, s22, 31872
    buffer_load_dwordx4 v45, s[8:11], s21 offen lds
    s_add_u32 m0, s23, 12288
    s_add_u32 s21, s22, 42112
    buffer_load_dwordx4 v44, s[8:11], s21 offen lds
    s_add_u32 m0, s23, 13312
    s_add_u32 s21, s22, 52352
    buffer_load_dwordx4 v45, s[8:11], s21 offen lds
    s_add_u32 m0, s23, 14336
    s_add_u32 s21, s22, 62592
    buffer_load_dwordx4 v44, s[8:11], s21 offen lds
    s_add_u32 m0, s23, 15360
    s_add_u32 s21, s22, 72832
    buffer_load_dwordx4 v45, s[8:11], s21 offen lds
    v_mfma_f32_32x32x16_bf16 v[92:107], a[224:227], v[32:35], v[92:107]
    v_mfma_f32_32x32x16_bf16 v[108:123], a[228:231], v[28:31], v[108:123]
    v_mfma_f32_32x32x16_bf16 v[124:139], a[228:231], v[32:35], v[124:139]
    ds_read_b64_tr_b16 v[28:29], v5 offset:22528
    ds_read_b64_tr_b16 v[30:31], v5 offset:23040
    ds_read_b64_tr_b16 v[32:33], v6 offset:22528
    ds_read_b64_tr_b16 v[34:35], v6 offset:23040
    s_waitcnt lgkmcnt(8)
    v_mfma_f32_32x32x16_bf16 v[76:91], a[232:235], v[36:39], v[76:91]
    v_mfma_f32_32x32x16_bf16 v[92:107], a[232:235], v[40:43], v[92:107]
    v_mfma_f32_32x32x16_bf16 v[108:123], a[236:239], v[36:39], v[108:123]
    v_mfma_f32_32x32x16_bf16 v[124:139], a[236:239], v[40:43], v[124:139]
    s_barrier
    s_waitcnt vmcnt(10)
    ds_read_b128 v[140:143], v46 offset:0
    ds_read_b128 v[144:147], v46 offset:4096
    ds_read_b128 v[148:151], v47 offset:0
    ds_read_b128 v[152:155], v47 offset:4096
    ds_read_b128 v[156:159], v48 offset:0
    ds_read_b128 v[160:163], v48 offset:4096
    ds_read_b128 v[164:167], v49 offset:0
    ds_read_b128 v[168:171], v49 offset:4096
    ds_read_b64_tr_b16 v[36:37], v5 offset:24576
    ds_read_b64_tr_b16 v[38:39], v5 offset:25088
    ds_read_b64_tr_b16 v[40:41], v6 offset:24576
    ds_read_b64_tr_b16 v[42:43], v6 offset:25088
    s_waitcnt lgkmcnt(8)
    v_mfma_f32_32x32x16_bf16 v[76:91], a[240:243], v[20:23], v[76:91]
    v_mfma_f32_32x32x16_bf16 v[92:107], a[240:243], v[24:27], v[92:107]
    v_mfma_f32_32x32x16_bf16 v[108:123], a[244:247], v[20:23], v[108:123]
    v_mfma_f32_32x32x16_bf16 v[124:139], a[244:247], v[24:27], v[124:139]
    ds_read_b64_tr_b16 v[20:21], v5 offset:26624
    ds_read_b64_tr_b16 v[22:23], v5 offset:27136
    ds_read_b64_tr_b16 v[24:25], v6 offset:26624
    ds_read_b64_tr_b16 v[26:27], v6 offset:27136
    s_waitcnt lgkmcnt(8)
    v_mfma_f32_32x32x16_bf16 v[76:91], a[248:251], v[28:31], v[76:91]
    v_mfma_f32_32x32x16_bf16 v[92:107], a[248:251], v[32:35], v[92:107]
    v_mfma_f32_32x32x16_bf16 v[108:123], a[252:255], v[28:31], v[108:123]
    v_mfma_f32_32x32x16_bf16 v[124:139], a[252:255], v[32:35], v[124:139]
    ds_read_b64_tr_b16 v[28:29], v5 offset:28672
    ds_read_b64_tr_b16 v[30:31], v5 offset:29184
    ds_read_b64_tr_b16 v[32:33], v6 offset:28672
    ds_read_b64_tr_b16 v[34:35], v6 offset:29184
    s_waitcnt lgkmcnt(8)
    v_mfma_f32_32x32x16_bf16 v[76:91], v[140:143], v[36:39], v[76:91]
    s_add_u32 m0, s26, 49152
    s_add_u32 s21, s20, 0
    buffer_load_dwordx4 v2, s[16:19], s21 offen lds
    s_add_u32 m0, s26, 50176
    s_add_u32 s21, s20, 65536
    buffer_load_dwordx4 v2, s[16:19], s21 offen lds
    s_add_u32 s20, s20, 524288
    v_mfma_f32_32x32x16_bf16 v[92:107], v[140:143], v[40:43], v[92:107]
    v_mfma_f32_32x32x16_bf16 v[108:123], v[144:147], v[36:39], v[108:123]
    v_mfma_f32_32x32x16_bf16 v[124:139], v[144:147], v[40:43], v[124:139]
    ds_read_b64_tr_b16 v[36:37], v5 offset:30720
    ds_read_b64_tr_b16 v[38:39], v5 offset:31232
    ds_read_b64_tr_b16 v[40:41], v6 offset:30720
    ds_read_b64_tr_b16 v[42:43], v6 offset:31232
    s_waitcnt lgkmcnt(8)
    v_mfma_f32_32x32x16_bf16 v[76:91], v[148:151], v[20:23], v[76:91]
    v_mfma_f32_32x32x16_bf16 v[92:107], v[148:151], v[24:27], v[92:107]
    v_mfma_f32_32x32x16_bf16 v[108:123], v[152:155], v[20:23], v[108:123]
    v_mfma_f32_32x32x16_bf16 v[124:139], v[152:155], v[24:27], v[124:139]
    s_barrier
    s_waitcnt vmcnt(2)
    ds_read_b128 v[172:175], v46 offset:8192
    ds_read_b128 v[176:179], v46 offset:12288
    ds_read_b128 v[180:183], v47 offset:8192
    ds_read_b128 v[184:187], v47 offset:12288
    ds_read_b128 v[188:191], v48 offset:8192
    ds_read_b128 v[192:195], v48 offset:12288
    ds_read_b128 v[196:199], v49 offset:8192
    ds_read_b128 v[200:203], v49 offset:12288
    ds_read_b64_tr_b16 v[20:21], v5 offset:32768
    ds_read_b64_tr_b16 v[22:23], v5 offset:33280
    ds_read_b64_tr_b16 v[24:25], v6 offset:32768
    ds_read_b64_tr_b16 v[26:27], v6 offset:33280
    s_waitcnt lgkmcnt(8)
    v_mfma_f32_32x32x16_bf16 v[76:91], v[156:159], v[28:31], v[76:91]
    v_mfma_f32_32x32x16_bf16 v[92:107], v[156:159], v[32:35], v[92:107]
    v_mfma_f32_32x32x16_bf16 v[108:123], v[160:163], v[28:31], v[108:123]
    v_mfma_f32_32x32x16_bf16 v[124:139], v[160:163], v[32:35], v[124:139]
    ds_read_b64_tr_b16 v[28:29], v5 offset:34816
    ds_read_b64_tr_b16 v[30:31], v5 offset:35328
    ds_read_b64_tr_b16 v[32:33], v6 offset:34816
    ds_read_b64_tr_b16 v[34:35], v6 offset:35328
    s_waitcnt lgkmcnt(8)
    v_mfma_f32_32x32x16_bf16 v[76:91], v[164:167], v[36:39], v[76:91]
    v_mfma_f32_32x32x16_bf16 v[92:107], v[164:167], v[40:43], v[92:107]
    v_mfma_f32_32x32x16_bf16 v[108:123], v[168:171], v[36:39], v[108:123]
    v_mfma_f32_32x32x16_bf16 v[124:139], v[168:171], v[40:43], v[124:139]
    ds_read_b64_tr_b16 v[36:37], v5 offset:36864
    ds_read_b64_tr_b16 v[38:39], v5 offset:37376
    ds_read_b64_tr_b16 v[40:41], v6 offset:36864
    ds_read_b64_tr_b16 v[42:43], v6 offset:37376
    s_waitcnt lgkmcnt(8)
    v_mfma_f32_32x32x16_bf16 v[76:91], v[172:175], v[20:23], v[76:91]
    s_add_u32 m0, s26, 57344
    s_add_u32 s21, s20, 0
    buffer_load_dwordx4 v2, s[16:19], s21 offen lds
    s_add_u32 m0, s26, 58368
    s_add_u32 s21, s20, 65536
    buffer_load_dwordx4 v2, s[16:19], s21 offen lds
    s_add_u32 s20, s20, 524288
    v_mfma_f32_32x32x16_bf16 v[92:107], v[172:175], v[24:27], v[92:107]
    v_mfma_f32_32x32x16_bf16 v[108:123], v[176:179], v[20:23], v[108:123]
    v_mfma_f32_32x32x16_bf16 v[124:139], v[176:179], v[24:27], v[124:139]
    ds_read_b64_tr_b16 v[20:21], v5 offset:38912
    ds_read_b64_tr_b16 v[22:23], v5 offset:39424
    ds_read_b64_tr_b16 v[24:25], v6 offset:38912
    ds_read_b64_tr_b16 v[26:27], v6 offset:39424
    s_waitcnt lgkmcnt(8)
    v_mfma_f32_32x32x16_bf16 v[76:91], v[180:183], v[28:31], v[76:91]
    v_mfma_f32_32x32x16_bf16 v[92:107], v[180:183], v[32:35], v[92:107]
    v_mfma_f32_32x32x16_bf16 v[108:123], v[184:187], v[28:31], v[108:123]
    v_mfma_f32_32x32x16_bf16 v[124:139], v[184:187], v[32:35], v[124:139]
    s_barrier
    s_waitcnt lgkmcnt(4)
    v_mfma_f32_32x32x16_bf16 v[76:91], v[188:191], v[36:39], v[76:91]
    v_mfma_f32_32x32x16_bf16 v[92:107], v[188:191], v[40:43], v[92:107]
    v_mfma_f32_32x32x16_bf16 v[108:123], v[192:195], v[36:39], v[108:123]
    v_mfma_f32_32x32x16_bf16 v[124:139], v[192:195], v[40:43], v[124:139]
    s_waitcnt lgkmcnt(0)
    v_mfma_f32_32x32x16_bf16 v[76:91], v[196:199], v[20:23], v[76:91]
    v_mfma_f32_32x32x16_bf16 v[92:107], v[196:199], v[24:27], v[92:107]
    v_mfma_f32_32x32x16_bf16 v[108:123], v[200:203], v[20:23], v[108:123]
    v_mfma_f32_32x32x16_bf16 v[124:139], v[200:203], v[24:27], v[124:139]
    s_barrier
    s_nop 7
    s_nop 3
    v_cvt_pk_bf16_f32 v44, v76, v77
    v_cvt_pk_bf16_f32 v45, v78, v79
    v_cvt_pk_bf16_f32 v46, v80, v81
    v_cvt_pk_bf16_f32 v47, v82, v83
    v_cvt_pk_bf16_f32 v48, v84, v85
    v_cvt_pk_bf16_f32 v49, v86, v87
    v_cvt_pk_bf16_f32 v50, v88, v89
    v_cvt_pk_bf16_f32 v51, v90, v91
    s_nop 1
    v_permlane32_swap_b32 v44, v46
    v_permlane32_swap_b32 v45, v47
    v_permlane32_swap_b32 v48, v50
    v_permlane32_swap_b32 v49, v51
    ds_write_b128 v14, v[44:47] offset:0
    ds_write_b128 v15, v[48:51] offset:0
    v_cvt_pk_bf16_f32 v52, v92, v93
    v_cvt_pk_bf16_f32 v53, v94, v95
    v_cvt_pk_bf16_f32 v54, v96, v97
    v_cvt_pk_bf16_f32 v55, v98, v99
    v_cvt_pk_bf16_f32 v56, v100, v101
    v_cvt_pk_bf16_f32 v57, v102, v103
    v_cvt_pk_bf16_f32 v58, v104, v105
    v_cvt_pk_bf16_f32 v59, v106, v107
    s_nop 1
    v_permlane32_swap_b32 v52, v54
    v_permlane32_swap_b32 v53, v55
    v_permlane32_swap_b32 v56, v58
    v_permlane32_swap_b32 v57, v59
    ds_write_b128 v14, v[52:55] offset:4096
    ds_write_b128 v15, v[56:59] offset:4096
    v_cvt_pk_bf16_f32 v60, v108, v109
    v_cvt_pk_bf16_f32 v61, v110, v111
    v_cvt_pk_bf16_f32 v62, v112, v113
    v_cvt_pk_bf16_f32 v63, v114, v115
    v_cvt_pk_bf16_f32 v64, v116, v117
    v_cvt_pk_bf16_f32 v65, v118, v119
    v_cvt_pk_bf16_f32 v66, v120, v121
    v_cvt_pk_bf16_f32 v67, v122, v123
    s_nop 1
    v_permlane32_swap_b32 v60, v62
    v_permlane32_swap_b32 v61, v63
    v_permlane32_swap_b32 v64, v66
    v_permlane32_swap_b32 v65, v67
    ds_write_b128 v16, v[60:63] offset:0
    ds_write_b128 v17, v[64:67] offset:0
    v_cvt_pk_bf16_f32 v68, v124, v125
    v_cvt_pk_bf16_f32 v69, v126, v127
    v_cvt_pk_bf16_f32 v70, v128, v129
    v_cvt_pk_bf16_f32 v71, v130, v131
    v_cvt_pk_bf16_f32 v72, v132, v133
    v_cvt_pk_bf16_f32 v73, v134, v135
    v_cvt_pk_bf16_f32 v74, v136, v137
    v_cvt_pk_bf16_f32 v75, v138, v139
    s_nop 1
    v_permlane32_swap_b32 v68, v70
    v_permlane32_swap_b32 v69, v71
    v_permlane32_swap_b32 v72, v74
    v_permlane32_swap_b32 v73, v75
    ds_write_b128 v16, v[68:71] offset:4096
    ds_write_b128 v17, v[72:75] offset:4096
    s_waitcnt lgkmcnt(0)
    ds_read_b128 v[44:47], v18 offset:0
    ds_read_b128 v[48:51], v18 offset:1024
    ds_read_b128 v[52:55], v18 offset:2048
    ds_read_b128 v[56:59], v18 offset:3072
    ds_read_b128 v[60:63], v18 offset:4096
    ds_read_b128 v[64:67], v18 offset:5120
    ds_read_b128 v[68:71], v18 offset:6144
    ds_read_b128 v[72:75], v18 offset:7168
    s_add_u32 s21, s90, 0
    s_waitcnt lgkmcnt(7)
    buffer_store_dwordx4 v[44:47], v8, s[4:7], s21 offen sc1
    s_add_u32 s21, s90, 33792
    s_waitcnt lgkmcnt(6)
    buffer_store_dwordx4 v[48:51], v8, s[4:7], s21 offen sc1
    s_add_u32 s21, s90, 67584
    s_waitcnt lgkmcnt(5)
    buffer_store_dwordx4 v[52:55], v8, s[4:7], s21 offen sc1
    s_add_u32 s21, s90, 101376
    s_waitcnt lgkmcnt(4)
    buffer_store_dwordx4 v[56:59], v8, s[4:7], s21 offen sc1
    s_add_u32 s21, s90, 135168
    s_waitcnt lgkmcnt(3)
    buffer_store_dwordx4 v[60:63], v8, s[4:7], s21 offen sc1
    s_add_u32 s21, s90, 168960
    s_waitcnt lgkmcnt(2)
    buffer_store_dwordx4 v[64:67], v8, s[4:7], s21 offen sc1
    s_add_u32 s21, s90, 202752
    s_waitcnt lgkmcnt(1)
    buffer_store_dwordx4 v[68:71], v8, s[4:7], s21 offen sc1
    s_add_u32 s21, s90, 236544
    s_waitcnt lgkmcnt(0)
    buffer_store_dwordx4 v[72:75], v8, s[4:7], s21 offen sc1
    s_mov_b32 s27, 0
    s_branch Lpois
Lunitd:
    s_mov_b32 s89, s87
Lunitd2:
    s_add_u32 s87, s87, s86
    s_cmp_lt_u32 s87, s88
    s_cbranch_scc1 Lunit
    s_waitcnt vmcnt(0)
    s_barrier
    s_cmp_lg_u32 s14, 0
    s_cbranch_scc1 Lsu_90
    s_cmp_ge_u32 s89, 192
    s_cbranch_scc1 Lsu_90
    s_cmp_ge_u32 s89, 128
    s_cselect_b32 s92, 0x10000, 1
    s_lshl_b32 s93, s85, 2
    s_add_u32 s93, s93, 128
    s_mov_b64 exec, 1
    v_mov_b32 v9, s92
    v_mov_b32 v10, s93
    buffer_atomic_add v9, v10, s[96:99], 0 offen sc1
    s_mov_b64 exec, -1
Lsu_90:
    s_add_u32 s91, s91, 1
    s_mov_b32 s88, 192
    s_cmp_eq_u32 s91, 3
    s_cbranch_scc1 Lprojdone
    s_cmp_eq_u32 s91, 2
    s_cbranch_scc1 Lr2
    s_cmp_ge_u32 s15, 16
    s_cbranch_scc1 Lnoprobe2
    s_cmp_lg_u32 s14, 0
    s_cbranch_scc1 Lnoprobe
    s_lshl_b32 s92, s15, 21
    s_add_u32 s92, s92, 167780096
    s_mov_b64 exec, 1
    v_mov_b32 v9, s92
    v_add_u32 v10, 8192, v9
    s_mov_b32 s32, -1
    s_mov_b32 s33, -1
    s_mov_b32 s34, 0
Lprb:
    buffer_store_dword v1, v9, s[4:7], 0 offen sc1
    s_waitcnt vmcnt(0)
    s_memtime s[92:93]
    s_waitcnt lgkmcnt(0)
    buffer_load_dword v11, v9, s[4:7], 0 offen sc1
    s_waitcnt vmcnt(0)
    s_memtime s[94:95]
    s_waitcnt lgkmcnt(0)
    s_sub_u32 s94, s94, s92
    s_min_u32 s32, s32, s94
    buffer_store_dword v1, v10, s[4:7], 0 offen sc1
    s_waitcnt vmcnt(0)
    s_memtime s[92:93]
    s_waitcnt lgkmcnt(0)
    buffer_load_dword v11, v10, s[4:7], 0 offen sc1
    s_waitcnt vmcnt(0)
    s_memtime s[94:95]
    s_waitcnt lgkmcnt(0)
    s_sub_u32 s94, s94, s92
    s_min_u32 s33, s33, s94
    s_add_u32 s34, s34, 1
    s_cmp_lt_u32 s34, 3
    s_cbranch_scc1 Lprb
    s_cmp_lt_u32 s33, s32
    s_cselect_b32 s34, 1, 0
    s_lshr_b32 s92, s2, 2
    s_and_b32 s92, s92, 1
    s_xor_b32 s34, s34, s92
    s_or_b32 s34, s34, 0x10000
    s_lshl_b32 s34, s34, s15
    v_mov_b32 v9, s34
    v_mov_b32 v10, 36
    buffer_atomic_or v9, v10, s[96:99], 0 offen sc1
    s_mov_b64 exec, -1
Lnoprobe:
    s_barrier
Lnoprobe2:
    s_lshr_b32 s85, s15, 6
    s_add_u32 s85, s85, 1
    s_and_b32 s87, s15, 63
    s_mov_b32 s86, 64
    s_lshl_b32 s82, s87, 2
    s_mov_b32 s83, 4
    s_branch Lphase
Lr2:
    s_mul_i32 s87, s3, 32
    s_add_u32 s87, s87, s13
    s_sub_u32 s87, s87, 0
    s_mov_b32 s85, 3
    s_mov_b32 s86, 26
    s_cmp_lt_u32 s87, 26
    s_cbranch_scc1 Lgrd
    s_sub_u32 s87, s87, 26
    s_add_u32 s85, s85, 1
    s_mov_b32 s86, 26
    s_cmp_lt_u32 s87, 26
    s_cbranch_scc1 Lgrd
    s_sub_u32 s87, s87, 26
    s_add_u32 s85, s85, 1
    s_mov_b32 s86, 26
    s_cmp_lt_u32 s87, 26
    s_cbranch_scc1 Lgrd
    s_sub_u32 s87, s87, 26
    s_add_u32 s85, s85, 1
    s_mov_b32 s86, 25
    s_cmp_lt_u32 s87, 25
    s_cbranch_scc1 Lgrd
    s_sub_u32 s87, s87, 25
    s_add_u32 s85, s85, 1
    s_mov_b32 s86, 25
Lgrd:
    s_mul_i32 s82, s87, 11
    s_mov_b32 s83, 11
    s_branch Lphase
Lprojdone:
    s_mov_b32 s82, 0
    s_mov_b32 s83, 0
    s_mov_b32 s92, 32
    s_cmp_lg_u32 s14, 0
    s_cbranch_scc1 Lwd_96
    v_mov_b32 v3, s92
Lwd_95:
    buffer_load_dword v2, v3, s[96:99], 0 offen sc1
    s_waitcnt vmcnt(0)
    v_readfirstlane_b32 s84, v2
    s_add_u32 s81, s81, 1
    s_cmp_gt_u32 s81, 0x200000
    s_cbranch_scc1 fused_kernel_exit
    s_lshr_b32 s84, s84, 0
    s_and_b32 s84, s84, 65535
    s_cmp_ge_u32 s84, 128
    s_cbranch_scc1 Lwd_96
    s_sleep 8
    s_branch Lwd_95
Lwd_96:
    s_barrier
Lssm:
    s_cmp_lg_u32 s14, 0
    s_cbranch_scc1 Ltks
    s_mov_b64 exec, 1
    v_mov_b32 v2, 1
    v_mov_b32 v3, 104410624
    buffer_atomic_add v2, v3, s[4:7], 0 offen sc0 sc1
    s_waitcnt vmcnt(0)
    v_mov_b32 v3, 151488
    ds_write_b32 v3, v2
    s_waitcnt lgkmcnt(0)
    s_mov_b64 exec, -1
Ltks:
    s_barrier
    v_mov_b32 v3, 151488
    ds_read_b32 v2, v3
    s_waitcnt lgkmcnt(0)
    v_readfirstlane_b32 s80, v2
    s_barrier
    s_cmp_ge_u32 s80, 160
    s_cbranch_scc1 Lssmd
    s_lshl_b32 s85, s80, 2
    s_add_u32 s80, s80, 200
    s_barrier
    s_mul_i32 s16, s14, 27776
    s_add_u32 s17, s85, s14
    v_lshlrev_b32 v3, 2, v1
    s_lshl_b32 s18, s17, 8
    s_mov_b32 s8, s56
    s_and_b32 s9, s57, 0xffff
    s_mov_b32 s10, 163840
    s_mov_b32 s11, 0x00020000
    buffer_load_dword v96, v3, s[8:11], s18 offen
    s_mov_b32 s8, s58
    s_and_b32 s9, s59, 0xffff
    s_mov_b32 s10, 163840
    s_mov_b32 s11, 0x00020000
    buffer_load_dword v97, v3, s[8:11], s18 offen
    s_mov_b32 s8, s60
    s_and_b32 s9, s61, 0xffff
    s_mov_b32 s10, 163840
    s_mov_b32 s11, 0x00020000
    buffer_load_dword v98, v3, s[8:11], s18 offen
    s_mov_b32 s8, s62
    s_and_b32 s9, s63, 0xffff
    s_mov_b32 s10, 163840
    s_mov_b32 s11, 0x00020000
    buffer_load_dword v99, v3, s[8:11], s18 offen
    s_mov_b32 s8, s64
    s_and_b32 s9, s65, 0xffff
    s_mov_b32 s10, 163840
    s_mov_b32 s11, 0x00020000
    buffer_load_dword v100, v3, s[8:11], s18 offen
    s_mov_b32 s8, s66
    s_and_b32 s9, s67, 0xffff
    s_mov_b32 s10, 163840
    s_mov_b32 s11, 0x00020000
    buffer_load_dword v101, v3, s[8:11], s18 offen
    v_mov_b32 v4, s17
    v_lshlrev_b32 v4, 1, v4
    s_mov_b32 s8, s68
    s_and_b32 s9, s69, 0xffff
    s_mov_b32 s10, 1280
    s_mov_b32 s11, 0x00020000
    buffer_load_ushort v157, v4, s[8:11], 0 offen
    s_mov_b32 s8, s70
    s_and_b32 s9, s71, 0xffff
    s_mov_b32 s10, 1280
    s_mov_b32 s11, 0x00020000
    buffer_load_ushort v158, v4, s[8:11], 0 offen
    s_mov_b32 s8, s40
    s_and_b32 s9, s41, 0xffff
    s_mov_b32 s10, 2621440
    s_mov_b32 s11, 0x00020000
    v_mul_u32_u24 v2, 1280, v250
    s_lshl_b32 s18, s85, 1
    s_add_u32 s19, s18, 0
    buffer_load_dwordx2 v[64:65], v2, s[8:11], s19 offen
    s_add_u32 s19, s18, 327680
    buffer_load_dwordx2 v[66:67], v2, s[8:11], s19 offen
    s_add_u32 s19, s18, 655360
    buffer_load_dwordx2 v[68:69], v2, s[8:11], s19 offen
    s_add_u32 s19, s18, 983040
    buffer_load_dwordx2 v[70:71], v2, s[8:11], s19 offen
    s_add_u32 s19, s18, 1310720
    buffer_load_dwordx2 v[72:73], v2, s[8:11], s19 offen
    s_add_u32 s19, s18, 1638400
    buffer_load_dwordx2 v[74:75], v2, s[8:11], s19 offen
    s_add_u32 s19, s18, 1966080
    buffer_load_dwordx2 v[76:77], v2, s[8:11], s19 offen
    s_add_u32 s19, s18, 2293760
    buffer_load_dwordx2 v[78:79], v2, s[8:11], s19 offen
    v_and_b32 v2, 15, v1
    v_lshrrev_b32 v10, 4, v1
    v_and_b32 v5, 7, v2
    v_lshrrev_b32 v6, 3, v2
    v_lshl_add_u32 v5, v6, 7, v5
    v_cvt_f32_u32 v20, v5
    v_and_b32 v5, 3, v2
    v_lshlrev_b32 v5, 1, v5
    v_lshrrev_b32 v6, 2, v2
    v_lshl_add_u32 v5, v6, 7, v5
    v_add_u32 v5, 256, v5
    v_and_b32 v7, 1, v2
    v_lshlrev_b32 v7, 2, v7
    v_lshrrev_b32 v6, 1, v2
    v_lshl_add_u32 v7, v6, 7, v7
    v_cmp_gt_u32 vcc, 8, v2
    s_nop 1
    v_cndmask_b32 v5, v7, v5, vcc
    v_cvt_f32_u32 v21, v5
    v_lshlrev_b32 v5, 7, v2
    v_add_u32 v5, 1024, v5
    v_min_u32 v5, 2048, v5
    v_cvt_f32_u32 v22, v5
    v_lshlrev_b32 v4, 3, v2
    v_cvt_f32_u32 v23, v4
    v_lshl_add_u32 v11, v10, 2, 0
    v_and_b32 v5, 7, v11
    v_lshrrev_b32 v6, 3, v11
    v_lshl_add_u32 v5, v6, 7, v5
    v_add_u32 v5, v5, v4
    v_cvt_f32_u32 v6, v5
    v_cvt_pk_bf16_f32 v6, v6, v6
    v_and_b32 v6, 0xffff, v6
    v_subrev_u32 v6, 0x4280, v6
    v_cmp_gt_u32 vcc, 128, v5
    s_nop 1
    v_cndmask_b32 v7, v6, v5, vcc
    v_lshl_add_u32 v7, v7, 1, s16
    v_add_u32 v24, 24304, v7
    v_and_b32 v5, 3, v11
    v_lshlrev_b32 v5, 1, v5
    v_lshrrev_b32 v6, 2, v11
    v_lshl_add_u32 v5, v6, 7, v5
    v_add_u32 v5, 256, v5
    v_and_b32 v7, 1, v11
    v_lshlrev_b32 v7, 2, v7
    v_lshrrev_b32 v6, 1, v11
    v_lshl_add_u32 v7, v6, 7, v7
    v_cmp_gt_u32 vcc, 8, v11
    s_nop 1
    v_cndmask_b32 v5, v7, v5, vcc
    v_add_u32 v5, v5, v4
    v_cvt_f32_u32 v6, v5
    v_cvt_pk_bf16_f32 v6, v6, v6
    v_and_b32 v6, 0xffff, v6
    v_subrev_u32 v6, 0x4280, v6
    v_cmp_gt_u32 vcc, 128, v5
    s_nop 1
    v_cndmask_b32 v7, v6, v5, vcc
    v_lshl_add_u32 v7, v7, 1, s16
    v_add_u32 v28, 24304, v7
    v_lshlrev_b32 v5, 7, v11
    v_add_u32 v5, 1024, v5
    v_min_u32 v5, 2048, v5
    v_add_u32 v5, v5, v4
    v_cvt_f32_u32 v6, v5
    v_cvt_pk_bf16_f32 v6, v6, v6
    v_and_b32 v6, 0xffff, v6
    v_subrev_u32 v6, 0x4280, v6
    v_cmp_gt_u32 vcc, 128, v5
    s_nop 1
    v_cndmask_b32 v7, v6, v5, vcc
    v_cmp_lt_u32 vcc, 2048, v5
    v_mov_b32 v6, 645
    s_nop 0
    v_cndmask_b32 v7, v7, v6, vcc
    v_lshl_add_u32 v7, v7, 1, s16
    v_add_u32 v32, 24304, v7
    v_lshl_add_u32 v11, v10, 2, 1
    v_and_b32 v5, 7, v11
    v_lshrrev_b32 v6, 3, v11
    v_lshl_add_u32 v5, v6, 7, v5
    v_add_u32 v5, v5, v4
    v_cvt_f32_u32 v6, v5
    v_cvt_pk_bf16_f32 v6, v6, v6
    v_and_b32 v6, 0xffff, v6
    v_subrev_u32 v6, 0x4280, v6
    v_cmp_gt_u32 vcc, 128, v5
    s_nop 1
    v_cndmask_b32 v7, v6, v5, vcc
    v_lshl_add_u32 v7, v7, 1, s16
    v_add_u32 v25, 24304, v7
    v_and_b32 v5, 3, v11
    v_lshlrev_b32 v5, 1, v5
    v_lshrrev_b32 v6, 2, v11
    v_lshl_add_u32 v5, v6, 7, v5
    v_add_u32 v5, 256, v5
    v_and_b32 v7, 1, v11
    v_lshlrev_b32 v7, 2, v7
    v_lshrrev_b32 v6, 1, v11
    v_lshl_add_u32 v7, v6, 7, v7
    v_cmp_gt_u32 vcc, 8, v11
    s_nop 1
    v_cndmask_b32 v5, v7, v5, vcc
    v_add_u32 v5, v5, v4
    v_cvt_f32_u32 v6, v5
    v_cvt_pk_bf16_f32 v6, v6, v6
    v_and_b32 v6, 0xffff, v6
    v_subrev_u32 v6, 0x4280, v6
    v_cmp_gt_u32 vcc, 128, v5
    s_nop 1
    v_cndmask_b32 v7, v6, v5, vcc
    v_lshl_add_u32 v7, v7, 1, s16
    v_add_u32 v29, 24304, v7
    v_lshlrev_b32 v5, 7, v11
    v_add_u32 v5, 1024, v5
    v_min_u32 v5, 2048, v5
    v_add_u32 v5, v5, v4
    v_cvt_f32_u32 v6, v5
    v_cvt_pk_bf16_f32 v6, v6, v6
    v_and_b32 v6, 0xffff, v6
    v_subrev_u32 v6, 0x4280, v6
    v_cmp_gt_u32 vcc, 128, v5
    s_nop 1
    v_cndmask_b32 v7, v6, v5, vcc
    v_cmp_lt_u32 vcc, 2048, v5
    v_mov_b32 v6, 645
    s_nop 0
    v_cndmask_b32 v7, v7, v6, vcc
    v_lshl_add_u32 v7, v7, 1, s16
    v_add_u32 v33, 24304, v7
    v_lshl_add_u32 v11, v10, 2, 2
    v_and_b32 v5, 7, v11
    v_lshrrev_b32 v6, 3, v11
    v_lshl_add_u32 v5, v6, 7, v5
    v_add_u32 v5, v5, v4
    v_cvt_f32_u32 v6, v5
    v_cvt_pk_bf16_f32 v6, v6, v6
    v_and_b32 v6, 0xffff, v6
    v_subrev_u32 v6, 0x4280, v6
    v_cmp_gt_u32 vcc, 128, v5
    s_nop 1
    v_cndmask_b32 v7, v6, v5, vcc
    v_lshl_add_u32 v7, v7, 1, s16
    v_add_u32 v26, 24304, v7
    v_and_b32 v5, 3, v11
    v_lshlrev_b32 v5, 1, v5
    v_lshrrev_b32 v6, 2, v11
    v_lshl_add_u32 v5, v6, 7, v5
    v_add_u32 v5, 256, v5
    v_and_b32 v7, 1, v11
    v_lshlrev_b32 v7, 2, v7
    v_lshrrev_b32 v6, 1, v11
    v_lshl_add_u32 v7, v6, 7, v7
    v_cmp_gt_u32 vcc, 8, v11
    s_nop 1
    v_cndmask_b32 v5, v7, v5, vcc
    v_add_u32 v5, v5, v4
    v_cvt_f32_u32 v6, v5
    v_cvt_pk_bf16_f32 v6, v6, v6
    v_and_b32 v6, 0xffff, v6
    v_subrev_u32 v6, 0x4280, v6
    v_cmp_gt_u32 vcc, 128, v5
    s_nop 1
    v_cndmask_b32 v7, v6, v5, vcc
    v_lshl_add_u32 v7, v7, 1, s16
    v_add_u32 v30, 24304, v7
    v_lshlrev_b32 v5, 7, v11
    v_add_u32 v5, 1024, v5
    v_min_u32 v5, 2048, v5
    v_add_u32 v5, v5, v4
    v_cvt_f32_u32 v6, v5
    v_cvt_pk_bf16_f32 v6, v6, v6
    v_and_b32 v6, 0xffff, v6
    v_subrev_u32 v6, 0x4280, v6
    v_cmp_gt_u32 vcc, 128, v5
    s_nop 1
    v_cndmask_b32 v7, v6, v5, vcc
    v_cmp_lt_u32 vcc, 2048, v5
    v_mov_b32 v6, 645
    s_nop 0
    v_cndmask_b32 v7, v7, v6, vcc
    v_lshl_add_u32 v7, v7, 1, s16
    v_add_u32 v34, 24304, v7
    v_lshl_add_u32 v11, v10, 2, 3
    v_and_b32 v5, 7, v11
    v_lshrrev_b32 v6, 3, v11
    v_lshl_add_u32 v5, v6, 7, v5
    v_add_u32 v5, v5, v4
    v_cvt_f32_u32 v6, v5
    v_cvt_pk_bf16_f32 v6, v6, v6
    v_and_b32 v6, 0xffff, v6
    v_subrev_u32 v6, 0x4280, v6
    v_cmp_gt_u32 vcc, 128, v5
    s_nop 1
    v_cndmask_b32 v7, v6, v5, vcc
    v_lshl_add_u32 v7, v7, 1, s16
    v_add_u32 v27, 24304, v7
    v_and_b32 v5, 3, v11
    v_lshlrev_b32 v5, 1, v5
    v_lshrrev_b32 v6, 2, v11
    v_lshl_add_u32 v5, v6, 7, v5
    v_add_u32 v5, 256, v5
    v_and_b32 v7, 1, v11
    v_lshlrev_b32 v7, 2, v7
    v_lshrrev_b32 v6, 1, v11
    v_lshl_add_u32 v7, v6, 7, v7
    v_cmp_gt_u32 vcc, 8, v11
    s_nop 1
    v_cndmask_b32 v5, v7, v5, vcc
    v_add_u32 v5, v5, v4
    v_cvt_f32_u32 v6, v5
    v_cvt_pk_bf16_f32 v6, v6, v6
    v_and_b32 v6, 0xffff, v6
    v_subrev_u32 v6, 0x4280, v6
    v_cmp_gt_u32 vcc, 128, v5
    s_nop 1
    v_cndmask_b32 v7, v6, v5, vcc
    v_lshl_add_u32 v7, v7, 1, s16
    v_add_u32 v31, 24304, v7
    v_lshlrev_b32 v5, 7, v11
    v_add_u32 v5, 1024, v5
    v_min_u32 v5, 2048, v5
    v_add_u32 v5, v5, v4
    v_cvt_f32_u32 v6, v5
    v_cvt_pk_bf16_f32 v6, v6, v6
    v_and_b32 v6, 0xffff, v6
    v_subrev_u32 v6, 0x4280, v6
    v_cmp_gt_u32 vcc, 128, v5
    s_nop 1
    v_cndmask_b32 v7, v6, v5, vcc
    v_cmp_lt_u32 vcc, 2048, v5
    v_mov_b32 v6, 645
    s_nop 0
    v_cndmask_b32 v7, v7, v6, vcc
    v_lshl_add_u32 v7, v7, 1, s16
    v_add_u32 v35, 24304, v7
    v_and_b32 v5, 31, v1
    v_lshrrev_b32 v6, 5, v1
    v_sub_u32 v7, 3, v5
    v_and_b32 v7, 3, v7
    v_lshlrev_b32 v8, 3, v6
    v_sub_u32 v8, v8, v5
    v_sub_u32 v8, v8, v7
    v_add_u32 v8, 2047, v8
    v_lshlrev_b32 v8, 1, v8
    v_mul_u32_u24 v7, 4160, v7
    v_add3_u32 v153, v8, v7, s16
    v_add_u32 v153, 64, v153
    v_mul_u32_u24 v7, 80, v5
    v_lshl_add_u32 v8, v6, 4, v7
    v_add_u32 v8, 19184, v8
    v_add_u32 v154, s16, v8
    v_lshl_add_u32 v8, v6, 3, v7
    v_add_u32 v8, 19184, v8
    v_add_u32 v155, s16, v8
    v_mul_u32_u24 v7, 272, v5
    v_lshl_add_u32 v7, v6, 5, v7
    s_lshl_b32 s19, s14, 1
    s_add_u32 s19, s19, 111104
    v_add_u32 v156, s19, v7
    v_mov_b32 v14, 0
    v_mov_b32 v15, 0
    v_mov_b32 v16, 0
    v_mov_b32 v17, 0
    v_lshl_add_u32 v7, v1, 4, s16
    ds_write_b128 v7, v[14:17] offset:16704
    ds_write_b128 v7, v[14:17] offset:17728
    v_min_u32 v8, 26, v1
    v_lshl_add_u32 v8, v8, 4, s16
    ds_write_b128 v8, v[14:17] offset:18752
    v_and_b32 v8, 7, v1
    v_min_u32 v8, 4, v8
    v_lshlrev_b32 v8, 4, v8
    v_bfe_u32 v9, v1, 3, 2
    v_mul_u32_u24 v9, 4160, v9
    v_add3_u32 v8, v8, v9, s16
    ds_write_b128 v8, v[14:17] offset:4144
    s_waitcnt vmcnt(8)
    s_mov_b32 s20, 0x3fb8aa3b
    s_mov_b32 s21, 0x3e22f983
    v_lshlrev_b32 v157, 16, v157
    v_mul_f32 v157, s20, v157
    v_exp_f32 v157, v157
    s_nop 0
    v_cvt_pk_bf16_f32 v157, v157, v157
    v_lshlrev_b32 v157, 16, v157
    v_lshlrev_b32 v158, 16, v158
    v_lshlrev_b32 v108, 16, v96
    v_lshlrev_b32 v109, 16, v97
    v_lshlrev_b32 v110, 16, v98
    v_lshlrev_b32 v111, 16, v99
    v_lshlrev_b32 v112, 16, v100
    v_lshlrev_b32 v113, 16, v101
    v_mul_f32 v108, v157, v108
    v_mul_f32 v109, v157, v109
    v_mul_f32 v110, v157, v110
    v_mul_f32 v111, v157, v111
    v_mul_f32 v104, s20, v108
    v_mul_f32 v105, s21, v109
    v_mul_f32 v106, v112, v110
    v_mul_f32 v107, v112, v111
    v_fma_f32 v106, -v113, v111, v106
    v_fma_f32 v107, v113, v110, v107
    v_and_b32 v120, 0xffff0000, v96
    v_and_b32 v121, 0xffff0000, v97
    v_and_b32 v122, 0xffff0000, v98
    v_and_b32 v123, 0xffff0000, v99
    v_and_b32 v124, 0xffff0000, v100
    v_and_b32 v125, 0xffff0000, v101
    v_mul_f32 v120, v157, v120
    v_mul_f32 v121, v157, v121
    v_mul_f32 v122, v157, v122
    v_mul_f32 v123, v157, v123
    v_mul_f32 v116, s20, v120
    v_mul_f32 v117, s21, v121
    v_mul_f32 v118, v124, v122
    v_mul_f32 v119, v124, v123
    v_fma_f32 v118, -v125, v123, v118
    v_fma_f32 v119, v125, v122, v119
    v_lshl_add_u32 v3, v1, 5, s16
    ds_write_b128 v3, v[104:107] offset:25616
    ds_write_b128 v3, v[116:119] offset:25632
    v_lshl_add_u32 v159, v10, 9, s16
    v_lshrrev_b32 v5, 5, v250
    v_mul_u32_u24 v5, 80, v5
    v_and_b32 v6, 31, v250
    v_lshl_add_u32 v5, v6, 1, v5
    v_add_u32 v6, 55552, v5
    s_waitcnt vmcnt(0)
    ds_write_b16 v5, v64 offset:19184
    ds_write_b16_d16_hi v5, v64 offset:46960
    ds_write_b16 v6, v65 offset:19184
    ds_write_b16_d16_hi v6, v65 offset:46960
    ds_write_b16 v5, v66 offset:19824
    ds_write_b16_d16_hi v5, v66 offset:47600
    ds_write_b16 v6, v67 offset:19824
    ds_write_b16_d16_hi v6, v67 offset:47600
    ds_write_b16 v5, v68 offset:20464
    ds_write_b16_d16_hi v5, v68 offset:48240
    ds_write_b16 v6, v69 offset:20464
    ds_write_b16_d16_hi v6, v69 offset:48240
    s_waitcnt lgkmcnt(0)
    ds_write_b16 v5, v70 offset:21104
    ds_write_b16_d16_hi v5, v70 offset:48880
    ds_write_b16 v6, v71 offset:21104
    ds_write_b16_d16_hi v6, v71 offset:48880
    ds_write_b16 v5, v72 offset:21744
    ds_write_b16_d16_hi v5, v72 offset:49520
    ds_write_b16 v6, v73 offset:21744
    ds_write_b16_d16_hi v6, v73 offset:49520
    ds_write_b16 v5, v74 offset:22384
    ds_write_b16_d16_hi v5, v74 offset:50160
    ds_write_b16 v6, v75 offset:22384
    ds_write_b16_d16_hi v6, v75 offset:50160
    s_waitcnt lgkmcnt(0)
    ds_write_b16 v5, v76 offset:23024
    ds_write_b16_d16_hi v5, v76 offset:50800
    ds_write_b16 v6, v77 offset:23024
    ds_write_b16_d16_hi v6, v77 offset:50800
    ds_write_b16 v5, v78 offset:23664
    ds_write_b16_d16_hi v5, v78 offset:51440
    ds_write_b16 v6, v79 offset:23664
    ds_write_b16_d16_hi v6, v79 offset:51440
    v_mov_b32 v52, 0
    v_mov_b32 v53, 0
    v_mov_b32 v54, 0
    v_mov_b32 v55, 0
    v_mov_b32 v56, 0
    v_mov_b32 v57, 0
    v_mov_b32 v58, 0
    v_mov_b32 v59, 0
    v_mov_b32 v60, 0
    v_mov_b32 v61, 0
    v_mov_b32 v62, 0
    v_mov_b32 v63, 0
    s_waitcnt lgkmcnt(0)
    v_mov_b32 v72, 0
    v_mov_b32 v73, 0
    v_mov_b32 v74, 0
    v_mov_b32 v75, 0
    v_mov_b32 v76, 0
    v_mov_b32 v77, 0
    v_mov_b32 v78, 0
    v_mov_b32 v79, 0
    ds_read_b128 v[44:47], v159 offset:25616
    ds_read_b128 v[48:51], v159 offset:25632
    s_mov_b32 s22, 16
Lkg_97:
    s_waitcnt lgkmcnt(0)
    v_mov_b32 v36, v44
    v_mov_b32 v37, v45
    v_mov_b32 v38, v46
    v_mov_b32 v39, v47
    v_mov_b32 v40, v48
    v_mov_b32 v41, v49
    v_mov_b32 v42, v50
    v_mov_b32 v43, v51
    v_add_u32 v159, 32, v159
    ds_read_b128 v[44:47], v159 offset:25616
    ds_read_b128 v[48:51], v159 offset:25632
    v_mul_f32 v104, v36, v20
    v_mul_f32 v108, v37, v20
    v_mul_f32 v105, v36, v21
    v_mfma_f32_16x16x4_f32 v[52:55], v72, v78, v[52:55]
    v_mul_f32 v109, v37, v21
    v_mul_f32 v106, v36, v22
    v_mul_f32 v110, v37, v22
    v_mul_f32 v107, v36, v23
    v_mul_f32 v111, v37, v23
    v_exp_f32 v104, v104
    v_mfma_f32_16x16x4_f32 v[56:59], v73, v78, v[56:59]
    v_fract_f32 v108, v108
    v_exp_f32 v105, v105
    v_fract_f32 v109, v109
    v_exp_f32 v106, v106
    v_mfma_f32_16x16x4_f32 v[60:63], v74, v78, v[60:63]
    v_fract_f32 v110, v110
    v_exp_f32 v107, v107
    v_fract_f32 v111, v111
    v_cos_f32 v112, v108
    v_mfma_f32_16x16x4_f32 v[52:55], v75, v79, v[52:55]
    v_sin_f32 v116, v108
    v_cos_f32 v113, v109
    v_sin_f32 v117, v109
    v_cos_f32 v114, v110
    v_mfma_f32_16x16x4_f32 v[56:59], v76, v79, v[56:59]
    v_sin_f32 v118, v110
    v_cos_f32 v115, v111
    v_sin_f32 v119, v111
    s_nop 0
    v_mul_f32 v112, v112, v104
    v_mfma_f32_16x16x4_f32 v[60:63], v77, v79, v[60:63]
    v_mul_f32 v116, v116, v104
    v_mul_f32 v113, v113, v105
    v_mul_f32 v117, v117, v105
    v_mul_f32 v114, v114, v106
    v_mul_f32 v118, v118, v106
    v_mul_f32 v70, v115, v107
    v_mul_f32 v71, v119, v107
    v_mul_f32 v120, v38, v112
    v_mul_f32 v124, v38, v116
    v_mul_f32 v121, v38, v113
    v_mul_f32 v125, v38, v117
    v_mul_f32 v122, v38, v114
    v_mul_f32 v126, v38, v118
    v_fma_f32 v64, -v39, v116, v120
    v_fma_f32 v67, -v39, v112, -v124
    v_fma_f32 v65, -v39, v117, v121
    v_fma_f32 v68, -v39, v113, -v125
    v_fma_f32 v66, -v39, v118, v122
    v_fma_f32 v69, -v39, v114, -v126
    v_mul_f32 v104, v40, v20
    v_mul_f32 v108, v41, v20
    v_mul_f32 v105, v40, v21
    v_mfma_f32_16x16x4_f32 v[52:55], v64, v70, v[52:55]
    v_mul_f32 v109, v41, v21
    v_mul_f32 v106, v40, v22
    v_mul_f32 v110, v41, v22
    v_mul_f32 v107, v40, v23
    v_mul_f32 v111, v41, v23
    v_exp_f32 v104, v104
    v_mfma_f32_16x16x4_f32 v[56:59], v65, v70, v[56:59]
    v_fract_f32 v108, v108
    v_exp_f32 v105, v105
    v_fract_f32 v109, v109
    v_exp_f32 v106, v106
    v_mfma_f32_16x16x4_f32 v[60:63], v66, v70, v[60:63]
    v_fract_f32 v110, v110
    v_exp_f32 v107, v107
    v_fract_f32 v111, v111
    v_cos_f32 v112, v108
    v_mfma_f32_16x16x4_f32 v[52:55], v67, v71, v[52:55]
    v_sin_f32 v116, v108
    v_cos_f32 v113, v109
    v_sin_f32 v117, v109
    v_cos_f32 v114, v110
    v_mfma_f32_16x16x4_f32 v[56:59], v68, v71, v[56:59]
    v_sin_f32 v118, v110
    v_cos_f32 v115, v111
    v_sin_f32 v119, v111
    s_nop 0
    v_mul_f32 v112, v112, v104
    v_mfma_f32_16x16x4_f32 v[60:63], v69, v71, v[60:63]
    v_mul_f32 v116, v116, v104
    v_mul_f32 v113, v113, v105
    v_mul_f32 v117, v117, v105
    v_mul_f32 v114, v114, v106
    v_mul_f32 v118, v118, v106
    v_mul_f32 v78, v115, v107
    v_mul_f32 v79, v119, v107
    v_mul_f32 v120, v42, v112
    v_mul_f32 v124, v42, v116
    v_mul_f32 v121, v42, v113
    v_mul_f32 v125, v42, v117
    v_mul_f32 v122, v42, v114
    v_mul_f32 v126, v42, v118
    v_fma_f32 v72, -v43, v116, v120
    v_fma_f32 v75, -v43, v112, -v124
    v_fma_f32 v73, -v43, v117, v121
    v_fma_f32 v76, -v43, v113, -v125
    v_fma_f32 v74, -v43, v118, v122
    v_fma_f32 v77, -v43, v114, -v126
    s_sub_u32 s22, s22, 1
    s_cmp_lg_u32 s22, 0
    s_cbranch_scc1 Lkg_97
    v_mfma_f32_16x16x4_f32 v[52:55], v72, v78, v[52:55]
    v_mfma_f32_16x16x4_f32 v[56:59], v73, v78, v[56:59]
    v_mfma_f32_16x16x4_f32 v[60:63], v74, v78, v[60:63]
    v_mfma_f32_16x16x4_f32 v[52:55], v75, v79, v[52:55]
    v_mfma_f32_16x16x4_f32 v[56:59], v76, v79, v[56:59]
    v_mfma_f32_16x16x4_f32 v[60:63], v77, v79, v[60:63]
    s_nop 11
    s_waitcnt lgkmcnt(0)
    v_cvt_pk_bf16_f32 v2, v52, v53
    ds_write_b16 v24, v2
    ds_write_b16_d16_hi v25, v2
    v_cvt_pk_bf16_f32 v2, v54, v55
    ds_write_b16 v26, v2
    ds_write_b16_d16_hi v27, v2
    v_cvt_pk_bf16_f32 v2, v56, v57
    ds_write_b16 v28, v2
    ds_write_b16_d16_hi v29, v2
    v_cvt_pk_bf16_f32 v2, v58, v59
    ds_write_b16 v30, v2
    ds_write_b16_d16_hi v31, v2
    v_cvt_pk_bf16_f32 v2, v60, v61
    ds_write_b16 v32, v2
    ds_write_b16_d16_hi v33, v2
    v_cvt_pk_bf16_f32 v2, v62, v63
    ds_write_b16 v34, v2
    ds_write_b16_d16_hi v35, v2
    s_waitcnt lgkmcnt(0)
    v_sub_u32 v2, 2047, v1
    v_lshl_add_u32 v3, v1, 1, s16
    s_mov_b32 s22, 8
Lex_98:
    v_subrev_u32 v4, 0, v2
    v_cvt_f32_u32 v6, v4
    v_cvt_pk_bf16_f32 v6, v6, v6
    v_and_b32 v6, 0xffff, v6
    v_subrev_u32 v6, 0x4280, v6
    v_cmp_gt_u32 vcc, 128, v4
    s_nop 1
    v_cndmask_b32 v5, v6, v4, vcc
    v_lshl_add_u32 v5, v5, 1, s16
    ds_read_u16 v10, v5 offset:24304
    v_subrev_u32 v4, 64, v2
    v_cvt_f32_u32 v6, v4
    v_cvt_pk_bf16_f32 v6, v6, v6
    v_and_b32 v6, 0xffff, v6
    v_subrev_u32 v6, 0x4280, v6
    v_cmp_gt_u32 vcc, 128, v4
    s_nop 1
    v_cndmask_b32 v5, v6, v4, vcc
    v_lshl_add_u32 v5, v5, 1, s16
    ds_read_u16 v11, v5 offset:24304
    v_subrev_u32 v4, 128, v2
    v_cvt_f32_u32 v6, v4
    v_cvt_pk_bf16_f32 v6, v6, v6
    v_and_b32 v6, 0xffff, v6
    v_subrev_u32 v6, 0x4280, v6
    v_cmp_gt_u32 vcc, 128, v4
    s_nop 1
    v_cndmask_b32 v5, v6, v4, vcc
    v_lshl_add_u32 v5, v5, 1, s16
    ds_read_u16 v12, v5 offset:24304
    v_subrev_u32 v4, 192, v2
    v_cvt_f32_u32 v6, v4
    v_cvt_pk_bf16_f32 v6, v6, v6
    v_and_b32 v6, 0xffff, v6
    v_subrev_u32 v6, 0x4280, v6
    v_cmp_gt_u32 vcc, 128, v4
    s_nop 1
    v_cndmask_b32 v5, v6, v4, vcc
    v_lshl_add_u32 v5, v5, 1, s16
    ds_read_u16 v13, v5 offset:24304
    s_waitcnt lgkmcnt(3)
    ds_write_b16 v3, v10 offset:64
    ds_write_b16 v3, v10 offset:4222
    ds_write_b16 v3, v10 offset:8380
    ds_write_b16 v3, v10 offset:12538
    s_waitcnt lgkmcnt(6)
    ds_write_b16 v3, v11 offset:192
    ds_write_b16 v3, v11 offset:4350
    ds_write_b16 v3, v11 offset:8508
    ds_write_b16 v3, v11 offset:12666
    s_waitcnt lgkmcnt(9)
    ds_write_b16 v3, v12 offset:320
    ds_write_b16 v3, v12 offset:4478
    ds_write_b16 v3, v12 offset:8636
    ds_write_b16 v3, v12 offset:12794
    s_waitcnt lgkmcnt(12)
    ds_write_b16 v3, v13 offset:448
    ds_write_b16 v3, v13 offset:4606
    ds_write_b16 v3, v13 offset:8764
    ds_write_b16 v3, v13 offset:12922
    v_subrev_u32 v2, 256, v2
    v_add_u32 v3, 512, v3
    s_waitcnt lgkmcnt(0)
    s_sub_u32 s22, s22, 1
    s_cmp_lg_u32 s22, 0
    s_cbranch_scc1 Lex_98
    s_barrier
    v_mov_b32 v64, 0
    v_mov_b32 v65, 0
    v_mov_b32 v66, 0
    v_mov_b32 v67, 0
    v_mov_b32 v68, 0
    v_mov_b32 v69, 0
    v_mov_b32 v70, 0
    v_mov_b32 v71, 0
    v_mov_b32 v72, 0
    v_mov_b32 v73, 0
    v_mov_b32 v74, 0
    v_mov_b32 v75, 0
    v_mov_b32 v76, 0
    v_mov_b32 v77, 0
    v_mov_b32 v78, 0
    v_mov_b32 v79, 0
    v_mov_b32 v80, 0
    v_mov_b32 v81, 0
    v_mov_b32 v82, 0
    v_mov_b32 v83, 0
    v_mov_b32 v84, 0
    v_mov_b32 v85, 0
    v_mov_b32 v86, 0
    v_mov_b32 v87, 0
    v_mov_b32 v88, 0
    v_mov_b32 v89, 0
    v_mov_b32 v90, 0
    v_mov_b32 v91, 0
    v_mov_b32 v92, 0
    v_mov_b32 v93, 0
    v_mov_b32 v94, 0
    v_mov_b32 v95, 0
    v_subrev_u32 v153, 64, v153
    v_subrev_u32 v154, 80, v154
    ds_read_b64 v[128:129], v153 offset:64
    ds_read_b64 v[130:131], v153 offset:72
    ds_read_b128 v[136:139], v154 offset:2640
    ds_read_b128 v[140:143], v154 offset:80
    s_mov_b32 s22, 32
Lcv_99:
    ds_read_b64 v[132:133], v153 offset:96
    ds_read_b64 v[134:135], v153 offset:104
    ds_read_b128 v[144:147], v154 offset:2672
    ds_read_b128 v[148:151], v154 offset:112
    s_waitcnt lgkmcnt(4)
    v_mfma_f32_32x32x16_bf16 v[80:95], v[128:131], v[136:139], v[80:95]
    v_mfma_f32_32x32x16_bf16 v[64:79], v[128:131], v[140:143], v[64:79]
    ds_read_b64 v[128:129], v153 offset:0
    ds_read_b64 v[130:131], v153 offset:8
    ds_read_b128 v[136:139], v154 offset:2560
    ds_read_b128 v[140:143], v154 offset:0
    s_waitcnt lgkmcnt(4)
    v_mfma_f32_32x32x16_bf16 v[80:95], v[132:135], v[144:147], v[80:95]
    v_mfma_f32_32x32x16_bf16 v[64:79], v[132:135], v[148:151], v[64:79]
    v_subrev_u32 v153, 64, v153
    v_subrev_u32 v154, 80, v154
    s_sub_u32 s22, s22, 1
    s_cmp_lg_u32 s22, 0
    s_cbranch_scc1 Lcv_99
    s_mov_b32 s22, 32
Lcv_100:
    ds_read_b64 v[132:133], v153 offset:96
    ds_read_b64 v[134:135], v153 offset:104
    ds_read_b128 v[144:147], v154 offset:2672
    s_waitcnt lgkmcnt(3)
    v_mfma_f32_32x32x16_bf16 v[80:95], v[128:131], v[136:139], v[80:95]
    ds_read_b64 v[128:129], v153 offset:0
    ds_read_b64 v[130:131], v153 offset:8
    ds_read_b128 v[136:139], v154 offset:2560
    s_waitcnt lgkmcnt(3)
    v_mfma_f32_32x32x16_bf16 v[80:95], v[132:135], v[144:147], v[80:95]
    v_subrev_u32 v153, 64, v153
    v_subrev_u32 v154, 80, v154
    s_sub_u32 s22, s22, 1
    s_cmp_lg_u32 s22, 0
    s_cbranch_scc1 Lcv_100
    s_waitcnt lgkmcnt(0)
    ds_read_b64 v[96:97], v155 offset:0
    ds_read_b64 v[98:99], v155 offset:16
    ds_read_b64 v[100:101], v155 offset:32
    ds_read_b64 v[102:103], v155 offset:48
    ds_read_b64 v[104:105], v155 offset:2560
    ds_read_b64 v[106:107], v155 offset:2576
    ds_read_b64 v[108:109], v155 offset:2592
    ds_read_b64 v[110:111], v155 offset:2608
    s_nop 7
    s_waitcnt lgkmcnt(0)
    v_lshlrev_b32 v2, 16, v96
    v_and_b32 v3, 0xffff0000, v96
    v_mul_f32 v2, v2, v158
    v_mul_f32 v3, v3, v158
    v_cvt_pk_bf16_f32 v4, v2, v3
    v_cvt_pk_bf16_f32 v5, v64, v65
    v_lshlrev_b32 v2, 16, v4
    v_and_b32 v3, 0xffff0000, v4
    v_lshlrev_b32 v6, 16, v5
    v_and_b32 v7, 0xffff0000, v5
    v_add_f32 v2, v2, v6
    v_add_f32 v3, v3, v7
    v_cvt_pk_bf16_f32 v4, v2, v3
    ds_write_b16 v156, v4 offset:0
    ds_write_b16_d16_hi v156, v4 offset:8
    v_lshlrev_b32 v2, 16, v97
    v_and_b32 v3, 0xffff0000, v97
    v_mul_f32 v2, v2, v158
    v_mul_f32 v3, v3, v158
    v_cvt_pk_bf16_f32 v4, v2, v3
    v_cvt_pk_bf16_f32 v5, v66, v67
    v_lshlrev_b32 v2, 16, v4
    v_and_b32 v3, 0xffff0000, v4
    v_lshlrev_b32 v6, 16, v5
    v_and_b32 v7, 0xffff0000, v5
    v_add_f32 v2, v2, v6
    v_add_f32 v3, v3, v7
    v_cvt_pk_bf16_f32 v4, v2, v3
    ds_write_b16 v156, v4 offset:16
    ds_write_b16_d16_hi v156, v4 offset:24
    s_waitcnt lgkmcnt(0)
    v_lshlrev_b32 v2, 16, v98
    v_and_b32 v3, 0xffff0000, v98
    v_mul_f32 v2, v2, v158
    v_mul_f32 v3, v3, v158
    v_cvt_pk_bf16_f32 v4, v2, v3
    v_cvt_pk_bf16_f32 v5, v68, v69
    v_lshlrev_b32 v2, 16, v4
    v_and_b32 v3, 0xffff0000, v4
    v_lshlrev_b32 v6, 16, v5
    v_and_b32 v7, 0xffff0000, v5
    v_add_f32 v2, v2, v6
    v_add_f32 v3, v3, v7
    v_cvt_pk_bf16_f32 v4, v2, v3
    ds_write_b16 v156, v4 offset:64
    ds_write_b16_d16_hi v156, v4 offset:72
    v_lshlrev_b32 v2, 16, v99
    v_and_b32 v3, 0xffff0000, v99
    v_mul_f32 v2, v2, v158
    v_mul_f32 v3, v3, v158
    v_cvt_pk_bf16_f32 v4, v2, v3
    v_cvt_pk_bf16_f32 v5, v70, v71
    v_lshlrev_b32 v2, 16, v4
    v_and_b32 v3, 0xffff0000, v4
    v_lshlrev_b32 v6, 16, v5
    v_and_b32 v7, 0xffff0000, v5
    v_add_f32 v2, v2, v6
    v_add_f32 v3, v3, v7
    v_cvt_pk_bf16_f32 v4, v2, v3
    ds_write_b16 v156, v4 offset:80
    ds_write_b16_d16_hi v156, v4 offset:88
    s_waitcnt lgkmcnt(0)
    v_lshlrev_b32 v2, 16, v100
    v_and_b32 v3, 0xffff0000, v100
    v_mul_f32 v2, v2, v158
    v_mul_f32 v3, v3, v158
    v_cvt_pk_bf16_f32 v4, v2, v3
    v_cvt_pk_bf16_f32 v5, v72, v73
    v_lshlrev_b32 v2, 16, v4
    v_and_b32 v3, 0xffff0000, v4
    v_lshlrev_b32 v6, 16, v5
    v_and_b32 v7, 0xffff0000, v5
    v_add_f32 v2, v2, v6
    v_add_f32 v3, v3, v7
    v_cvt_pk_bf16_f32 v4, v2, v3
    ds_write_b16 v156, v4 offset:128
    ds_write_b16_d16_hi v156, v4 offset:136
    v_lshlrev_b32 v2, 16, v101
    v_and_b32 v3, 0xffff0000, v101
    v_mul_f32 v2, v2, v158
    v_mul_f32 v3, v3, v158
    v_cvt_pk_bf16_f32 v4, v2, v3
    v_cvt_pk_bf16_f32 v5, v74, v75
    v_lshlrev_b32 v2, 16, v4
    v_and_b32 v3, 0xffff0000, v4
    v_lshlrev_b32 v6, 16, v5
    v_and_b32 v7, 0xffff0000, v5
    v_add_f32 v2, v2, v6
    v_add_f32 v3, v3, v7
    v_cvt_pk_bf16_f32 v4, v2, v3
    ds_write_b16 v156, v4 offset:144
    ds_write_b16_d16_hi v156, v4 offset:152
    s_waitcnt lgkmcnt(0)
    v_lshlrev_b32 v2, 16, v102
    v_and_b32 v3, 0xffff0000, v102
    v_mul_f32 v2, v2, v158
    v_mul_f32 v3, v3, v158
    v_cvt_pk_bf16_f32 v4, v2, v3
    v_cvt_pk_bf16_f32 v5, v76, v77
    v_lshlrev_b32 v2, 16, v4
    v_and_b32 v3, 0xffff0000, v4
    v_lshlrev_b32 v6, 16, v5
    v_and_b32 v7, 0xffff0000, v5
    v_add_f32 v2, v2, v6
    v_add_f32 v3, v3, v7
    v_cvt_pk_bf16_f32 v4, v2, v3
    ds_write_b16 v156, v4 offset:192
    ds_write_b16_d16_hi v156, v4 offset:200
    v_lshlrev_b32 v2, 16, v103
    v_and_b32 v3, 0xffff0000, v103
    v_mul_f32 v2, v2, v158
    v_mul_f32 v3, v3, v158
    v_cvt_pk_bf16_f32 v4, v2, v3
    v_cvt_pk_bf16_f32 v5, v78, v79
    v_lshlrev_b32 v2, 16, v4
    v_and_b32 v3, 0xffff0000, v4
    v_lshlrev_b32 v6, 16, v5
    v_and_b32 v7, 0xffff0000, v5
    v_add_f32 v2, v2, v6
    v_add_f32 v3, v3, v7
    v_cvt_pk_bf16_f32 v4, v2, v3
    ds_write_b16 v156, v4 offset:208
    ds_write_b16_d16_hi v156, v4 offset:216
    s_waitcnt lgkmcnt(0)
    v_lshlrev_b32 v2, 16, v104
    v_and_b32 v3, 0xffff0000, v104
    v_mul_f32 v2, v2, v158
    v_mul_f32 v3, v3, v158
    v_cvt_pk_bf16_f32 v4, v2, v3
    v_cvt_pk_bf16_f32 v5, v80, v81
    v_lshlrev_b32 v2, 16, v4
    v_and_b32 v3, 0xffff0000, v4
    v_lshlrev_b32 v6, 16, v5
    v_and_b32 v7, 0xffff0000, v5
    v_add_f32 v2, v2, v6
    v_add_f32 v3, v3, v7
    v_cvt_pk_bf16_f32 v4, v2, v3
    ds_write_b16 v156, v4 offset:8704
    ds_write_b16_d16_hi v156, v4 offset:8712
    v_lshlrev_b32 v2, 16, v105
    v_and_b32 v3, 0xffff0000, v105
    v_mul_f32 v2, v2, v158
    v_mul_f32 v3, v3, v158
    v_cvt_pk_bf16_f32 v4, v2, v3
    v_cvt_pk_bf16_f32 v5, v82, v83
    v_lshlrev_b32 v2, 16, v4
    v_and_b32 v3, 0xffff0000, v4
    v_lshlrev_b32 v6, 16, v5
    v_and_b32 v7, 0xffff0000, v5
    v_add_f32 v2, v2, v6
    v_add_f32 v3, v3, v7
    v_cvt_pk_bf16_f32 v4, v2, v3
    ds_write_b16 v156, v4 offset:8720
    ds_write_b16_d16_hi v156, v4 offset:8728
    s_waitcnt lgkmcnt(0)
    v_lshlrev_b32 v2, 16, v106
    v_and_b32 v3, 0xffff0000, v106
    v_mul_f32 v2, v2, v158
    v_mul_f32 v3, v3, v158
    v_cvt_pk_bf16_f32 v4, v2, v3
    v_cvt_pk_bf16_f32 v5, v84, v85
    v_lshlrev_b32 v2, 16, v4
    v_and_b32 v3, 0xffff0000, v4
    v_lshlrev_b32 v6, 16, v5
    v_and_b32 v7, 0xffff0000, v5
    v_add_f32 v2, v2, v6
    v_add_f32 v3, v3, v7
    v_cvt_pk_bf16_f32 v4, v2, v3
    ds_write_b16 v156, v4 offset:8768
    ds_write_b16_d16_hi v156, v4 offset:8776
    v_lshlrev_b32 v2, 16, v107
    v_and_b32 v3, 0xffff0000, v107
    v_mul_f32 v2, v2, v158
    v_mul_f32 v3, v3, v158
    v_cvt_pk_bf16_f32 v4, v2, v3
    v_cvt_pk_bf16_f32 v5, v86, v87
    v_lshlrev_b32 v2, 16, v4
    v_and_b32 v3, 0xffff0000, v4
    v_lshlrev_b32 v6, 16, v5
    v_and_b32 v7, 0xffff0000, v5
    v_add_f32 v2, v2, v6
    v_add_f32 v3, v3, v7
    v_cvt_pk_bf16_f32 v4, v2, v3
    ds_write_b16 v156, v4 offset:8784
    ds_write_b16_d16_hi v156, v4 offset:8792
    s_waitcnt lgkmcnt(0)
    v_lshlrev_b32 v2, 16, v108
    v_and_b32 v3, 0xffff0000, v108
    v_mul_f32 v2, v2, v158
    v_mul_f32 v3, v3, v158
    v_cvt_pk_bf16_f32 v4, v2, v3
    v_cvt_pk_bf16_f32 v5, v88, v89
    v_lshlrev_b32 v2, 16, v4
    v_and_b32 v3, 0xffff0000, v4
    v_lshlrev_b32 v6, 16, v5
    v_and_b32 v7, 0xffff0000, v5
    v_add_f32 v2, v2, v6
    v_add_f32 v3, v3, v7
    v_cvt_pk_bf16_f32 v4, v2, v3
    ds_write_b16 v156, v4 offset:8832
    ds_write_b16_d16_hi v156, v4 offset:8840
    v_lshlrev_b32 v2, 16, v109
    v_and_b32 v3, 0xffff0000, v109
    v_mul_f32 v2, v2, v158
    v_mul_f32 v3, v3, v158
    v_cvt_pk_bf16_f32 v4, v2, v3
    v_cvt_pk_bf16_f32 v5, v90, v91
    v_lshlrev_b32 v2, 16, v4
    v_and_b32 v3, 0xffff0000, v4
    v_lshlrev_b32 v6, 16, v5
    v_and_b32 v7, 0xffff0000, v5
    v_add_f32 v2, v2, v6
    v_add_f32 v3, v3, v7
    v_cvt_pk_bf16_f32 v4, v2, v3
    ds_write_b16 v156, v4 offset:8848
    ds_write_b16_d16_hi v156, v4 offset:8856
    s_waitcnt lgkmcnt(0)
    v_lshlrev_b32 v2, 16, v110
    v_and_b32 v3, 0xffff0000, v110
    v_mul_f32 v2, v2, v158
    v_mul_f32 v3, v3, v158
    v_cvt_pk_bf16_f32 v4, v2, v3
    v_cvt_pk_bf16_f32 v5, v92, v93
    v_lshlrev_b32 v2, 16, v4
    v_and_b32 v3, 0xffff0000, v4
    v_lshlrev_b32 v6, 16, v5
    v_and_b32 v7, 0xffff0000, v5
    v_add_f32 v2, v2, v6
    v_add_f32 v3, v3, v7
    v_cvt_pk_bf16_f32 v4, v2, v3
    ds_write_b16 v156, v4 offset:8896
    ds_write_b16_d16_hi v156, v4 offset:8904
    v_lshlrev_b32 v2, 16, v111
    v_and_b32 v3, 0xffff0000, v111
    v_mul_f32 v2, v2, v158
    v_mul_f32 v3, v3, v158
    v_cvt_pk_bf16_f32 v4, v2, v3
    v_cvt_pk_bf16_f32 v5, v94, v95
    v_lshlrev_b32 v2, 16, v4
    v_and_b32 v3, 0xffff0000, v4
    v_lshlrev_b32 v6, 16, v5
    v_and_b32 v7, 0xffff0000, v5
    v_add_f32 v2, v2, v6
    v_add_f32 v3, v3, v7
    v_cvt_pk_bf16_f32 v4, v2, v3
    ds_write_b16 v156, v4 offset:8912
    ds_write_b16_d16_hi v156, v4 offset:8920
    s_waitcnt lgkmcnt(0)
    s_barrier
    v_lshlrev_b32 v3, 4, v250
    v_lshrrev_b32 v2, 4, v250
    v_lshl_add_u32 v2, v2, 4, v3
    v_add_u32 v2, 111104, v2
    ds_read_b128 v[96:99], v2 offset:0
    ds_read_b128 v[100:103], v2 offset:4352
    ds_read_b128 v[104:107], v2 offset:8704
    ds_read_b128 v[108:111], v2 offset:13056
    s_lshl_b32 s18, s85, 12
    s_add_u32 s18, s18, 83886080
    s_waitcnt lgkmcnt(0)
    s_add_u32 s19, s18, 0
    buffer_store_dwordx4 v[96:99], v3, s[4:7], s19 offen sc1
    s_add_u32 s19, s18, 4096
    buffer_store_dwordx4 v[100:103], v3, s[4:7], s19 offen sc1
    s_add_u32 s19, s18, 8192
    buffer_store_dwordx4 v[104:107], v3, s[4:7], s19 offen sc1
    s_add_u32 s19, s18, 12288
    buffer_store_dwordx4 v[108:111], v3, s[4:7], s19 offen sc1
    s_mov_b32 s92, 104410880
    s_waitcnt vmcnt(0)
    s_barrier
    s_cmp_lg_u32 s14, 0
    s_cbranch_scc1 Lsg_101
    s_mov_b64 exec, 1
    v_mov_b32 v2, 1
    v_mov_b32 v3, s92
    buffer_atomic_add v2, v3, s[4:7], 0 offen sc1
    s_mov_b64 exec, -1
Lsg_101:
    s_branch Lssm
Lssmd:
    s_cmp_ge_u32 s13, 28
    s_cbranch_scc1 Lcomb
    s_mov_b32 s92, 128
    s_cmp_lg_u32 s14, 0
    s_cbranch_scc1 Lwd_103
    v_mov_b32 v3, s92
Lwd_102:
    buffer_load_dword v2, v3, s[96:99], 0 offen sc1
    s_waitcnt vmcnt(0)
    v_readfirstlane_b32 s84, v2
    s_add_u32 s81, s81, 1
    s_cmp_gt_u32 s81, 0x200000
    s_cbranch_scc1 fused_kernel_exit
    s_lshr_b32 s84, s84, 0
    s_and_b32 s84, s84, 4294967295
    s_cmp_ge_u32 s84, 4194432
    s_cbranch_scc1 Lwd_103
    s_sleep 8
    s_branch Lwd_102
Lwd_103:
    s_barrier
    s_mov_b32 s92, 132
    s_cmp_lg_u32 s14, 0
    s_cbranch_scc1 Lwd_105
    v_mov_b32 v3, s92
Lwd_104:
    buffer_load_dword v2, v3, s[96:99], 0 offen sc1
    s_waitcnt vmcnt(0)
    v_readfirstlane_b32 s84, v2
    s_add_u32 s81, s81, 1
    s_cmp_gt_u32 s81, 0x200000
    s_cbranch_scc1 fused_kernel_exit
    s_lshr_b32 s84, s84, 0
    s_and_b32 s84, s84, 4294967295
    s_cmp_ge_u32 s84, 4194432
    s_cbranch_scc1 Lwd_105
    s_sleep 8
    s_branch Lwd_104
Lwd_105:
    s_barrier
    s_mov_b32 s92, 136
    s_cmp_lg_u32 s14, 0
    s_cbranch_scc1 Lwd_107
    v_mov_b32 v3, s92
Lwd_106:
    buffer_load_dword v2, v3, s[96:99], 0 offen sc1
    s_waitcnt vmcnt(0)
    v_readfirstlane_b32 s84, v2
    s_add_u32 s81, s81, 1
    s_cmp_gt_u32 s81, 0x200000
    s_cbranch_scc1 fused_kernel_exit
    s_lshr_b32 s84, s84, 0
    s_and_b32 s84, s84, 4294967295
    s_cmp_ge_u32 s84, 4194432
    s_cbranch_scc1 Lwd_107
    s_sleep 8
    s_branch Lwd_106
Lwd_107:
    s_barrier
    s_mov_b32 s92, 140
    s_cmp_lg_u32 s14, 0
    s_cbranch_scc1 Lwd_109
    v_mov_b32 v3, s92
Lwd_108:
    buffer_load_dword v2, v3, s[96:99], 0 offen sc1
    s_waitcnt vmcnt(0)
    v_readfirstlane_b32 s84, v2
    s_add_u32 s81, s81, 1
    s_cmp_gt_u32 s81, 0x200000
    s_cbranch_scc1 fused_kernel_exit
    s_lshr_b32 s84, s84, 0
    s_and_b32 s84, s84, 4294967295
    s_cmp_ge_u32 s84, 4194432
    s_cbranch_scc1 Lwd_109
    s_sleep 8
    s_branch Lwd_108
Lwd_109:
    s_barrier
    s_mov_b32 s92, 144
    s_cmp_lg_u32 s14, 0
    s_cbranch_scc1 Lwd_111
    v_mov_b32 v3, s92
Lwd_110:
    buffer_load_dword v2, v3, s[96:99], 0 offen sc1
    s_waitcnt vmcnt(0)
    v_readfirstlane_b32 s84, v2
    s_add_u32 s81, s81, 1
    s_cmp_gt_u32 s81, 0x200000
    s_cbranch_scc1 fused_kernel_exit
    s_lshr_b32 s84, s84, 0
    s_and_b32 s84, s84, 4294967295
    s_cmp_ge_u32 s84, 4194432
    s_cbranch_scc1 Lwd_111
    s_sleep 8
    s_branch Lwd_110
Lwd_111:
    s_barrier
    s_mov_b32 s92, 148
    s_cmp_lg_u32 s14, 0
    s_cbranch_scc1 Lwd_113
    v_mov_b32 v3, s92
Lwd_112:
    buffer_load_dword v2, v3, s[96:99], 0 offen sc1
    s_waitcnt vmcnt(0)
    v_readfirstlane_b32 s84, v2
    s_add_u32 s81, s81, 1
    s_cmp_gt_u32 s81, 0x200000
    s_cbranch_scc1 fused_kernel_exit
    s_lshr_b32 s84, s84, 0
    s_and_b32 s84, s84, 4294967295
    s_cmp_ge_u32 s84, 4194432
    s_cbranch_scc1 Lwd_113
    s_sleep 8
    s_branch Lwd_112
Lwd_113:
    s_barrier
    s_mov_b32 s92, 152
    s_cmp_lg_u32 s14, 0
    s_cbranch_scc1 Lwd_115
    v_mov_b32 v3, s92
Lwd_114:
    buffer_load_dword v2, v3, s[96:99], 0 offen sc1
    s_waitcnt vmcnt(0)
    v_readfirstlane_b32 s84, v2
    s_add_u32 s81, s81, 1
    s_cmp_gt_u32 s81, 0x200000
    s_cbranch_scc1 fused_kernel_exit
    s_lshr_b32 s84, s84, 0
    s_and_b32 s84, s84, 4294967295
    s_cmp_ge_u32 s84, 4194432
    s_cbranch_scc1 Lwd_115
    s_sleep 8
    s_branch Lwd_114
Lwd_115:
    s_barrier
    s_mov_b32 s92, 156
    s_cmp_lg_u32 s14, 0
    s_cbranch_scc1 Lwd_117
    v_mov_b32 v3, s92
Lwd_116:
    buffer_load_dword v2, v3, s[96:99], 0 offen sc1
    s_waitcnt vmcnt(0)
    v_readfirstlane_b32 s84, v2
    s_add_u32 s81, s81, 1
    s_cmp_gt_u32 s81, 0x200000
    s_cbranch_scc1 fused_kernel_exit
    s_lshr_b32 s84, s84, 0
    s_and_b32 s84, s84, 4294967295
    s_cmp_ge_u32 s84, 4194432
    s_cbranch_scc1 Lwd_117
    s_sleep 8
    s_branch Lwd_116
Lwd_117:
    s_barrier
    v_mov_b32 v3, 40
    buffer_load_dword v2, v3, s[96:99], 0 offen sc1
    s_waitcnt vmcnt(0)
    v_readfirstlane_b32 s35, v2
    s_cmp_lt_u32 s13, 20
    s_cbranch_scc1 Lop
Lnext:
    s_cmp_lg_u32 s14, 0
    s_cbranch_scc1 Ltk
    s_mov_b64 exec, 1
    v_mov_b32 v2, 1
    s_lshl_b32 s84, s3, 7
    s_add_u32 s84, s84, 104410112
    v_mov_b32 v3, s84
    buffer_atomic_add v2, v3, s[4:7], 0 offen sc0 sc1
    s_waitcnt vmcnt(0)
    v_mov_b32 v3, 151488
    ds_write_b32 v3, v2
    s_waitcnt lgkmcnt(0)
    s_mov_b64 exec, -1
Ltk:
    s_barrier
    v_mov_b32 v3, 151488
    ds_read_b32 v2, v3
    s_waitcnt lgkmcnt(0)
    v_readfirstlane_b32 s80, v2
    s_barrier
    s_cmp_lt_u32 s80, 128
    s_cbranch_scc1 Latk
    s_cmp_lt_u32 s13, 20
    s_cbranch_scc1 Lopb
    s_branch Lcomb
Latk:
    s_lshr_b32 s86, s80, 3
    s_and_b32 s85, s80, 7
    s_lshl_b32 s84, s3, 3
    s_add_u32 s85, s85, s84
    s_barrier
    s_lshl_b32 s16, s14, 13
    s_add_u32 s16, s16, 98304
    v_and_b32 v19, 31, v1
    v_lshrrev_b32 v20, 5, v1
    v_and_b32 v29, 7, v1
    v_xor_b32 v20, v20, v29
    v_lshlrev_b32 v19, 7, v19
    v_add_u32 v19, s16, v19
    v_xor_b32 v25, 0, v20
    v_lshl_add_u32 v25, v25, 4, v19
    v_xor_b32 v26, 2, v20
    v_lshl_add_u32 v26, v26, 4, v19
    v_xor_b32 v27, 4, v20
    v_lshl_add_u32 v27, v27, 4, v19
    v_xor_b32 v28, 6, v20
    v_lshl_add_u32 v28, v28, 4, v19
    v_lshrrev_b32 v19, 3, v1
    v_xor_b32 v20, v29, v19
    v_lshlrev_b32 v19, 7, v19
    v_lshl_add_u32 v19, v20, 4, v19
    v_add_u32 v29, s16, v19
    v_lshrrev_b32 v19, 3, v1
    s_mov_b32 s16, 8320
    v_mul_lo_u32 v19, v19, s16
    v_and_b32 v18, 7, v1
    v_lshl_add_u32 v18, v18, 4, v19
    v_lshrrev_b32 v19, 4, v1
    v_and_b32 v20, 15, v1
    v_xor_b32 v20, v20, v19
    v_xor_b32 v21, 0, v20
    v_lshlrev_b32 v21, 4, v21
    v_mul_u32_u24 v22, 8320, v19
    v_add_u32 v2, v22, v21
    v_mul_u32_u24 v22, 4224, v19
    v_add_u32 v6, v22, v21
    v_xor_b32 v21, 4, v20
    v_lshlrev_b32 v21, 4, v21
    v_mul_u32_u24 v22, 8320, v19
    v_add_u32 v3, v22, v21
    v_mul_u32_u24 v22, 4224, v19
    v_add_u32 v7, v22, v21
    v_xor_b32 v21, 8, v20
    v_lshlrev_b32 v21, 4, v21
    v_mul_u32_u24 v22, 8320, v19
    v_add_u32 v4, v22, v21
    v_mul_u32_u24 v22, 4224, v19
    v_add_u32 v8, v22, v21
    v_xor_b32 v21, 12, v20
    v_lshlrev_b32 v21, 4, v21
    v_mul_u32_u24 v22, 8320, v19
    v_add_u32 v5, v22, v21
    v_mul_u32_u24 v22, 4224, v19
    v_add_u32 v9, v22, v21
    v_and_b32 v19, 31, v1
    v_lshrrev_b32 v20, 5, v1
    s_lshl_b32 s16, s14, 13
    v_lshlrev_b32 v21, 8, v19
    v_add_u32 v10, s16, v21
    v_and_b32 v21, 15, v19
    v_xor_b32 v12, v21, v20
    v_and_b32 v22, 0x13, v19
    v_bfe_u32 v23, v19, 2, 1
    v_lshl_add_u32 v22, v23, 3, v22
    v_bfe_u32 v23, v19, 3, 1
    v_lshl_add_u32 v22, v23, 2, v22
    v_lshlrev_b32 v23, 8, v22
    v_add_u32 v23, 32768, v23
    v_add_u32 v11, s16, v23
    v_and_b32 v22, 15, v22
    v_xor_b32 v13, v22, v20
    s_lshl_b32 s17, s14, 2
    s_add_u32 s18, s17, 0
    v_xor_b32 v22, s18, v12
    v_lshlrev_b32 v22, 4, v22
    v_lshl_add_u32 v22, v19, 8, v22
    v_add_u32 v14, 65536, v22
    s_add_u32 s18, s17, 2
    v_xor_b32 v22, s18, v12
    v_lshlrev_b32 v22, 4, v22
    v_lshl_add_u32 v22, v19, 8, v22
    v_add_u32 v15, 65536, v22
    v_lshlrev_b32 v21, 4, v20
    v_and_b32 v22, 7, v19
    v_lshl_add_u32 v16, v22, 6, v21
    v_lshlrev_b32 v22, 3, v20
    v_lshl_add_u32 v17, v19, 4, v22
    v_sub_u32 v22, v19, v22
    v_mov_b32 v23, 0xff800000
    v_cmp_gt_i32 vcc, 0, v22
    s_nop 1
    v_cndmask_b32 v32, 0, v23, vcc
    v_cmp_gt_i32 vcc, 1, v22
    s_nop 1
    v_cndmask_b32 v33, 0, v23, vcc
    v_cmp_gt_i32 vcc, 2, v22
    s_nop 1
    v_cndmask_b32 v34, 0, v23, vcc
    v_cmp_gt_i32 vcc, 3, v22
    s_nop 1
    v_cndmask_b32 v35, 0, v23, vcc
    v_cmp_gt_i32 vcc, 4, v22
    s_nop 1
    v_cndmask_b32 v36, 0, v23, vcc
    v_cmp_gt_i32 vcc, 5, v22
    s_nop 1
    v_cndmask_b32 v37, 0, v23, vcc
    v_cmp_gt_i32 vcc, 6, v22
    s_nop 1
    v_cndmask_b32 v38, 0, v23, vcc
    v_cmp_gt_i32 vcc, 7, v22
    s_nop 1
    v_cndmask_b32 v39, 0, v23, vcc
    v_cmp_gt_i32 vcc, 16, v22
    s_nop 1
    v_cndmask_b32 v40, 0, v23, vcc
    v_cmp_gt_i32 vcc, 17, v22
    s_nop 1
    v_cndmask_b32 v41, 0, v23, vcc
    v_cmp_gt_i32 vcc, 18, v22
    s_nop 1
    v_cndmask_b32 v42, 0, v23, vcc
    v_cmp_gt_i32 vcc, 19, v22
    s_nop 1
    v_cndmask_b32 v43, 0, v23, vcc
    v_cmp_gt_i32 vcc, 20, v22
    s_nop 1
    v_cndmask_b32 v44, 0, v23, vcc
    v_cmp_gt_i32 vcc, 21, v22
    s_nop 1
    v_cndmask_b32 v45, 0, v23, vcc
    v_cmp_gt_i32 vcc, 22, v22
    s_nop 1
    v_cndmask_b32 v46, 0, v23, vcc
    v_cmp_gt_i32 vcc, 23, v22
    s_nop 1
    v_cndmask_b32 v47, 0, v23, vcc
    s_lshl_b32 s24, s86, 2
    s_add_u32 s24, s24, s14
    s_mul_i32 s16, s24, 266240
    s_lshl_b32 s17, s85, 8
    s_add_u32 s16, s16, s17
    s_add_u32 s20, s16, 56623104
    s_lshl_b32 s25, s14, 13
    s_lshl_b32 s18, s85, 2
    s_add_u32 s18, s18, s14
    s_mul_i32 s18, s18, 135168
    s_lshl_b32 s19, s86, 8
    s_add_u32 s18, s18, s19
    s_add_u32 m0, s25, 65536
    s_add_u32 s23, s18, 18874368
    buffer_load_dwordx4 v6, s[4:7], s23 offen lds
    s_add_u32 m0, s25, 66560
    s_add_u32 s23, s18, 18891264
    buffer_load_dwordx4 v7, s[4:7], s23 offen lds
    s_add_u32 m0, s25, 67584
    s_add_u32 s23, s18, 18908160
    buffer_load_dwordx4 v8, s[4:7], s23 offen lds
    s_add_u32 m0, s25, 68608
    s_add_u32 s23, s18, 18925056
    buffer_load_dwordx4 v9, s[4:7], s23 offen lds
    s_add_u32 m0, s25, 69632
    s_add_u32 s23, s18, 18941952
    buffer_load_dwordx4 v6, s[4:7], s23 offen lds
    s_add_u32 m0, s25, 70656
    s_add_u32 s23, s18, 18958848
    buffer_load_dwordx4 v7, s[4:7], s23 offen lds
    s_add_u32 m0, s25, 71680
    s_add_u32 s23, s18, 18975744
    buffer_load_dwordx4 v8, s[4:7], s23 offen lds
    s_add_u32 m0, s25, 72704
    s_add_u32 s23, s18, 18992640
    buffer_load_dwordx4 v9, s[4:7], s23 offen lds
    s_add_u32 m0, s25, 0
    s_add_u32 s23, s16, 37748736
    buffer_load_dwordx4 v2, s[4:7], s23 offen lds
    s_add_u32 m0, s25, 1024
    s_add_u32 s23, s16, 37782016
    buffer_load_dwordx4 v3, s[4:7], s23 offen lds
    s_add_u32 m0, s25, 2048
    s_add_u32 s23, s16, 37815296
    buffer_load_dwordx4 v4, s[4:7], s23 offen lds
    s_add_u32 m0, s25, 3072
    s_add_u32 s23, s16, 37848576
    buffer_load_dwordx4 v5, s[4:7], s23 offen lds
    s_add_u32 m0, s25, 4096
    s_add_u32 s23, s16, 37881856
    buffer_load_dwordx4 v2, s[4:7], s23 offen lds
    s_add_u32 m0, s25, 5120
    s_add_u32 s23, s16, 37915136
    buffer_load_dwordx4 v3, s[4:7], s23 offen lds
    s_add_u32 m0, s25, 6144
    s_add_u32 s23, s16, 37948416
    buffer_load_dwordx4 v4, s[4:7], s23 offen lds
    s_add_u32 m0, s25, 7168
    s_add_u32 s23, s16, 37981696
    buffer_load_dwordx4 v5, s[4:7], s23 offen lds
    s_add_u32 m0, s25, 32768
    s_add_u32 s23, s16, 0
    buffer_load_dwordx4 v2, s[4:7], s23 offen lds
    s_add_u32 m0, s25, 33792
    s_add_u32 s23, s16, 33280
    buffer_load_dwordx4 v3, s[4:7], s23 offen lds
    s_add_u32 m0, s25, 34816
    s_add_u32 s23, s16, 66560
    buffer_load_dwordx4 v4, s[4:7], s23 offen lds
    s_add_u32 m0, s25, 35840
    s_add_u32 s23, s16, 99840
    buffer_load_dwordx4 v5, s[4:7], s23 offen lds
    s_add_u32 m0, s25, 36864
    s_add_u32 s23, s16, 133120
    buffer_load_dwordx4 v2, s[4:7], s23 offen lds
    s_add_u32 m0, s25, 37888
    s_add_u32 s23, s16, 166400
    buffer_load_dwordx4 v3, s[4:7], s23 offen lds
    s_add_u32 m0, s25, 38912
    s_add_u32 s23, s16, 199680
    buffer_load_dwordx4 v4, s[4:7], s23 offen lds
    s_add_u32 m0, s25, 39936
    s_add_u32 s23, s16, 232960
    buffer_load_dwordx4 v5, s[4:7], s23 offen lds
    s_waitcnt vmcnt(0)
    s_barrier
    v_xor_b32 v19, 0, v12
    v_lshl_add_u32 v19, v19, 4, v10
    ds_read_b128 v[48:51], v19
    v_xor_b32 v20, 0, v13
    v_lshl_add_u32 v20, v20, 4, v11
    ds_read_b128 v[80:83], v20
    v_xor_b32 v19, 2, v12
    v_lshl_add_u32 v19, v19, 4, v10
    ds_read_b128 v[52:55], v19
    v_xor_b32 v20, 2, v13
    v_lshl_add_u32 v20, v20, 4, v11
    ds_read_b128 v[84:87], v20
    v_xor_b32 v19, 4, v12
    v_lshl_add_u32 v19, v19, 4, v10
    ds_read_b128 v[56:59], v19
    v_xor_b32 v20, 4, v13
    v_lshl_add_u32 v20, v20, 4, v11
    ds_read_b128 v[88:91], v20
    v_xor_b32 v19, 6, v12
    v_lshl_add_u32 v19, v19, 4, v10
    ds_read_b128 v[60:63], v19
    v_xor_b32 v20, 6, v13
    v_lshl_add_u32 v20, v20, 4, v11
    ds_read_b128 v[92:95], v20
    s_waitcnt lgkmcnt(0)
    v_xor_b32 v19, 8, v12
    v_lshl_add_u32 v19, v19, 4, v10
    ds_read_b128 v[64:67], v19
    v_xor_b32 v20, 8, v13
    v_lshl_add_u32 v20, v20, 4, v11
    ds_read_b128 v[96:99], v20
    v_xor_b32 v19, 10, v12
    v_lshl_add_u32 v19, v19, 4, v10
    ds_read_b128 v[68:71], v19
    v_xor_b32 v20, 10, v13
    v_lshl_add_u32 v20, v20, 4, v11
    ds_read_b128 v[100:103], v20
    v_xor_b32 v19, 12, v12
    v_lshl_add_u32 v19, v19, 4, v10
    ds_read_b128 v[72:75], v19
    v_xor_b32 v20, 12, v13
    v_lshl_add_u32 v20, v20, 4, v11
    ds_read_b128 v[104:107], v20
    v_xor_b32 v19, 14, v12
    v_lshl_add_u32 v19, v19, 4, v10
    ds_read_b128 v[76:79], v19
    v_xor_b32 v20, 14, v13
    v_lshl_add_u32 v20, v20, 4, v11
    ds_read_b128 v[108:111], v20
    s_waitcnt lgkmcnt(0)
    ds_read_b128 v[144:147], v14 offset:0
    ds_read_b128 v[148:151], v15 offset:0
    ds_read_b128 v[152:155], v14 offset:8192
    ds_read_b128 v[156:159], v15 offset:8192
    ds_read_b128 v[160:163], v14 offset:16384
    ds_read_b128 v[164:167], v15 offset:16384
    ds_read_b128 v[168:171], v14 offset:24576
    ds_read_b128 v[172:175], v15 offset:24576
    v_mfma_f32_32x32x16_bf16 v[184:199], v[80:83], v[48:51], 0
    v_mfma_f32_32x32x16_bf16 v[184:199], v[84:87], v[52:55], v[184:199]
    v_mfma_f32_32x32x16_bf16 v[184:199], v[88:91], v[56:59], v[184:199]
    v_mfma_f32_32x32x16_bf16 v[184:199], v[92:95], v[60:63], v[184:199]
    v_mfma_f32_32x32x16_bf16 v[184:199], v[96:99], v[64:67], v[184:199]
    v_mfma_f32_32x32x16_bf16 v[184:199], v[100:103], v[68:71], v[184:199]
    v_mfma_f32_32x32x16_bf16 v[184:199], v[104:107], v[72:75], v[184:199]
    v_mfma_f32_32x32x16_bf16 v[184:199], v[108:111], v[76:79], v[184:199]
    s_lshl_b32 s90, s85, 7
    s_add_u32 s90, s90, 104333312
    v_mov_b32 v19, s90
Lpw:
    buffer_load_dwordx4 v[216:219], v19, s[4:7], 0 offen sc1
    s_waitcnt vmcnt(0)
    v_min_u32 v216, v216, v217
    v_min3_u32 v216, v216, v218, v219
    s_nop 0
    v_readfirstlane_b32 s91, v216
    s_add_u32 s81, s81, 1
    s_cmp_gt_u32 s81, 0x200000
    s_cbranch_scc1 fused_kernel_exit
    s_cmp_gt_u32 s91, s24
    s_cbranch_scc1 Lpw2
    s_sleep 2
    s_branch Lpw
Lpw2:
    s_lshl_b32 s21, s24, 16
    s_lshl_b32 s19, s85, 11
    s_add_u32 s19, s19, s21
    s_add_u32 s22, s19, 75497472
    s_add_u32 s19, s19, 79691776
    buffer_load_dwordx4 v[112:115], v16, s[4:7], s22 offen offset:0
    buffer_load_dwordx4 v[116:119], v16, s[4:7], s22 offen offset:32
    buffer_load_dwordx4 v[120:123], v16, s[4:7], s22 offen offset:512
    buffer_load_dwordx4 v[124:127], v16, s[4:7], s22 offen offset:544
    buffer_load_dwordx4 v[128:131], v16, s[4:7], s22 offen offset:1024
    buffer_load_dwordx4 v[132:135], v16, s[4:7], s22 offen offset:1056
    buffer_load_dwordx4 v[136:139], v16, s[4:7], s22 offen offset:1536
    buffer_load_dwordx4 v[140:143], v16, s[4:7], s22 offen offset:1568
    buffer_load_dwordx2 v[176:177], v17, s[4:7], s19 offen offset:0
    buffer_load_dwordx2 v[178:179], v17, s[4:7], s19 offen offset:512
    buffer_load_dwordx2 v[180:181], v17, s[4:7], s19 offen offset:1024
    buffer_load_dwordx2 v[182:183], v17, s[4:7], s19 offen offset:1536
    s_mov_b32 s21, 0x3db504f3
    s_mov_b32 s22, 0x3fb8aa3b
    s_nop 3
    v_cvt_pk_bf16_f32 v19, v184, v185
    v_lshlrev_b32 v184, 16, v19
    v_and_b32 v185, 0xffff0000, v19
    v_cvt_pk_bf16_f32 v19, v186, v187
    v_lshlrev_b32 v186, 16, v19
    v_and_b32 v187, 0xffff0000, v19
    v_cvt_pk_bf16_f32 v19, v188, v189
    v_lshlrev_b32 v188, 16, v19
    v_and_b32 v189, 0xffff0000, v19
    v_cvt_pk_bf16_f32 v19, v190, v191
    v_lshlrev_b32 v190, 16, v19
    v_and_b32 v191, 0xffff0000, v19
    v_cvt_pk_bf16_f32 v19, v192, v193
    v_lshlrev_b32 v192, 16, v19
    v_and_b32 v193, 0xffff0000, v19
    v_cvt_pk_bf16_f32 v19, v194, v195
    v_lshlrev_b32 v194, 16, v19
    v_and_b32 v195, 0xffff0000, v19
    v_cvt_pk_bf16_f32 v19, v196, v197
    v_lshlrev_b32 v196, 16, v19
    v_and_b32 v197, 0xffff0000, v19
    v_cvt_pk_bf16_f32 v19, v198, v199
    v_lshlrev_b32 v198, 16, v19
    v_and_b32 v199, 0xffff0000, v19
    v_mul_f32 v184, s21, v184
    v_mul_f32 v185, s21, v185
    v_mul_f32 v186, s21, v186
    v_mul_f32 v187, s21, v187
    v_mul_f32 v188, s21, v188
    v_mul_f32 v189, s21, v189
    v_mul_f32 v190, s21, v190
    v_mul_f32 v191, s21, v191
    v_mul_f32 v192, s21, v192
    v_mul_f32 v193, s21, v193
    v_mul_f32 v194, s21, v194
    v_mul_f32 v195, s21, v195
    v_mul_f32 v196, s21, v196
    v_mul_f32 v197, s21, v197
    v_mul_f32 v198, s21, v198
    v_mul_f32 v199, s21, v199
    v_cvt_pk_bf16_f32 v19, v184, v185
    v_lshlrev_b32 v184, 16, v19
    v_and_b32 v185, 0xffff0000, v19
    v_cvt_pk_bf16_f32 v19, v186, v187
    v_lshlrev_b32 v186, 16, v19
    v_and_b32 v187, 0xffff0000, v19
    v_cvt_pk_bf16_f32 v19, v188, v189
    v_lshlrev_b32 v188, 16, v19
    v_and_b32 v189, 0xffff0000, v19
    v_cvt_pk_bf16_f32 v19, v190, v191
    v_lshlrev_b32 v190, 16, v19
    v_and_b32 v191, 0xffff0000, v19
    v_cvt_pk_bf16_f32 v19, v192, v193
    v_lshlrev_b32 v192, 16, v19
    v_and_b32 v193, 0xffff0000, v19
    v_cvt_pk_bf16_f32 v19, v194, v195
    v_lshlrev_b32 v194, 16, v19
    v_and_b32 v195, 0xffff0000, v19
    v_cvt_pk_bf16_f32 v19, v196, v197
    v_lshlrev_b32 v196, 16, v19
    v_and_b32 v197, 0xffff0000, v19
    v_cvt_pk_bf16_f32 v19, v198, v199
    v_lshlrev_b32 v198, 16, v19
    v_and_b32 v199, 0xffff0000, v19
    v_add_f32 v184, v184, v32
    v_add_f32 v185, v185, v33
    v_add_f32 v186, v186, v34
    v_add_f32 v187, v187, v35
    v_add_f32 v188, v188, v36
    v_add_f32 v189, v189, v37
    v_add_f32 v190, v190, v38
    v_add_f32 v191, v191, v39
    v_add_f32 v192, v192, v40
    v_add_f32 v193, v193, v41
    v_add_f32 v194, v194, v42
    v_add_f32 v195, v195, v43
    v_add_f32 v196, v196, v44
    v_add_f32 v197, v197, v45
    v_add_f32 v198, v198, v46
    v_add_f32 v199, v199, v47
    v_max3_f32 v21, v184, v185, v186
    v_max3_f32 v21, v21, v187, v188
    v_max3_f32 v21, v21, v189, v190
    v_max3_f32 v21, v21, v191, v192
    v_max3_f32 v21, v21, v193, v194
    v_max3_f32 v21, v21, v195, v196
    v_max3_f32 v21, v21, v197, v198
    v_max_f32 v21, v21, v199
    s_waitcnt vmcnt(11)
    v_mfma_f32_32x32x16_bf16 v[200:215], v[112:115], v[48:51], 0
    s_waitcnt vmcnt(10)
    v_mfma_f32_32x32x16_bf16 v[200:215], v[116:119], v[52:55], v[200:215]
    s_waitcnt vmcnt(9)
    v_mfma_f32_32x32x16_bf16 v[200:215], v[120:123], v[56:59], v[200:215]
    s_waitcnt vmcnt(8)
    v_mfma_f32_32x32x16_bf16 v[200:215], v[124:127], v[60:63], v[200:215]
    s_waitcnt vmcnt(7)
    v_mfma_f32_32x32x16_bf16 v[200:215], v[128:131], v[64:67], v[200:215]
    s_waitcnt vmcnt(6)
    v_mfma_f32_32x32x16_bf16 v[200:215], v[132:135], v[68:71], v[200:215]
    s_waitcnt vmcnt(5)
    v_mfma_f32_32x32x16_bf16 v[200:215], v[136:139], v[72:75], v[200:215]
    s_waitcnt vmcnt(4)
    v_mfma_f32_32x32x16_bf16 v[200:215], v[140:143], v[76:79], v[200:215]
    s_nop 11
    v_cvt_pk_bf16_f32 v19, v200, v201
    v_lshlrev_b32 v200, 16, v19
    v_and_b32 v201, 0xffff0000, v19
    v_cvt_pk_bf16_f32 v19, v202, v203
    v_lshlrev_b32 v202, 16, v19
    v_and_b32 v203, 0xffff0000, v19
    v_mul_f32 v200, s21, v200
    v_mul_f32 v201, s21, v201
    v_mul_f32 v202, s21, v202
    v_mul_f32 v203, s21, v203
    v_cvt_pk_bf16_f32 v19, v200, v201
    v_lshlrev_b32 v200, 16, v19
    v_and_b32 v201, 0xffff0000, v19
    v_cvt_pk_bf16_f32 v19, v202, v203
    v_lshlrev_b32 v202, 16, v19
    v_and_b32 v203, 0xffff0000, v19
    v_max3_f32 v21, v21, v200, v201
    v_max3_f32 v19, v21, v202, v203
    v_mov_b32 v20, v19
    s_nop 1
    v_permlane32_swap_b32 v19, v20
    v_max_f32 v19, v19, v20
    v_mul_f32 v19, s22, v19
    v_fma_f32 v184, v184, s22, -v19
    v_fma_f32 v185, v185, s22, -v19
    v_fma_f32 v186, v186, s22, -v19
    v_fma_f32 v187, v187, s22, -v19
    v_fma_f32 v188, v188, s22, -v19
    v_fma_f32 v189, v189, s22, -v19
    v_fma_f32 v190, v190, s22, -v19
    v_fma_f32 v191, v191, s22, -v19
    v_fma_f32 v192, v192, s22, -v19
    v_fma_f32 v193, v193, s22, -v19
    v_fma_f32 v194, v194, s22, -v19
    v_fma_f32 v195, v195, s22, -v19
    v_fma_f32 v196, v196, s22, -v19
    v_fma_f32 v197, v197, s22, -v19
    v_fma_f32 v198, v198, s22, -v19
    v_fma_f32 v199, v199, s22, -v19
    v_fma_f32 v200, v200, s22, -v19
    v_fma_f32 v201, v201, s22, -v19
    v_fma_f32 v202, v202, s22, -v19
    v_fma_f32 v203, v203, s22, -v19
    v_exp_f32 v184, v184
    v_exp_f32 v185, v185
    v_exp_f32 v186, v186
    v_exp_f32 v187, v187
    v_exp_f32 v188, v188
    v_exp_f32 v189, v189
    v_exp_f32 v190, v190
    v_exp_f32 v191, v191
    v_exp_f32 v192, v192
    v_exp_f32 v193, v193
    v_exp_f32 v194, v194
    v_exp_f32 v195, v195
    v_exp_f32 v196, v196
    v_exp_f32 v197, v197
    v_exp_f32 v198, v198
    v_exp_f32 v199, v199
    v_exp_f32 v200, v200
    v_exp_f32 v201, v201
    v_exp_f32 v202, v202
    v_exp_f32 v203, v203
    s_nop 0
    v_cvt_pk_bf16_f32 v216, v184, v185
    v_cvt_pk_bf16_f32 v217, v186, v187
    v_cvt_pk_bf16_f32 v218, v188, v189
    v_cvt_pk_bf16_f32 v219, v190, v191
    v_cvt_pk_bf16_f32 v220, v192, v193
    v_cvt_pk_bf16_f32 v221, v194, v195
    v_cvt_pk_bf16_f32 v222, v196, v197
    v_cvt_pk_bf16_f32 v223, v198, v199
    v_cvt_pk_bf16_f32 v224, v200, v201
    v_cvt_pk_bf16_f32 v225, v202, v203
    s_waitcnt vmcnt(0) lgkmcnt(0)
    v_add_f32 v19, v184, v185
    v_mfma_f32_32x32x16_bf16 v[80:95], v[144:147], v[216:219], 0
    v_mfma_f32_32x32x16_bf16 v[80:95], v[148:151], v[220:223], v[80:95]
    v_mfma_f32_32x32x8_bf16 v[80:95], v[176:177], v[224:225], v[80:95]
    v_mfma_f32_32x32x16_bf16 v[96:111], v[152:155], v[216:219], 0
    v_mfma_f32_32x32x16_bf16 v[96:111], v[156:159], v[220:223], v[96:111]
    v_mfma_f32_32x32x8_bf16 v[96:111], v[178:179], v[224:225], v[96:111]
    v_mfma_f32_32x32x16_bf16 v[112:127], v[160:163], v[216:219], 0
    v_mfma_f32_32x32x16_bf16 v[112:127], v[164:167], v[220:223], v[112:127]
    v_mfma_f32_32x32x8_bf16 v[112:127], v[180:181], v[224:225], v[112:127]
    v_mfma_f32_32x32x16_bf16 v[128:143], v[168:171], v[216:219], 0
    v_mfma_f32_32x32x16_bf16 v[128:143], v[172:175], v[220:223], v[128:143]
    v_mfma_f32_32x32x8_bf16 v[128:143], v[182:183], v[224:225], v[128:143]
    v_add_f32 v19, v19, v186
    v_add_f32 v19, v19, v187
    v_add_f32 v19, v19, v188
    v_add_f32 v19, v19, v189
    v_add_f32 v19, v19, v190
    v_add_f32 v19, v19, v191
    v_add_f32 v19, v19, v192
    v_add_f32 v19, v19, v193
    v_add_f32 v19, v19, v194
    v_add_f32 v19, v19, v195
    v_add_f32 v19, v19, v196
    v_add_f32 v19, v19, v197
    v_add_f32 v19, v19, v198
    v_add_f32 v19, v19, v199
    v_add_f32 v19, v19, v200
    v_add_f32 v19, v19, v201
    v_add_f32 v19, v19, v202
    v_add_f32 v19, v19, v203
    v_mov_b32 v20, v19
    s_nop 1
    v_permlane32_swap_b32 v19, v20
    v_add_f32 v19, v19, v20
    v_rcp_f32 v19, v19
    s_nop 11
    v_mul_f32 v80, v80, v19
    v_mul_f32 v81, v81, v19
    v_mul_f32 v82, v82, v19
    v_mul_f32 v83, v83, v19
    v_mul_f32 v84, v84, v19
    v_mul_f32 v85, v85, v19
    v_mul_f32 v86, v86, v19
    v_mul_f32 v87, v87, v19
    v_mul_f32 v88, v88, v19
    v_mul_f32 v89, v89, v19
    v_mul_f32 v90, v90, v19
    v_mul_f32 v91, v91, v19
    v_mul_f32 v92, v92, v19
    v_mul_f32 v93, v93, v19
    v_mul_f32 v94, v94, v19
    v_mul_f32 v95, v95, v19
    v_cvt_pk_bf16_f32 v48, v80, v81
    v_cvt_pk_bf16_f32 v49, v82, v83
    v_cvt_pk_bf16_f32 v50, v84, v85
    v_cvt_pk_bf16_f32 v51, v86, v87
    v_cvt_pk_bf16_f32 v52, v88, v89
    v_cvt_pk_bf16_f32 v53, v90, v91
    v_cvt_pk_bf16_f32 v54, v92, v93
    v_cvt_pk_bf16_f32 v55, v94, v95
    s_nop 1
    v_permlane32_swap_b32 v48, v50
    v_permlane32_swap_b32 v49, v51
    v_permlane32_swap_b32 v52, v54
    v_permlane32_swap_b32 v53, v55
    ds_write_b128 v25, v[48:51] offset:0
    ds_write_b128 v26, v[52:55] offset:0
    v_mul_f32 v96, v96, v19
    v_mul_f32 v97, v97, v19
    v_mul_f32 v98, v98, v19
    v_mul_f32 v99, v99, v19
    v_mul_f32 v100, v100, v19
    v_mul_f32 v101, v101, v19
    v_mul_f32 v102, v102, v19
    v_mul_f32 v103, v103, v19
    v_mul_f32 v104, v104, v19
    v_mul_f32 v105, v105, v19
    v_mul_f32 v106, v106, v19
    v_mul_f32 v107, v107, v19
    v_mul_f32 v108, v108, v19
    v_mul_f32 v109, v109, v19
    v_mul_f32 v110, v110, v19
    v_mul_f32 v111, v111, v19
    v_cvt_pk_bf16_f32 v56, v96, v97
    v_cvt_pk_bf16_f32 v57, v98, v99
    v_cvt_pk_bf16_f32 v58, v100, v101
    v_cvt_pk_bf16_f32 v59, v102, v103
    v_cvt_pk_bf16_f32 v60, v104, v105
    v_cvt_pk_bf16_f32 v61, v106, v107
    v_cvt_pk_bf16_f32 v62, v108, v109
    v_cvt_pk_bf16_f32 v63, v110, v111
    s_nop 1
    v_permlane32_swap_b32 v56, v58
    v_permlane32_swap_b32 v57, v59
    v_permlane32_swap_b32 v60, v62
    v_permlane32_swap_b32 v61, v63
    ds_write_b128 v27, v[56:59] offset:0
    ds_write_b128 v28, v[60:63] offset:0
    v_mul_f32 v112, v112, v19
    v_mul_f32 v113, v113, v19
    v_mul_f32 v114, v114, v19
    v_mul_f32 v115, v115, v19
    v_mul_f32 v116, v116, v19
    v_mul_f32 v117, v117, v19
    v_mul_f32 v118, v118, v19
    v_mul_f32 v119, v119, v19
    v_mul_f32 v120, v120, v19
    v_mul_f32 v121, v121, v19
    v_mul_f32 v122, v122, v19
    v_mul_f32 v123, v123, v19
    v_mul_f32 v124, v124, v19
    v_mul_f32 v125, v125, v19
    v_mul_f32 v126, v126, v19
    v_mul_f32 v127, v127, v19
    v_cvt_pk_bf16_f32 v64, v112, v113
    v_cvt_pk_bf16_f32 v65, v114, v115
    v_cvt_pk_bf16_f32 v66, v116, v117
    v_cvt_pk_bf16_f32 v67, v118, v119
    v_cvt_pk_bf16_f32 v68, v120, v121
    v_cvt_pk_bf16_f32 v69, v122, v123
    v_cvt_pk_bf16_f32 v70, v124, v125
    v_cvt_pk_bf16_f32 v71, v126, v127
    s_nop 1
    v_permlane32_swap_b32 v64, v66
    v_permlane32_swap_b32 v65, v67
    v_permlane32_swap_b32 v68, v70
    v_permlane32_swap_b32 v69, v71
    ds_write_b128 v25, v[64:67] offset:4096
    ds_write_b128 v26, v[68:71] offset:4096
    v_mul_f32 v128, v128, v19
    v_mul_f32 v129, v129, v19
    v_mul_f32 v130, v130, v19
    v_mul_f32 v131, v131, v19
    v_mul_f32 v132, v132, v19
    v_mul_f32 v133, v133, v19
    v_mul_f32 v134, v134, v19
    v_mul_f32 v135, v135, v19
    v_mul_f32 v136, v136, v19
    v_mul_f32 v137, v137, v19
    v_mul_f32 v138, v138, v19
    v_mul_f32 v139, v139, v19
    v_mul_f32 v140, v140, v19
    v_mul_f32 v141, v141, v19
    v_mul_f32 v142, v142, v19
    v_mul_f32 v143, v143, v19
    v_cvt_pk_bf16_f32 v72, v128, v129
    v_cvt_pk_bf16_f32 v73, v130, v131
    v_cvt_pk_bf16_f32 v74, v132, v133
    v_cvt_pk_bf16_f32 v75, v134, v135
    v_cvt_pk_bf16_f32 v76, v136, v137
    v_cvt_pk_bf16_f32 v77, v138, v139
    v_cvt_pk_bf16_f32 v78, v140, v141
    v_cvt_pk_bf16_f32 v79, v142, v143
    s_nop 1
    v_permlane32_swap_b32 v72, v74
    v_permlane32_swap_b32 v73, v75
    v_permlane32_swap_b32 v76, v78
    v_permlane32_swap_b32 v77, v79
    ds_write_b128 v27, v[72:75] offset:4096
    ds_write_b128 v28, v[76:79] offset:4096
    s_cmp_lg_u32 s35, 0
    s_cbranch_scc1 Lfs_118
    s_waitcnt lgkmcnt(0)
    ds_read_b128 v[48:51], v29 offset:0
    ds_read_b128 v[52:55], v29 offset:1024
    ds_read_b128 v[56:59], v29 offset:2048
    ds_read_b128 v[60:63], v29 offset:3072
    ds_read_b128 v[64:67], v29 offset:4096
    ds_read_b128 v[68:71], v29 offset:5120
    ds_read_b128 v[72:75], v29 offset:6144
    ds_read_b128 v[76:79], v29 offset:7168
    s_add_u32 s23, s20, 0
    s_waitcnt lgkmcnt(7)
    buffer_store_dwordx4 v[48:51], v18, s[4:7], s23 offen
    s_add_u32 s23, s20, 66560
    s_waitcnt lgkmcnt(6)
    buffer_store_dwordx4 v[52:55], v18, s[4:7], s23 offen
    s_add_u32 s23, s20, 133120
    s_waitcnt lgkmcnt(5)
    buffer_store_dwordx4 v[56:59], v18, s[4:7], s23 offen
    s_add_u32 s23, s20, 199680
    s_waitcnt lgkmcnt(4)
    buffer_store_dwordx4 v[60:63], v18, s[4:7], s23 offen
    s_add_u32 s23, s20, 128
    s_waitcnt lgkmcnt(3)
    buffer_store_dwordx4 v[64:67], v18, s[4:7], s23 offen
    s_add_u32 s23, s20, 66688
    s_waitcnt lgkmcnt(2)
    buffer_store_dwordx4 v[68:71], v18, s[4:7], s23 offen
    s_add_u32 s23, s20, 133248
    s_waitcnt lgkmcnt(1)
    buffer_store_dwordx4 v[72:75], v18, s[4:7], s23 offen
    s_add_u32 s23, s20, 199808
    s_waitcnt lgkmcnt(0)
    buffer_store_dwordx4 v[76:79], v18, s[4:7], s23 offen
    s_branch Lfe_119
Lfs_118:
    s_waitcnt lgkmcnt(0)
    ds_read_b128 v[48:51], v29 offset:0
    ds_read_b128 v[52:55], v29 offset:1024
    ds_read_b128 v[56:59], v29 offset:2048
    ds_read_b128 v[60:63], v29 offset:3072
    ds_read_b128 v[64:67], v29 offset:4096
    ds_read_b128 v[68:71], v29 offset:5120
    ds_read_b128 v[72:75], v29 offset:6144
    ds_read_b128 v[76:79], v29 offset:7168
    s_add_u32 s23, s20, 0
    s_waitcnt lgkmcnt(7)
    buffer_store_dwordx4 v[48:51], v18, s[4:7], s23 offen sc1
    s_add_u32 s23, s20, 66560
    s_waitcnt lgkmcnt(6)
    buffer_store_dwordx4 v[52:55], v18, s[4:7], s23 offen sc1
    s_add_u32 s23, s20, 133120
    s_waitcnt lgkmcnt(5)
    buffer_store_dwordx4 v[56:59], v18, s[4:7], s23 offen sc1
    s_add_u32 s23, s20, 199680
    s_waitcnt lgkmcnt(4)
    buffer_store_dwordx4 v[60:63], v18, s[4:7], s23 offen sc1
    s_add_u32 s23, s20, 128
    s_waitcnt lgkmcnt(3)
    buffer_store_dwordx4 v[64:67], v18, s[4:7], s23 offen sc1
    s_add_u32 s23, s20, 66688
    s_waitcnt lgkmcnt(2)
    buffer_store_dwordx4 v[68:71], v18, s[4:7], s23 offen sc1
    s_add_u32 s23, s20, 133248
    s_waitcnt lgkmcnt(1)
    buffer_store_dwordx4 v[72:75], v18, s[4:7], s23 offen sc1
    s_add_u32 s23, s20, 199808
    s_waitcnt lgkmcnt(0)
    buffer_store_dwordx4 v[76:79], v18, s[4:7], s23 offen sc1
Lfe_119:
    s_lshl_b32 s92, s3, 4
    s_add_u32 s92, s92, s86
    s_lshl_b32 s92, s92, 7
    s_add_u32 s92, s92, 104401920
    s_waitcnt vmcnt(0)
    s_barrier
    s_cmp_lg_u32 s14, 0
    s_cbranch_scc1 Lsg_120
    s_mov_b64 exec, 1
    v_mov_b32 v2, 1
    v_mov_b32 v3, s92
    buffer_atomic_add v2, v3, s[4:7], 0 offen sc1
    s_mov_b64 exec, -1
Lsg_120:
    s_cmp_lt_u32 s13, 20
    s_cbranch_scc1 Lopb
    s_branch Lnext
Lop:
    s_cmp_ge_u32 s13, 10
    s_cselect_b32 s38, 1, 0
    s_mul_i32 s86, s38, 10
    s_sub_u32 s86, s13, s86
    s_mov_b32 s32, 0
    s_cmp_ge_u32 s86, 5
    s_cselect_b32 s87, 1, 0
    s_mul_i32 s85, s87, 5
    s_sub_u32 s85, s86, s85
    s_lshl_b32 s88, s3, 1
    s_add_u32 s87, s87, s88
    s_mov_b32 s8, s50
    s_and_b32 s9, s51, 0xffff
    s_mov_b32 s10, 5242880
    s_mov_b32 s11, 0x00020000
    v_lshrrev_b32 v15, 4, v1
    v_mul_u32_u24 v13, 1280, v15
    v_bfe_u32 v14, v1, 2, 2
    v_xor_b32 v14, v14, v15
    v_lshl_add_u32 v13, v14, 6, v13
    v_and_b32 v14, 3, v1
    v_lshl_add_u32 v13, v14, 4, v13
    s_lshl_b32 s16, s87, 2
    s_add_u32 s16, s16, s14
    s_mul_i32 s16, s16, 163840
    s_lshl_b32 s17, s85, 8
    s_add_u32 s16, s16, s17
    s_lshl_b32 s17, s14, 15
    s_add_u32 s18, s17, 32768
    s_barrier
Low_121:
    s_mov_b32 m0, s17
    s_add_u32 s17, s17, 1024
    buffer_load_dwordx4 v13, s[8:11], s16 offen lds
    s_add_u32 s16, s16, 5120
    s_cmp_lt_u32 s17, s18
    s_cbranch_scc1 Low_121
    v_lshrrev_b32 v13, 5, v1
    v_lshlrev_b32 v13, 3, v13
    v_bfe_u32 v14, v1, 2, 2
    v_add_u32 v13, v13, v14
    v_lshlrev_b32 v13, 8, v13
    v_bfe_u32 v15, v1, 4, 1
    v_lshl_add_u32 v13, v15, 5, v13
    v_and_b32 v15, 3, v1
    v_lshl_add_u32 v13, v15, 3, v13
    v_xor_b32 v14, s14, v14
    v_lshl_add_u32 v13, v14, 6, v13
    v_add_u32 v14, 0x10000, v13
    s_waitcnt vmcnt(0)
    s_barrier
    ds_read_b64_tr_b16 a[0:1], v13 offset:0
    ds_read_b64_tr_b16 a[2:3], v13 offset:1024
    ds_read_b64_tr_b16 a[4:5], v13 offset:4096
    ds_read_b64_tr_b16 a[6:7], v13 offset:5120
    ds_read_b64_tr_b16 a[8:9], v13 offset:8192
    ds_read_b64_tr_b16 a[10:11], v13 offset:9216
    ds_read_b64_tr_b16 a[12:13], v13 offset:12288
    ds_read_b64_tr_b16 a[14:15], v13 offset:13312
    ds_read_b64_tr_b16 a[16:17], v13 offset:16384
    ds_read_b64_tr_b16 a[18:19], v13 offset:17408
    ds_read_b64_tr_b16 a[20:21], v13 offset:20480
    ds_read_b64_tr_b16 a[22:23], v13 offset:21504
    s_waitcnt lgkmcnt(0)
    ds_read_b64_tr_b16 a[24:25], v13 offset:24576
    ds_read_b64_tr_b16 a[26:27], v13 offset:25600
    ds_read_b64_tr_b16 a[28:29], v13 offset:28672
    ds_read_b64_tr_b16 a[30:31], v13 offset:29696
    ds_read_b64_tr_b16 a[32:33], v13 offset:32768
    ds_read_b64_tr_b16 a[34:35], v13 offset:33792
    ds_read_b64_tr_b16 a[36:37], v13 offset:36864
    ds_read_b64_tr_b16 a[38:39], v13 offset:37888
    ds_read_b64_tr_b16 a[40:41], v13 offset:40960
    ds_read_b64_tr_b16 a[42:43], v13 offset:41984
    ds_read_b64_tr_b16 a[44:45], v13 offset:45056
    ds_read_b64_tr_b16 a[46:47], v13 offset:46080
    s_waitcnt lgkmcnt(0)
    ds_read_b64_tr_b16 a[48:49], v13 offset:49152
    ds_read_b64_tr_b16 a[50:51], v13 offset:50176
    ds_read_b64_tr_b16 a[52:53], v13 offset:53248
    ds_read_b64_tr_b16 a[54:55], v13 offset:54272
    ds_read_b64_tr_b16 a[56:57], v13 offset:57344
    ds_read_b64_tr_b16 a[58:59], v13 offset:58368
    ds_read_b64_tr_b16 a[60:61], v13 offset:61440
    ds_read_b64_tr_b16 a[62:63], v13 offset:62464
    ds_read_b64_tr_b16 a[64:65], v14 offset:0
    ds_read_b64_tr_b16 a[66:67], v14 offset:1024
    ds_read_b64_tr_b16 a[68:69], v14 offset:4096
    ds_read_b64_tr_b16 a[70:71], v14 offset:5120
    s_waitcnt lgkmcnt(0)
    ds_read_b64_tr_b16 a[72:73], v14 offset:8192
    ds_read_b64_tr_b16 a[74:75], v14 offset:9216
    ds_read_b64_tr_b16 a[76:77], v14 offset:12288
    ds_read_b64_tr_b16 a[78:79], v14 offset:13312
    ds_read_b64_tr_b16 a[80:81], v14 offset:16384
    ds_read_b64_tr_b16 a[82:83], v14 offset:17408
    ds_read_b64_tr_b16 a[84:85], v14 offset:20480
    ds_read_b64_tr_b16 a[86:87], v14 offset:21504
    ds_read_b64_tr_b16 a[88:89], v14 offset:24576
    ds_read_b64_tr_b16 a[90:91], v14 offset:25600
    ds_read_b64_tr_b16 a[92:93], v14 offset:28672
    ds_read_b64_tr_b16 a[94:95], v14 offset:29696
    s_waitcnt lgkmcnt(0)
    ds_read_b64_tr_b16 a[96:97], v14 offset:32768
    ds_read_b64_tr_b16 a[98:99], v14 offset:33792
    ds_read_b64_tr_b16 a[100:101], v14 offset:36864
    ds_read_b64_tr_b16 a[102:103], v14 offset:37888
    ds_read_b64_tr_b16 a[104:105], v14 offset:40960
    ds_read_b64_tr_b16 a[106:107], v14 offset:41984
    ds_read_b64_tr_b16 a[108:109], v14 offset:45056
    ds_read_b64_tr_b16 a[110:111], v14 offset:46080
    ds_read_b64_tr_b16 a[112:113], v14 offset:49152
    ds_read_b64_tr_b16 a[114:115], v14 offset:50176
    ds_read_b64_tr_b16 a[116:117], v14 offset:53248
    ds_read_b64_tr_b16 a[118:119], v14 offset:54272
    s_waitcnt lgkmcnt(0)
    ds_read_b64_tr_b16 a[120:121], v14 offset:57344
    ds_read_b64_tr_b16 a[122:123], v14 offset:58368
    ds_read_b64_tr_b16 a[124:125], v14 offset:61440
    ds_read_b64_tr_b16 a[126:127], v14 offset:62464
    s_waitcnt lgkmcnt(0)
    s_mov_b32 s33, s85
    s_mov_b32 s34, s87
Lopb:
    s_cmp_lg_u32 s14, 0
    s_cbranch_scc1 Lod_122
    s_lshl_b32 s92, s3, 4
    s_add_u32 s92, s92, s32
    s_lshl_b32 s92, s92, 7
    s_add_u32 s92, s92, 104401920
    v_mov_b32 v3, s92
    s_lshl_b32 s92, s3, 7
    s_add_u32 s92, s92, 104410112
    v_mov_b32 v5, s92
    s_lshl_b32 s92, s3, 10
    s_add_u32 s92, s92, 104333312
    v_mov_b32 v7, s92
    buffer_load_dword v2, v3, s[4:7], 0 offen sc1
    buffer_load_dword v4, v5, s[4:7], 0 offen sc1
    buffer_load_dword v6, v7, s[4:7], 0 offen sc1
    s_waitcnt vmcnt(0)
    v_readfirstlane_b32 s84, v2
    v_readfirstlane_b32 s92, v4
    v_readfirstlane_b32 s93, v6
    s_lshr_b32 s94, s92, 3
    s_add_u32 s94, s94, 1
    s_lshl_b32 s94, s94, 2
    s_cmp_ge_u32 s93, s94
    s_cselect_b32 s95, 2, 0
    s_cmp_ge_u32 s92, 128
    s_cselect_b32 s95, 0, s95
    s_cmp_ge_u32 s84, 8
    s_cselect_b32 s95, 1, s95
    v_mov_b32 v2, s95
    v_mov_b32 v3, 151488
    ds_write_b32 v3, v2
    s_waitcnt lgkmcnt(0)
Lod_122:
    s_barrier
    v_mov_b32 v3, 151488
    ds_read_b32 v2, v3
    s_waitcnt lgkmcnt(0)
    v_readfirstlane_b32 s95, v2
    s_barrier
    s_add_u32 s81, s81, 1
    s_cmp_gt_u32 s81, 0x200000
    s_cbranch_scc1 fused_kernel_exit
    s_cmp_eq_u32 s95, 2
    s_cbranch_scc1 Lnext
    s_cmp_eq_u32 s95, 1
    s_cbranch_scc1 Logo_123
    s_sleep 3
    s_branch Lopb
Logo_123:
    s_mov_b32 s86, s32
    s_mov_b32 s85, s33
    s_mov_b32 s87, s34
    v_lshrrev_b32 v13, 3, v1
    s_lshl_b32 s16, s14, 4
    v_add_u32 v13, s16, v13
    v_mul_u32_u24 v13, 8320, v13
    v_and_b32 v14, 7, v1
    v_lshrrev_b32 v15, 4, v1
    v_xor_b32 v14, v14, v15
    v_lshl_add_u32 v2, v14, 4, v13
    v_xor_b32 v14, 4, v14
    v_lshl_add_u32 v3, v14, 4, v13
    v_and_b32 v13, 31, v1
    v_bfe_u32 v14, v1, 1, 3
    v_lshrrev_b32 v15, 5, v1
    v_xor_b32 v14, v14, v15
    v_lshlrev_b32 v13, 7, v13
    v_xor_b32 v15, 0, v14
    v_lshl_add_u32 v4, v15, 4, v13
    v_add_u32 v8, 0x10000, v4
    v_xor_b32 v15, 2, v14
    v_lshl_add_u32 v5, v15, 4, v13
    v_add_u32 v9, 0x10000, v5
    v_xor_b32 v15, 4, v14
    v_lshl_add_u32 v6, v15, 4, v13
    v_add_u32 v10, 0x10000, v6
    v_xor_b32 v15, 6, v14
    v_lshl_add_u32 v7, v15, 4, v13
    v_add_u32 v11, 0x10000, v7
    s_lshl_b32 s16, s14, 13
    s_add_u32 s16, s16, 65536
    v_and_b32 v13, 31, v1
    v_lshrrev_b32 v14, 5, v1
    v_and_b32 v22, 7, v1
    v_xor_b32 v14, v14, v22
    v_lshlrev_b32 v13, 7, v13
    v_add_u32 v13, s16, v13
    v_xor_b32 v18, 0, v14
    v_lshl_add_u32 v18, v18, 4, v13
    v_xor_b32 v19, 2, v14
    v_lshl_add_u32 v19, v19, 4, v13
    v_xor_b32 v20, 4, v14
    v_lshl_add_u32 v20, v20, 4, v13
    v_xor_b32 v21, 6, v14
    v_lshl_add_u32 v21, v21, 4, v13
    v_lshrrev_b32 v13, 3, v1
    v_xor_b32 v14, v22, v13
    v_lshlrev_b32 v13, 7, v13
    v_lshl_add_u32 v13, v14, 4, v13
    v_add_u32 v22, s16, v13
    v_lshrrev_b32 v13, 3, v1
    s_mov_b32 s16, 2560
    v_mul_lo_u32 v13, v13, s16
    v_and_b32 v12, 7, v1
    v_lshl_add_u32 v12, v12, 4, v13
    s_add_u32 s80, s86, 900
    s_lshl_b32 s84, s85, 4
    s_add_u32 s80, s80, s84
    s_lshl_b32 s91, s86, 1
    s_add_u32 s91, s91, s38
    s_mul_i32 s88, s91, 532480
    s_lshl_b32 s89, s87, 10
    s_add_u32 s88, s88, s89
    s_add_u32 s88, s88, 56623104
    s_mul_i32 s90, s87, 5242880
    s_add_u32 s90, s90, 205520896
    s_mul_i32 s89, s91, 163840
    s_add_u32 s90, s90, s89
    s_lshl_b32 s89, s85, 9
    s_add_u32 s90, s90, s89
    s_lshl_b32 s89, s14, 7
    s_add_u32 s90, s90, s89
    s_barrier
    s_lshl_b32 s16, s14, 11
    s_add_u32 m0, s16, 0
    s_add_u32 s17, s88, 0
    buffer_load_dwordx4 v2, s[4:7], s17 offen sc1 lds
    s_add_u32 m0, s16, 1024
    s_add_u32 s17, s88, 66560
    buffer_load_dwordx4 v3, s[4:7], s17 offen sc1 lds
    s_add_u32 m0, s16, 8192
    s_add_u32 s17, s88, 128
    buffer_load_dwordx4 v2, s[4:7], s17 offen sc1 lds
    s_add_u32 m0, s16, 9216
    s_add_u32 s17, s88, 66688
    buffer_load_dwordx4 v3, s[4:7], s17 offen sc1 lds
    s_add_u32 m0, s16, 16384
    s_add_u32 s17, s88, 256
    buffer_load_dwordx4 v2, s[4:7], s17 offen sc1 lds
    s_add_u32 m0, s16, 17408
    s_add_u32 s17, s88, 66816
    buffer_load_dwordx4 v3, s[4:7], s17 offen sc1 lds
    s_add_u32 m0, s16, 24576
    s_add_u32 s17, s88, 384
    buffer_load_dwordx4 v2, s[4:7], s17 offen sc1 lds
    s_add_u32 m0, s16, 25600
    s_add_u32 s17, s88, 66944
    buffer_load_dwordx4 v3, s[4:7], s17 offen sc1 lds
    s_add_u32 m0, s16, 32768
    s_add_u32 s17, s88, 512
    buffer_load_dwordx4 v2, s[4:7], s17 offen sc1 lds
    s_add_u32 m0, s16, 33792
    s_add_u32 s17, s88, 67072
    buffer_load_dwordx4 v3, s[4:7], s17 offen sc1 lds
    s_add_u32 m0, s16, 40960
    s_add_u32 s17, s88, 640
    buffer_load_dwordx4 v2, s[4:7], s17 offen sc1 lds
    s_add_u32 m0, s16, 41984
    s_add_u32 s17, s88, 67200
    buffer_load_dwordx4 v3, s[4:7], s17 offen sc1 lds
    s_add_u32 m0, s16, 49152
    s_add_u32 s17, s88, 768
    buffer_load_dwordx4 v2, s[4:7], s17 offen sc1 lds
    s_add_u32 m0, s16, 50176
    s_add_u32 s17, s88, 67328
    buffer_load_dwordx4 v3, s[4:7], s17 offen sc1 lds
    s_add_u32 m0, s16, 57344
    s_add_u32 s17, s88, 896
    buffer_load_dwordx4 v2, s[4:7], s17 offen sc1 lds
    s_add_u32 m0, s16, 58368
    s_add_u32 s17, s88, 67456
    buffer_load_dwordx4 v3, s[4:7], s17 offen sc1 lds
    s_waitcnt vmcnt(8)
    s_barrier
    ds_read_b128 v[24:27], v4 offset:0
    ds_read_b128 v[28:31], v4 offset:4096
    ds_read_b128 v[32:35], v5 offset:0
    ds_read_b128 v[36:39], v5 offset:4096
    ds_read_b128 v[40:43], v6 offset:0
    ds_read_b128 v[44:47], v6 offset:4096
    s_waitcnt lgkmcnt(4)
    v_mfma_f32_32x32x16_bf16 v[56:71], a[0:3], v[24:27], 0
    v_mfma_f32_32x32x16_bf16 v[72:87], a[0:3], v[28:31], 0
    ds_read_b128 v[24:27], v7 offset:0
    ds_read_b128 v[28:31], v7 offset:4096
    s_waitcnt lgkmcnt(4)
    v_mfma_f32_32x32x16_bf16 v[56:71], a[4:7], v[32:35], v[56:71]
    v_mfma_f32_32x32x16_bf16 v[72:87], a[4:7], v[36:39], v[72:87]
    ds_read_b128 v[32:35], v4 offset:8192
    ds_read_b128 v[36:39], v4 offset:12288
    s_waitcnt lgkmcnt(4)
    v_mfma_f32_32x32x16_bf16 v[56:71], a[8:11], v[40:43], v[56:71]
    v_mfma_f32_32x32x16_bf16 v[72:87], a[8:11], v[44:47], v[72:87]
    ds_read_b128 v[40:43], v5 offset:8192
    ds_read_b128 v[44:47], v5 offset:12288
    s_waitcnt lgkmcnt(4)
    v_mfma_f32_32x32x16_bf16 v[56:71], a[12:15], v[24:27], v[56:71]
    v_mfma_f32_32x32x16_bf16 v[72:87], a[12:15], v[28:31], v[72:87]
    ds_read_b128 v[24:27], v6 offset:8192
    ds_read_b128 v[28:31], v6 offset:12288
    s_waitcnt lgkmcnt(4)
    v_mfma_f32_32x32x16_bf16 v[56:71], a[16:19], v[32:35], v[56:71]
    v_mfma_f32_32x32x16_bf16 v[72:87], a[16:19], v[36:39], v[72:87]
    ds_read_b128 v[32:35], v7 offset:8192
    ds_read_b128 v[36:39], v7 offset:12288
    s_waitcnt lgkmcnt(4)
    v_mfma_f32_32x32x16_bf16 v[56:71], a[20:23], v[40:43], v[56:71]
    v_mfma_f32_32x32x16_bf16 v[72:87], a[20:23], v[44:47], v[72:87]
    ds_read_b128 v[40:43], v4 offset:16384
    ds_read_b128 v[44:47], v4 offset:20480
    s_waitcnt lgkmcnt(4)
    v_mfma_f32_32x32x16_bf16 v[56:71], a[24:27], v[24:27], v[56:71]
    v_mfma_f32_32x32x16_bf16 v[72:87], a[24:27], v[28:31], v[72:87]
    ds_read_b128 v[24:27], v5 offset:16384
    ds_read_b128 v[28:31], v5 offset:20480
    s_waitcnt lgkmcnt(4)
    v_mfma_f32_32x32x16_bf16 v[56:71], a[28:31], v[32:35], v[56:71]
    v_mfma_f32_32x32x16_bf16 v[72:87], a[28:31], v[36:39], v[72:87]
    ds_read_b128 v[32:35], v6 offset:16384
    ds_read_b128 v[36:39], v6 offset:20480
    s_waitcnt lgkmcnt(4)
    v_mfma_f32_32x32x16_bf16 v[56:71], a[32:35], v[40:43], v[56:71]
    v_mfma_f32_32x32x16_bf16 v[72:87], a[32:35], v[44:47], v[72:87]
    ds_read_b128 v[40:43], v7 offset:16384
    ds_read_b128 v[44:47], v7 offset:20480
    s_waitcnt lgkmcnt(4)
    v_mfma_f32_32x32x16_bf16 v[56:71], a[36:39], v[24:27], v[56:71]
    v_mfma_f32_32x32x16_bf16 v[72:87], a[36:39], v[28:31], v[72:87]
    ds_read_b128 v[24:27], v4 offset:24576
    ds_read_b128 v[28:31], v4 offset:28672
    s_waitcnt lgkmcnt(4)
    v_mfma_f32_32x32x16_bf16 v[56:71], a[40:43], v[32:35], v[56:71]
    v_mfma_f32_32x32x16_bf16 v[72:87], a[40:43], v[36:39], v[72:87]
    ds_read_b128 v[32:35], v5 offset:24576
    ds_read_b128 v[36:39], v5 offset:28672
    s_waitcnt lgkmcnt(4)
    v_mfma_f32_32x32x16_bf16 v[56:71], a[44:47], v[40:43], v[56:71]
    v_mfma_f32_32x32x16_bf16 v[72:87], a[44:47], v[44:47], v[72:87]
    ds_read_b128 v[40:43], v6 offset:24576
    ds_read_b128 v[44:47], v6 offset:28672
    s_waitcnt lgkmcnt(4)
    v_mfma_f32_32x32x16_bf16 v[56:71], a[48:51], v[24:27], v[56:71]
    v_mfma_f32_32x32x16_bf16 v[72:87], a[48:51], v[28:31], v[72:87]
    ds_read_b128 v[24:27], v7 offset:24576
    ds_read_b128 v[28:31], v7 offset:28672
    s_waitcnt lgkmcnt(4)
    v_mfma_f32_32x32x16_bf16 v[56:71], a[52:55], v[32:35], v[56:71]
    v_mfma_f32_32x32x16_bf16 v[72:87], a[52:55], v[36:39], v[72:87]
    s_waitcnt lgkmcnt(2)
    v_mfma_f32_32x32x16_bf16 v[56:71], a[56:59], v[40:43], v[56:71]
    v_mfma_f32_32x32x16_bf16 v[72:87], a[56:59], v[44:47], v[72:87]
    s_waitcnt lgkmcnt(0)
    v_mfma_f32_32x32x16_bf16 v[56:71], a[60:63], v[24:27], v[56:71]
    v_mfma_f32_32x32x16_bf16 v[72:87], a[60:63], v[28:31], v[72:87]
    s_waitcnt vmcnt(0)
    s_barrier
    ds_read_b128 v[32:35], v4 offset:32768
    ds_read_b128 v[36:39], v4 offset:36864
    ds_read_b128 v[40:43], v5 offset:32768
    ds_read_b128 v[44:47], v5 offset:36864
    ds_read_b128 v[24:27], v6 offset:32768
    ds_read_b128 v[28:31], v6 offset:36864
    s_waitcnt lgkmcnt(4)
    v_mfma_f32_32x32x16_bf16 v[56:71], a[64:67], v[32:35], v[56:71]
    v_mfma_f32_32x32x16_bf16 v[72:87], a[64:67], v[36:39], v[72:87]
    ds_read_b128 v[32:35], v7 offset:32768
    ds_read_b128 v[36:39], v7 offset:36864
    s_waitcnt lgkmcnt(4)
    v_mfma_f32_32x32x16_bf16 v[56:71], a[68:71], v[40:43], v[56:71]
    v_mfma_f32_32x32x16_bf16 v[72:87], a[68:71], v[44:47], v[72:87]
    ds_read_b128 v[40:43], v4 offset:40960
    ds_read_b128 v[44:47], v4 offset:45056
    s_waitcnt lgkmcnt(4)
    v_mfma_f32_32x32x16_bf16 v[56:71], a[72:75], v[24:27], v[56:71]
    v_mfma_f32_32x32x16_bf16 v[72:87], a[72:75], v[28:31], v[72:87]
    ds_read_b128 v[24:27], v5 offset:40960
    ds_read_b128 v[28:31], v5 offset:45056
    s_waitcnt lgkmcnt(4)
    v_mfma_f32_32x32x16_bf16 v[56:71], a[76:79], v[32:35], v[56:71]
    v_mfma_f32_32x32x16_bf16 v[72:87], a[76:79], v[36:39], v[72:87]
    ds_read_b128 v[32:35], v6 offset:40960
    ds_read_b128 v[36:39], v6 offset:45056
    s_waitcnt lgkmcnt(4)
    v_mfma_f32_32x32x16_bf16 v[56:71], a[80:83], v[40:43], v[56:71]
    v_mfma_f32_32x32x16_bf16 v[72:87], a[80:83], v[44:47], v[72:87]
    ds_read_b128 v[40:43], v7 offset:40960
    ds_read_b128 v[44:47], v7 offset:45056
    s_waitcnt lgkmcnt(4)
    v_mfma_f32_32x32x16_bf16 v[56:71], a[84:87], v[24:27], v[56:71]
    v_mfma_f32_32x32x16_bf16 v[72:87], a[84:87], v[28:31], v[72:87]
    ds_read_b128 v[24:27], v4 offset:49152
    ds_read_b128 v[28:31], v4 offset:53248
    s_waitcnt lgkmcnt(4)
    v_mfma_f32_32x32x16_bf16 v[56:71], a[88:91], v[32:35], v[56:71]
    v_mfma_f32_32x32x16_bf16 v[72:87], a[88:91], v[36:39], v[72:87]
    ds_read_b128 v[32:35], v5 offset:49152
    ds_read_b128 v[36:39], v5 offset:53248
    s_waitcnt lgkmcnt(4)
    v_mfma_f32_32x32x16_bf16 v[56:71], a[92:95], v[40:43], v[56:71]
    v_mfma_f32_32x32x16_bf16 v[72:87], a[92:95], v[44:47], v[72:87]
    ds_read_b128 v[40:43], v6 offset:49152
    ds_read_b128 v[44:47], v6 offset:53248
    s_waitcnt lgkmcnt(4)
    v_mfma_f32_32x32x16_bf16 v[56:71], a[96:99], v[24:27], v[56:71]
    v_mfma_f32_32x32x16_bf16 v[72:87], a[96:99], v[28:31], v[72:87]
    ds_read_b128 v[24:27], v7 offset:49152
    ds_read_b128 v[28:31], v7 offset:53248
    s_waitcnt lgkmcnt(4)
    v_mfma_f32_32x32x16_bf16 v[56:71], a[100:103], v[32:35], v[56:71]
    v_mfma_f32_32x32x16_bf16 v[72:87], a[100:103], v[36:39], v[72:87]
    ds_read_b128 v[32:35], v4 offset:57344
    ds_read_b128 v[36:39], v4 offset:61440
    s_waitcnt lgkmcnt(4)
    v_mfma_f32_32x32x16_bf16 v[56:71], a[104:107], v[40:43], v[56:71]
    v_mfma_f32_32x32x16_bf16 v[72:87], a[104:107], v[44:47], v[72:87]
    ds_read_b128 v[40:43], v5 offset:57344
    ds_read_b128 v[44:47], v5 offset:61440
    s_waitcnt lgkmcnt(4)
    v_mfma_f32_32x32x16_bf16 v[56:71], a[108:111], v[24:27], v[56:71]
    v_mfma_f32_32x32x16_bf16 v[72:87], a[108:111], v[28:31], v[72:87]
    ds_read_b128 v[24:27], v6 offset:57344
    ds_read_b128 v[28:31], v6 offset:61440
    s_waitcnt lgkmcnt(4)
    v_mfma_f32_32x32x16_bf16 v[56:71], a[112:115], v[32:35], v[56:71]
    v_mfma_f32_32x32x16_bf16 v[72:87], a[112:115], v[36:39], v[72:87]
    ds_read_b128 v[32:35], v7 offset:57344
    ds_read_b128 v[36:39], v7 offset:61440
    s_waitcnt lgkmcnt(4)
    v_mfma_f32_32x32x16_bf16 v[56:71], a[116:119], v[40:43], v[56:71]
    v_mfma_f32_32x32x16_bf16 v[72:87], a[116:119], v[44:47], v[72:87]
    s_waitcnt lgkmcnt(2)
    v_mfma_f32_32x32x16_bf16 v[56:71], a[120:123], v[24:27], v[56:71]
    v_mfma_f32_32x32x16_bf16 v[72:87], a[120:123], v[28:31], v[72:87]
    s_waitcnt lgkmcnt(0)
    v_mfma_f32_32x32x16_bf16 v[56:71], a[124:127], v[32:35], v[56:71]
    v_mfma_f32_32x32x16_bf16 v[72:87], a[124:127], v[36:39], v[72:87]
    s_nop 11
    ds_write_b128 v18, v[56:59] offset:0
    ds_write_b128 v19, v[60:63] offset:0
    ds_write_b128 v20, v[64:67] offset:0
    ds_write_b128 v21, v[68:71] offset:0
    ds_write_b128 v18, v[72:75] offset:4096
    ds_write_b128 v19, v[76:79] offset:4096
    ds_write_b128 v20, v[80:83] offset:4096
    ds_write_b128 v21, v[84:87] offset:4096
    s_waitcnt lgkmcnt(0)
    ds_read_b128 v[120:123], v22 offset:0
    ds_read_b128 v[124:127], v22 offset:1024
    ds_read_b128 v[128:131], v22 offset:2048
    ds_read_b128 v[132:135], v22 offset:3072
    ds_read_b128 v[136:139], v22 offset:4096
    ds_read_b128 v[140:143], v22 offset:5120
    ds_read_b128 v[144:147], v22 offset:6144
    ds_read_b128 v[148:151], v22 offset:7168
    s_add_u32 s16, s90, 0
    s_waitcnt lgkmcnt(7)
    buffer_store_dwordx4 v[120:123], v12, s[4:7], s16 offen sc1
    s_add_u32 s16, s90, 20480
    s_waitcnt lgkmcnt(6)
    buffer_store_dwordx4 v[124:127], v12, s[4:7], s16 offen sc1
    s_add_u32 s16, s90, 40960
    s_waitcnt lgkmcnt(5)
    buffer_store_dwordx4 v[128:131], v12, s[4:7], s16 offen sc1
    s_add_u32 s16, s90, 61440
    s_waitcnt lgkmcnt(4)
    buffer_store_dwordx4 v[132:135], v12, s[4:7], s16 offen sc1
    s_add_u32 s16, s90, 81920
    s_waitcnt lgkmcnt(3)
    buffer_store_dwordx4 v[136:139], v12, s[4:7], s16 offen sc1
    s_add_u32 s16, s90, 102400
    s_waitcnt lgkmcnt(2)
    buffer_store_dwordx4 v[140:143], v12, s[4:7], s16 offen sc1
    s_add_u32 s16, s90, 122880
    s_waitcnt lgkmcnt(1)
    buffer_store_dwordx4 v[144:147], v12, s[4:7], s16 offen sc1
    s_add_u32 s16, s90, 143360
    s_waitcnt lgkmcnt(0)
    buffer_store_dwordx4 v[148:151], v12, s[4:7], s16 offen sc1
    s_lshl_b32 s92, s86, 7
    s_add_u32 s92, s92, 104399872
    s_waitcnt vmcnt(0)
    s_barrier
    s_cmp_lg_u32 s14, 0
    s_cbranch_scc1 Lsg_124
    s_mov_b64 exec, 1
    v_mov_b32 v13, 1
    v_mov_b32 v14, s92
    buffer_atomic_add v13, v14, s[4:7], 0 offen sc1
    s_mov_b64 exec, -1
Lsg_124:
    s_add_u32 s32, s32, 1
    s_cmp_lt_u32 s32, 16
    s_cbranch_scc1 Lopb
    s_branch Lcomb
Lcomb:
    s_mov_b32 s16, s40
    s_and_b32 s17, s41, 0xffff
    s_mov_b32 s18, 2621440
    s_mov_b32 s19, 0x00020000
    s_mov_b32 s20, s72
    s_and_b32 s21, s73, 0xffff
    s_mov_b32 s22, 1280
    s_mov_b32 s23, 0x00020000
    s_mov_b32 s24, s74
    s_and_b32 s25, s75, 0xffff
    s_mov_b32 s26, 2621440
    s_mov_b32 s27, 0x00020000
    s_mov_b32 s92, 104410880
    s_cmp_lg_u32 s14, 0
    s_cbranch_scc1 Lwd_126
    v_mov_b32 v3, s92
Lwd_125:
    buffer_load_dword v2, v3, s[4:7], 0 offen sc1
    s_waitcnt vmcnt(0)
    v_readfirstlane_b32 s84, v2
    s_add_u32 s81, s81, 1
    s_cmp_gt_u32 s81, 0x200000
    s_cbranch_scc1 fused_kernel_exit
    s_lshr_b32 s84, s84, 0
    s_and_b32 s84, s84, 65535
    s_cmp_ge_u32 s84, 160
    s_cbranch_scc1 Lwd_126
    s_sleep 8
    s_branch Lwd_125
Lwd_126:
    s_barrier
    v_lshlrev_b32 v4, 2, v1
    v_lshlrev_b32 v5, 3, v1
    v_lshrrev_b32 v6, 1, v1
    v_lshlrev_b32 v6, 14, v6
    v_and_b32 v7, 1, v1
    v_lshl_add_u32 v6, v7, 2, v6
    buffer_load_dword v8, v4, s[20:23], 0 offen offset:0
    buffer_load_dword v9, v4, s[20:23], 0 offen offset:256
    buffer_load_dword v10, v4, s[20:23], 0 offen offset:512
    buffer_load_dword v11, v4, s[20:23], 0 offen offset:768
    buffer_load_dword v12, v4, s[20:23], 0 offen offset:1024
Lcn:
    s_cmp_lg_u32 s14, 0
    s_cbranch_scc1 Ltkc
    s_mov_b64 exec, 1
    v_mov_b32 v2, 1
    v_mov_b32 v3, 104410752
    buffer_atomic_add v2, v3, s[4:7], 0 offen sc0 sc1
    s_waitcnt vmcnt(0)
    v_mov_b32 v3, 151488
    ds_write_b32 v3, v2
    s_waitcnt lgkmcnt(0)
    s_mov_b64 exec, -1
Ltkc:
    s_barrier
    v_mov_b32 v3, 151488
    ds_read_b32 v2, v3
    s_waitcnt lgkmcnt(0)
    v_readfirstlane_b32 s80, v2
    s_barrier
    s_cmp_ge_u32 s80, 288
    s_cbranch_scc1 fused_kernel_exit
    s_cmp_ge_u32 s80, 224
    s_cbranch_scc1 Lc4
    s_lshr_b32 s86, s80, 4
    s_lshl_b32 s88, s80, 3
    s_lshl_b32 s89, s14, 1
    s_add_u32 s88, s88, s89
    s_add_u32 s89, s88, 1
    s_add_u32 s80, s80, 400
    s_lshl_b32 s92, s86, 7
    s_add_u32 s92, s92, 104399872
    s_cmp_lg_u32 s14, 0
    s_cbranch_scc1 Lwd_128
    v_mov_b32 v3, s92
Lwd_127:
    buffer_load_dword v2, v3, s[4:7], 0 offen sc1
    s_waitcnt vmcnt(0)
    v_readfirstlane_b32 s84, v2
    s_add_u32 s81, s81, 1
    s_cmp_gt_u32 s81, 0x200000
    s_cbranch_scc1 fused_kernel_exit
    s_lshr_b32 s84, s84, 0
    s_and_b32 s84, s84, 65535
    s_cmp_ge_u32 s84, 80
    s_cbranch_scc1 Lwd_128
    s_sleep 8
    s_branch Lwd_127
Lwd_128:
    s_barrier
    s_mul_i32 s28, s88, 1280
    s_lshl_b32 s29, s88, 3
    s_add_u32 s29, s29, 83886080
    s_lshl_b32 s30, s28, 1
    s_add_u32 s30, s30, 205520896
    buffer_load_dword v24, v4, s[16:19], s28 offen offset:0
    buffer_load_dword v25, v4, s[16:19], s28 offen offset:256
    buffer_load_dword v26, v4, s[16:19], s28 offen offset:512
    buffer_load_dword v27, v4, s[16:19], s28 offen offset:768
    buffer_load_dword v28, v4, s[16:19], s28 offen offset:1024
    s_add_u32 s31, s29, 0
    buffer_load_dword v29, v6, s[4:7], s31 offen
    s_add_u32 s31, s29, 524288
    buffer_load_dword v30, v6, s[4:7], s31 offen
    s_add_u32 s31, s29, 1048576
    buffer_load_dword v31, v6, s[4:7], s31 offen
    s_add_u32 s31, s29, 1572864
    buffer_load_dword v32, v6, s[4:7], s31 offen
    s_add_u32 s31, s29, 2097152
    buffer_load_dword v33, v6, s[4:7], s31 offen
    s_add_u32 s31, s30, 0
    buffer_load_dwordx2 v[34:35], v5, s[4:7], s31 offen offset:0
    buffer_load_dwordx2 v[36:37], v5, s[4:7], s31 offen offset:512
    buffer_load_dwordx2 v[38:39], v5, s[4:7], s31 offen offset:1024
    buffer_load_dwordx2 v[40:41], v5, s[4:7], s31 offen offset:1536
    buffer_load_dwordx2 v[42:43], v5, s[4:7], s31 offen offset:2048
    s_add_u32 s31, s30, 5242880
    buffer_load_dwordx2 v[44:45], v5, s[4:7], s31 offen offset:0
    buffer_load_dwordx2 v[46:47], v5, s[4:7], s31 offen offset:512
    buffer_load_dwordx2 v[48:49], v5, s[4:7], s31 offen offset:1024
    buffer_load_dwordx2 v[50:51], v5, s[4:7], s31 offen offset:1536
    buffer_load_dwordx2 v[52:53], v5, s[4:7], s31 offen offset:2048
    s_add_u32 s31, s30, 10485760
    buffer_load_dwordx2 v[54:55], v5, s[4:7], s31 offen offset:0
    buffer_load_dwordx2 v[56:57], v5, s[4:7], s31 offen offset:512
    buffer_load_dwordx2 v[58:59], v5, s[4:7], s31 offen offset:1024
    buffer_load_dwordx2 v[60:61], v5, s[4:7], s31 offen offset:1536
    buffer_load_dwordx2 v[62:63], v5, s[4:7], s31 offen offset:2048
    s_add_u32 s31, s30, 15728640
    buffer_load_dwordx2 v[64:65], v5, s[4:7], s31 offen offset:0
    buffer_load_dwordx2 v[66:67], v5, s[4:7], s31 offen offset:512
    buffer_load_dwordx2 v[68:69], v5, s[4:7], s31 offen offset:1024
    buffer_load_dwordx2 v[70:71], v5, s[4:7], s31 offen offset:1536
    buffer_load_dwordx2 v[72:73], v5, s[4:7], s31 offen offset:2048
    s_add_u32 s31, s30, 20971520
    buffer_load_dwordx2 v[74:75], v5, s[4:7], s31 offen offset:0
    buffer_load_dwordx2 v[76:77], v5, s[4:7], s31 offen offset:512
    buffer_load_dwordx2 v[78:79], v5, s[4:7], s31 offen offset:1024
    buffer_load_dwordx2 v[80:81], v5, s[4:7], s31 offen offset:1536
    buffer_load_dwordx2 v[82:83], v5, s[4:7], s31 offen offset:2048
    s_add_u32 s31, s30, 26214400
    buffer_load_dwordx2 v[84:85], v5, s[4:7], s31 offen offset:0
    buffer_load_dwordx2 v[86:87], v5, s[4:7], s31 offen offset:512
    buffer_load_dwordx2 v[88:89], v5, s[4:7], s31 offen offset:1024
    buffer_load_dwordx2 v[90:91], v5, s[4:7], s31 offen offset:1536
    buffer_load_dwordx2 v[92:93], v5, s[4:7], s31 offen offset:2048
    s_add_u32 s31, s30, 31457280
    buffer_load_dwordx2 v[94:95], v5, s[4:7], s31 offen offset:0
    buffer_load_dwordx2 v[96:97], v5, s[4:7], s31 offen offset:512
    buffer_load_dwordx2 v[98:99], v5, s[4:7], s31 offen offset:1024
    buffer_load_dwordx2 v[100:101], v5, s[4:7], s31 offen offset:1536
    buffer_load_dwordx2 v[102:103], v5, s[4:7], s31 offen offset:2048
    s_add_u32 s31, s30, 36700160
    buffer_load_dwordx2 v[104:105], v5, s[4:7], s31 offen offset:0
    buffer_load_dwordx2 v[106:107], v5, s[4:7], s31 offen offset:512
    buffer_load_dwordx2 v[108:109], v5, s[4:7], s31 offen offset:1024
    buffer_load_dwordx2 v[110:111], v5, s[4:7], s31 offen offset:1536
    buffer_load_dwordx2 v[112:113], v5, s[4:7], s31 offen offset:2048
    s_mul_i32 s28, s89, 1280
    s_lshl_b32 s29, s89, 3
    s_add_u32 s29, s29, 83886080
    s_lshl_b32 s30, s28, 1
    s_add_u32 s30, s30, 205520896
    buffer_load_dword v114, v4, s[16:19], s28 offen offset:0
    buffer_load_dword v115, v4, s[16:19], s28 offen offset:256
    buffer_load_dword v116, v4, s[16:19], s28 offen offset:512
    buffer_load_dword v117, v4, s[16:19], s28 offen offset:768
    buffer_load_dword v118, v4, s[16:19], s28 offen offset:1024
    s_add_u32 s31, s29, 0
    buffer_load_dword v119, v6, s[4:7], s31 offen
    s_add_u32 s31, s29, 524288
    buffer_load_dword v120, v6, s[4:7], s31 offen
    s_add_u32 s31, s29, 1048576
    buffer_load_dword v121, v6, s[4:7], s31 offen
    s_add_u32 s31, s29, 1572864
    buffer_load_dword v122, v6, s[4:7], s31 offen
    s_add_u32 s31, s29, 2097152
    buffer_load_dword v123, v6, s[4:7], s31 offen
    s_add_u32 s31, s30, 0
    buffer_load_dwordx2 v[124:125], v5, s[4:7], s31 offen offset:0
    buffer_load_dwordx2 v[126:127], v5, s[4:7], s31 offen offset:512
    buffer_load_dwordx2 v[128:129], v5, s[4:7], s31 offen offset:1024
    buffer_load_dwordx2 v[130:131], v5, s[4:7], s31 offen offset:1536
    buffer_load_dwordx2 v[132:133], v5, s[4:7], s31 offen offset:2048
    s_add_u32 s31, s30, 5242880
    buffer_load_dwordx2 v[134:135], v5, s[4:7], s31 offen offset:0
    buffer_load_dwordx2 v[136:137], v5, s[4:7], s31 offen offset:512
    buffer_load_dwordx2 v[138:139], v5, s[4:7], s31 offen offset:1024
    buffer_load_dwordx2 v[140:141], v5, s[4:7], s31 offen offset:1536
    buffer_load_dwordx2 v[142:143], v5, s[4:7], s31 offen offset:2048
    s_add_u32 s31, s30, 10485760
    buffer_load_dwordx2 v[144:145], v5, s[4:7], s31 offen offset:0
    buffer_load_dwordx2 v[146:147], v5, s[4:7], s31 offen offset:512
    buffer_load_dwordx2 v[148:149], v5, s[4:7], s31 offen offset:1024
    buffer_load_dwordx2 v[150:151], v5, s[4:7], s31 offen offset:1536
    buffer_load_dwordx2 v[152:153], v5, s[4:7], s31 offen offset:2048
    s_add_u32 s31, s30, 15728640
    buffer_load_dwordx2 v[154:155], v5, s[4:7], s31 offen offset:0
    buffer_load_dwordx2 v[156:157], v5, s[4:7], s31 offen offset:512
    buffer_load_dwordx2 v[158:159], v5, s[4:7], s31 offen offset:1024
    buffer_load_dwordx2 v[160:161], v5, s[4:7], s31 offen offset:1536
    buffer_load_dwordx2 v[162:163], v5, s[4:7], s31 offen offset:2048
    s_add_u32 s31, s30, 20971520
    buffer_load_dwordx2 v[164:165], v5, s[4:7], s31 offen offset:0
    buffer_load_dwordx2 v[166:167], v5, s[4:7], s31 offen offset:512
    buffer_load_dwordx2 v[168:169], v5, s[4:7], s31 offen offset:1024
    buffer_load_dwordx2 v[170:171], v5, s[4:7], s31 offen offset:1536
    buffer_load_dwordx2 v[172:173], v5, s[4:7], s31 offen offset:2048
    s_add_u32 s31, s30, 26214400
    buffer_load_dwordx2 v[174:175], v5, s[4:7], s31 offen offset:0
    buffer_load_dwordx2 v[176:177], v5, s[4:7], s31 offen offset:512
    buffer_load_dwordx2 v[178:179], v5, s[4:7], s31 offen offset:1024
    buffer_load_dwordx2 v[180:181], v5, s[4:7], s31 offen offset:1536
    buffer_load_dwordx2 v[182:183], v5, s[4:7], s31 offen offset:2048
    s_add_u32 s31, s30, 31457280
    buffer_load_dwordx2 v[184:185], v5, s[4:7], s31 offen offset:0
    buffer_load_dwordx2 v[186:187], v5, s[4:7], s31 offen offset:512
    buffer_load_dwordx2 v[188:189], v5, s[4:7], s31 offen offset:1024
    buffer_load_dwordx2 v[190:191], v5, s[4:7], s31 offen offset:1536
    buffer_load_dwordx2 v[192:193], v5, s[4:7], s31 offen offset:2048
    s_add_u32 s31, s30, 36700160
    buffer_load_dwordx2 v[194:195], v5, s[4:7], s31 offen offset:0
    buffer_load_dwordx2 v[196:197], v5, s[4:7], s31 offen offset:512
    buffer_load_dwordx2 v[198:199], v5, s[4:7], s31 offen offset:1024
    buffer_load_dwordx2 v[200:201], v5, s[4:7], s31 offen offset:1536
    buffer_load_dwordx2 v[202:203], v5, s[4:7], s31 offen offset:2048
    s_waitcnt vmcnt(50)
    s_mul_i32 s28, s88, 1280
    v_mov_b32 v20, 0
    v_lshlrev_b32 v14, 16, v24
    v_and_b32 v15, 0xffff0000, v24
    v_lshlrev_b32 v16, 16, v8
    v_and_b32 v17, 0xffff0000, v8
    v_mul_f32 v14, v14, v16
    v_mul_f32 v15, v15, v17
    v_cvt_pk_bf16_f32 v16, v14, v15
    v_lshlrev_b32 v14, 16, v16
    v_and_b32 v15, 0xffff0000, v16
    v_add_f32 v20, v20, v14
    v_add_f32 v20, v20, v15
    v_lshlrev_b32 v14, 16, v25
    v_and_b32 v15, 0xffff0000, v25
    v_lshlrev_b32 v16, 16, v9
    v_and_b32 v17, 0xffff0000, v9
    v_mul_f32 v14, v14, v16
    v_mul_f32 v15, v15, v17
    v_cvt_pk_bf16_f32 v16, v14, v15
    v_lshlrev_b32 v14, 16, v16
    v_and_b32 v15, 0xffff0000, v16
    v_add_f32 v20, v20, v14
    v_add_f32 v20, v20, v15
    v_lshlrev_b32 v14, 16, v26
    v_and_b32 v15, 0xffff0000, v26
    v_lshlrev_b32 v16, 16, v10
    v_and_b32 v17, 0xffff0000, v10
    v_mul_f32 v14, v14, v16
    v_mul_f32 v15, v15, v17
    v_cvt_pk_bf16_f32 v16, v14, v15
    v_lshlrev_b32 v14, 16, v16
    v_and_b32 v15, 0xffff0000, v16
    v_add_f32 v20, v20, v14
    v_add_f32 v20, v20, v15
    v_lshlrev_b32 v14, 16, v27
    v_and_b32 v15, 0xffff0000, v27
    v_lshlrev_b32 v16, 16, v11
    v_and_b32 v17, 0xffff0000, v11
    v_mul_f32 v14, v14, v16
    v_mul_f32 v15, v15, v17
    v_cvt_pk_bf16_f32 v16, v14, v15
    v_lshlrev_b32 v14, 16, v16
    v_and_b32 v15, 0xffff0000, v16
    v_add_f32 v20, v20, v14
    v_add_f32 v20, v20, v15
    v_lshlrev_b32 v14, 16, v28
    v_and_b32 v15, 0xffff0000, v28
    v_lshlrev_b32 v16, 16, v12
    v_and_b32 v17, 0xffff0000, v12
    v_mul_f32 v14, v14, v16
    v_mul_f32 v15, v15, v17
    v_cvt_pk_bf16_f32 v16, v14, v15
    v_lshlrev_b32 v14, 16, v16
    v_and_b32 v15, 0xffff0000, v16
    v_add_f32 v20, v20, v14
    v_add_f32 v20, v20, v15
    s_nop 1
    v_add_f32_dpp v20, v20, v20 row_ror:1 row_mask:0xf bank_mask:0xf
    s_nop 1
    v_add_f32_dpp v20, v20, v20 row_ror:2 row_mask:0xf bank_mask:0xf
    s_nop 1
    v_add_f32_dpp v20, v20, v20 row_ror:4 row_mask:0xf bank_mask:0xf
    s_nop 1
    v_add_f32_dpp v20, v20, v20 row_ror:8 row_mask:0xf bank_mask:0xf
    s_nop 1
    v_mov_b32 v14, v20
    s_nop 1
    v_permlane16_swap_b32 v20, v14
    v_add_f32 v20, v20, v14
    v_mov_b32 v14, v20
    s_nop 1
    v_permlane32_swap_b32 v20, v14
    v_add_f32 v20, v20, v14
    v_cvt_pk_bf16_f32 v20, v20, v20
    v_lshlrev_b32 v20, 16, v20
    v_mul_f32 v20, 0xbfb8aa3b, v20
    v_exp_f32 v20, v20
    s_nop 0
    v_add_f32 v20, 1.0, v20
    v_rcp_f32 v20, v20
    s_nop 0
    v_cvt_pk_bf16_f32 v20, v20, v20
    v_lshlrev_b32 v20, 16, v20
    v_sub_f32 v21, 1.0, v20
    v_cvt_pk_bf16_f32 v21, v21, v21
    v_lshlrev_b32 v21, 16, v21
    v_add_f32 v14, v34, v44
    v_add_f32 v14, v14, v54
    v_add_f32 v14, v14, v64
    v_add_f32 v14, v14, v74
    v_add_f32 v14, v14, v84
    v_add_f32 v14, v14, v94
    v_add_f32 v14, v14, v104
    v_add_f32 v15, v35, v45
    v_add_f32 v15, v15, v55
    v_add_f32 v15, v15, v65
    v_add_f32 v15, v15, v75
    v_add_f32 v15, v15, v85
    v_add_f32 v15, v15, v95
    v_add_f32 v15, v15, v105
    v_cvt_pk_bf16_f32 v16, v14, v15
    v_lshlrev_b32 v14, 16, v16
    v_and_b32 v15, 0xffff0000, v16
    v_mul_f32 v14, v20, v14
    v_mul_f32 v15, v20, v15
    v_cvt_pk_bf16_f32 v16, v14, v15
    v_lshlrev_b32 v17, 16, v29
    v_and_b32 v18, 0xffff0000, v29
    v_mul_f32 v17, v21, v17
    v_mul_f32 v18, v21, v18
    v_cvt_pk_bf16_f32 v19, v17, v18
    v_lshlrev_b32 v14, 16, v16
    v_and_b32 v15, 0xffff0000, v16
    v_lshlrev_b32 v17, 16, v19
    v_and_b32 v18, 0xffff0000, v19
    v_add_f32 v14, v14, v17
    v_add_f32 v15, v15, v18
    v_cvt_pk_bf16_f32 v24, v14, v15
    buffer_store_dword v24, v4, s[24:27], s28 offen offset:0
    v_add_f32 v14, v36, v46
    v_add_f32 v14, v14, v56
    v_add_f32 v14, v14, v66
    v_add_f32 v14, v14, v76
    v_add_f32 v14, v14, v86
    v_add_f32 v14, v14, v96
    v_add_f32 v14, v14, v106
    v_add_f32 v15, v37, v47
    v_add_f32 v15, v15, v57
    v_add_f32 v15, v15, v67
    v_add_f32 v15, v15, v77
    v_add_f32 v15, v15, v87
    v_add_f32 v15, v15, v97
    v_add_f32 v15, v15, v107
    v_cvt_pk_bf16_f32 v16, v14, v15
    v_lshlrev_b32 v14, 16, v16
    v_and_b32 v15, 0xffff0000, v16
    v_mul_f32 v14, v20, v14
    v_mul_f32 v15, v20, v15
    v_cvt_pk_bf16_f32 v16, v14, v15
    v_lshlrev_b32 v17, 16, v30
    v_and_b32 v18, 0xffff0000, v30
    v_mul_f32 v17, v21, v17
    v_mul_f32 v18, v21, v18
    v_cvt_pk_bf16_f32 v19, v17, v18
    v_lshlrev_b32 v14, 16, v16
    v_and_b32 v15, 0xffff0000, v16
    v_lshlrev_b32 v17, 16, v19
    v_and_b32 v18, 0xffff0000, v19
    v_add_f32 v14, v14, v17
    v_add_f32 v15, v15, v18
    v_cvt_pk_bf16_f32 v25, v14, v15
    buffer_store_dword v25, v4, s[24:27], s28 offen offset:256
    v_add_f32 v14, v38, v48
    v_add_f32 v14, v14, v58
    v_add_f32 v14, v14, v68
    v_add_f32 v14, v14, v78
    v_add_f32 v14, v14, v88
    v_add_f32 v14, v14, v98
    v_add_f32 v14, v14, v108
    v_add_f32 v15, v39, v49
    v_add_f32 v15, v15, v59
    v_add_f32 v15, v15, v69
    v_add_f32 v15, v15, v79
    v_add_f32 v15, v15, v89
    v_add_f32 v15, v15, v99
    v_add_f32 v15, v15, v109
    v_cvt_pk_bf16_f32 v16, v14, v15
    v_lshlrev_b32 v14, 16, v16
    v_and_b32 v15, 0xffff0000, v16
    v_mul_f32 v14, v20, v14
    v_mul_f32 v15, v20, v15
    v_cvt_pk_bf16_f32 v16, v14, v15
    v_lshlrev_b32 v17, 16, v31
    v_and_b32 v18, 0xffff0000, v31
    v_mul_f32 v17, v21, v17
    v_mul_f32 v18, v21, v18
    v_cvt_pk_bf16_f32 v19, v17, v18
    v_lshlrev_b32 v14, 16, v16
    v_and_b32 v15, 0xffff0000, v16
    v_lshlrev_b32 v17, 16, v19
    v_and_b32 v18, 0xffff0000, v19
    v_add_f32 v14, v14, v17
    v_add_f32 v15, v15, v18
    v_cvt_pk_bf16_f32 v26, v14, v15
    buffer_store_dword v26, v4, s[24:27], s28 offen offset:512
    v_add_f32 v14, v40, v50
    v_add_f32 v14, v14, v60
    v_add_f32 v14, v14, v70
    v_add_f32 v14, v14, v80
    v_add_f32 v14, v14, v90
    v_add_f32 v14, v14, v100
    v_add_f32 v14, v14, v110
    v_add_f32 v15, v41, v51
    v_add_f32 v15, v15, v61
    v_add_f32 v15, v15, v71
    v_add_f32 v15, v15, v81
    v_add_f32 v15, v15, v91
    v_add_f32 v15, v15, v101
    v_add_f32 v15, v15, v111
    v_cvt_pk_bf16_f32 v16, v14, v15
    v_lshlrev_b32 v14, 16, v16
    v_and_b32 v15, 0xffff0000, v16
    v_mul_f32 v14, v20, v14
    v_mul_f32 v15, v20, v15
    v_cvt_pk_bf16_f32 v16, v14, v15
    v_lshlrev_b32 v17, 16, v32
    v_and_b32 v18, 0xffff0000, v32
    v_mul_f32 v17, v21, v17
    v_mul_f32 v18, v21, v18
    v_cvt_pk_bf16_f32 v19, v17, v18
    v_lshlrev_b32 v14, 16, v16
    v_and_b32 v15, 0xffff0000, v16
    v_lshlrev_b32 v17, 16, v19
    v_and_b32 v18, 0xffff0000, v19
    v_add_f32 v14, v14, v17
    v_add_f32 v15, v15, v18
    v_cvt_pk_bf16_f32 v27, v14, v15
    buffer_store_dword v27, v4, s[24:27], s28 offen offset:768
    v_add_f32 v14, v42, v52
    v_add_f32 v14, v14, v62
    v_add_f32 v14, v14, v72
    v_add_f32 v14, v14, v82
    v_add_f32 v14, v14, v92
    v_add_f32 v14, v14, v102
    v_add_f32 v14, v14, v112
    v_add_f32 v15, v43, v53
    v_add_f32 v15, v15, v63
    v_add_f32 v15, v15, v73
    v_add_f32 v15, v15, v83
    v_add_f32 v15, v15, v93
    v_add_f32 v15, v15, v103
    v_add_f32 v15, v15, v113
    v_cvt_pk_bf16_f32 v16, v14, v15
    v_lshlrev_b32 v14, 16, v16
    v_and_b32 v15, 0xffff0000, v16
    v_mul_f32 v14, v20, v14
    v_mul_f32 v15, v20, v15
    v_cvt_pk_bf16_f32 v16, v14, v15
    v_lshlrev_b32 v17, 16, v33
    v_and_b32 v18, 0xffff0000, v33
    v_mul_f32 v17, v21, v17
    v_mul_f32 v18, v21, v18
    v_cvt_pk_bf16_f32 v19, v17, v18
    v_lshlrev_b32 v14, 16, v16
    v_and_b32 v15, 0xffff0000, v16
    v_lshlrev_b32 v17, 16, v19
    v_and_b32 v18, 0xffff0000, v19
    v_add_f32 v14, v14, v17
    v_add_f32 v15, v15, v18
    v_cvt_pk_bf16_f32 v28, v14, v15
    buffer_store_dword v28, v4, s[24:27], s28 offen offset:1024
    s_waitcnt vmcnt(5)
    s_branch Lc1
Lc4:
    s_sub_u32 s89, s80, 224
    s_lshl_b32 s89, s89, 2
    s_add_u32 s89, s89, 1792
    s_add_u32 s89, s89, s14
    s_lshr_b32 s86, s89, 7
    s_add_u32 s80, s80, 400
    s_lshl_b32 s92, s86, 7
    s_add_u32 s92, s92, 104399872
    s_mul_i32 s28, s89, 1280
    s_lshl_b32 s29, s89, 3
    s_add_u32 s29, s29, 83886080
    s_lshl_b32 s30, s28, 1
    s_add_u32 s30, s30, 205520896
    buffer_load_dword v114, v4, s[16:19], s28 offen offset:0
    buffer_load_dword v115, v4, s[16:19], s28 offen offset:256
    buffer_load_dword v116, v4, s[16:19], s28 offen offset:512
    buffer_load_dword v117, v4, s[16:19], s28 offen offset:768
    buffer_load_dword v118, v4, s[16:19], s28 offen offset:1024
    s_add_u32 s31, s29, 0
    buffer_load_dword v119, v6, s[4:7], s31 offen
    s_add_u32 s31, s29, 524288
    buffer_load_dword v120, v6, s[4:7], s31 offen
    s_add_u32 s31, s29, 1048576
    buffer_load_dword v121, v6, s[4:7], s31 offen
    s_add_u32 s31, s29, 1572864
    buffer_load_dword v122, v6, s[4:7], s31 offen
    s_add_u32 s31, s29, 2097152
    buffer_load_dword v123, v6, s[4:7], s31 offen
    s_cmp_lg_u32 s14, 0
    s_cbranch_scc1 Lwd_130
    v_mov_b32 v3, s92
Lwd_129:
    buffer_load_dword v2, v3, s[4:7], 0 offen sc1
    s_waitcnt vmcnt(0)
    v_readfirstlane_b32 s84, v2
    s_add_u32 s81, s81, 1
    s_cmp_gt_u32 s81, 0x200000
    s_cbranch_scc1 fused_kernel_exit
    s_lshr_b32 s84, s84, 0
    s_and_b32 s84, s84, 65535
    s_cmp_ge_u32 s84, 80
    s_cbranch_scc1 Lwd_130
    s_sleep 2
    s_branch Lwd_129
Lwd_130:
    s_barrier
    s_mul_i32 s28, s89, 1280
    s_lshl_b32 s29, s89, 3
    s_add_u32 s29, s29, 83886080
    s_lshl_b32 s30, s28, 1
    s_add_u32 s30, s30, 205520896
    s_add_u32 s31, s30, 0
    buffer_load_dwordx2 v[124:125], v5, s[4:7], s31 offen offset:0
    buffer_load_dwordx2 v[126:127], v5, s[4:7], s31 offen offset:512
    buffer_load_dwordx2 v[128:129], v5, s[4:7], s31 offen offset:1024
    buffer_load_dwordx2 v[130:131], v5, s[4:7], s31 offen offset:1536
    buffer_load_dwordx2 v[132:133], v5, s[4:7], s31 offen offset:2048
    s_add_u32 s31, s30, 5242880
    buffer_load_dwordx2 v[134:135], v5, s[4:7], s31 offen offset:0
    buffer_load_dwordx2 v[136:137], v5, s[4:7], s31 offen offset:512
    buffer_load_dwordx2 v[138:139], v5, s[4:7], s31 offen offset:1024
    buffer_load_dwordx2 v[140:141], v5, s[4:7], s31 offen offset:1536
    buffer_load_dwordx2 v[142:143], v5, s[4:7], s31 offen offset:2048
    s_add_u32 s31, s30, 10485760
    buffer_load_dwordx2 v[144:145], v5, s[4:7], s31 offen offset:0
    buffer_load_dwordx2 v[146:147], v5, s[4:7], s31 offen offset:512
    buffer_load_dwordx2 v[148:149], v5, s[4:7], s31 offen offset:1024
    buffer_load_dwordx2 v[150:151], v5, s[4:7], s31 offen offset:1536
    buffer_load_dwordx2 v[152:153], v5, s[4:7], s31 offen offset:2048
    s_add_u32 s31, s30, 15728640
    buffer_load_dwordx2 v[154:155], v5, s[4:7], s31 offen offset:0
    buffer_load_dwordx2 v[156:157], v5, s[4:7], s31 offen offset:512
    buffer_load_dwordx2 v[158:159], v5, s[4:7], s31 offen offset:1024
    buffer_load_dwordx2 v[160:161], v5, s[4:7], s31 offen offset:1536
    buffer_load_dwordx2 v[162:163], v5, s[4:7], s31 offen offset:2048
    s_add_u32 s31, s30, 20971520
    buffer_load_dwordx2 v[164:165], v5, s[4:7], s31 offen offset:0
    buffer_load_dwordx2 v[166:167], v5, s[4:7], s31 offen offset:512
    buffer_load_dwordx2 v[168:169], v5, s[4:7], s31 offen offset:1024
    buffer_load_dwordx2 v[170:171], v5, s[4:7], s31 offen offset:1536
    buffer_load_dwordx2 v[172:173], v5, s[4:7], s31 offen offset:2048
    s_add_u32 s31, s30, 26214400
    buffer_load_dwordx2 v[174:175], v5, s[4:7], s31 offen offset:0
    buffer_load_dwordx2 v[176:177], v5, s[4:7], s31 offen offset:512
    buffer_load_dwordx2 v[178:179], v5, s[4:7], s31 offen offset:1024
    buffer_load_dwordx2 v[180:181], v5, s[4:7], s31 offen offset:1536
    buffer_load_dwordx2 v[182:183], v5, s[4:7], s31 offen offset:2048
    s_add_u32 s31, s30, 31457280
    buffer_load_dwordx2 v[184:185], v5, s[4:7], s31 offen offset:0
    buffer_load_dwordx2 v[186:187], v5, s[4:7], s31 offen offset:512
    buffer_load_dwordx2 v[188:189], v5, s[4:7], s31 offen offset:1024
    buffer_load_dwordx2 v[190:191], v5, s[4:7], s31 offen offset:1536
    buffer_load_dwordx2 v[192:193], v5, s[4:7], s31 offen offset:2048
    s_add_u32 s31, s30, 36700160
    buffer_load_dwordx2 v[194:195], v5, s[4:7], s31 offen offset:0
    buffer_load_dwordx2 v[196:197], v5, s[4:7], s31 offen offset:512
    buffer_load_dwordx2 v[198:199], v5, s[4:7], s31 offen offset:1024
    buffer_load_dwordx2 v[200:201], v5, s[4:7], s31 offen offset:1536
    buffer_load_dwordx2 v[202:203], v5, s[4:7], s31 offen offset:2048
    s_waitcnt vmcnt(0)
Lc1:
    s_mul_i32 s28, s89, 1280
    v_mov_b32 v20, 0
    v_lshlrev_b32 v14, 16, v114
    v_and_b32 v15, 0xffff0000, v114
    v_lshlrev_b32 v16, 16, v8
    v_and_b32 v17, 0xffff0000, v8
    v_mul_f32 v14, v14, v16
    v_mul_f32 v15, v15, v17
    v_cvt_pk_bf16_f32 v16, v14, v15
    v_lshlrev_b32 v14, 16, v16
    v_and_b32 v15, 0xffff0000, v16
    v_add_f32 v20, v20, v14
    v_add_f32 v20, v20, v15
    v_lshlrev_b32 v14, 16, v115
    v_and_b32 v15, 0xffff0000, v115
    v_lshlrev_b32 v16, 16, v9
    v_and_b32 v17, 0xffff0000, v9
    v_mul_f32 v14, v14, v16
    v_mul_f32 v15, v15, v17
    v_cvt_pk_bf16_f32 v16, v14, v15
    v_lshlrev_b32 v14, 16, v16
    v_and_b32 v15, 0xffff0000, v16
    v_add_f32 v20, v20, v14
    v_add_f32 v20, v20, v15
    v_lshlrev_b32 v14, 16, v116
    v_and_b32 v15, 0xffff0000, v116
    v_lshlrev_b32 v16, 16, v10
    v_and_b32 v17, 0xffff0000, v10
    v_mul_f32 v14, v14, v16
    v_mul_f32 v15, v15, v17
    v_cvt_pk_bf16_f32 v16, v14, v15
    v_lshlrev_b32 v14, 16, v16
    v_and_b32 v15, 0xffff0000, v16
    v_add_f32 v20, v20, v14
    v_add_f32 v20, v20, v15
    v_lshlrev_b32 v14, 16, v117
    v_and_b32 v15, 0xffff0000, v117
    v_lshlrev_b32 v16, 16, v11
    v_and_b32 v17, 0xffff0000, v11
    v_mul_f32 v14, v14, v16
    v_mul_f32 v15, v15, v17
    v_cvt_pk_bf16_f32 v16, v14, v15
    v_lshlrev_b32 v14, 16, v16
    v_and_b32 v15, 0xffff0000, v16
    v_add_f32 v20, v20, v14
    v_add_f32 v20, v20, v15
    v_lshlrev_b32 v14, 16, v118
    v_and_b32 v15, 0xffff0000, v118
    v_lshlrev_b32 v16, 16, v12
    v_and_b32 v17, 0xffff0000, v12
    v_mul_f32 v14, v14, v16
    v_mul_f32 v15, v15, v17
    v_cvt_pk_bf16_f32 v16, v14, v15
    v_lshlrev_b32 v14, 16, v16
    v_and_b32 v15, 0xffff0000, v16
    v_add_f32 v20, v20, v14
    v_add_f32 v20, v20, v15
    s_nop 1
    v_add_f32_dpp v20, v20, v20 row_ror:1 row_mask:0xf bank_mask:0xf
    s_nop 1
    v_add_f32_dpp v20, v20, v20 row_ror:2 row_mask:0xf bank_mask:0xf
    s_nop 1
    v_add_f32_dpp v20, v20, v20 row_ror:4 row_mask:0xf bank_mask:0xf
    s_nop 1
    v_add_f32_dpp v20, v20, v20 row_ror:8 row_mask:0xf bank_mask:0xf
    s_nop 1
    v_mov_b32 v14, v20
    s_nop 1
    v_permlane16_swap_b32 v20, v14
    v_add_f32 v20, v20, v14
    v_mov_b32 v14, v20
    s_nop 1
    v_permlane32_swap_b32 v20, v14
    v_add_f32 v20, v20, v14
    v_cvt_pk_bf16_f32 v20, v20, v20
    v_lshlrev_b32 v20, 16, v20
    v_mul_f32 v20, 0xbfb8aa3b, v20
    v_exp_f32 v20, v20
    s_nop 0
    v_add_f32 v20, 1.0, v20
    v_rcp_f32 v20, v20
    s_nop 0
    v_cvt_pk_bf16_f32 v20, v20, v20
    v_lshlrev_b32 v20, 16, v20
    v_sub_f32 v21, 1.0, v20
    v_cvt_pk_bf16_f32 v21, v21, v21
    v_lshlrev_b32 v21, 16, v21
    v_add_f32 v14, v124, v134
    v_add_f32 v14, v14, v144
    v_add_f32 v14, v14, v154
    v_add_f32 v14, v14, v164
    v_add_f32 v14, v14, v174
    v_add_f32 v14, v14, v184
    v_add_f32 v14, v14, v194
    v_add_f32 v15, v125, v135
    v_add_f32 v15, v15, v145
    v_add_f32 v15, v15, v155
    v_add_f32 v15, v15, v165
    v_add_f32 v15, v15, v175
    v_add_f32 v15, v15, v185
    v_add_f32 v15, v15, v195
    v_cvt_pk_bf16_f32 v16, v14, v15
    v_lshlrev_b32 v14, 16, v16
    v_and_b32 v15, 0xffff0000, v16
    v_mul_f32 v14, v20, v14
    v_mul_f32 v15, v20, v15
    v_cvt_pk_bf16_f32 v16, v14, v15
    v_lshlrev_b32 v17, 16, v119
    v_and_b32 v18, 0xffff0000, v119
    v_mul_f32 v17, v21, v17
    v_mul_f32 v18, v21, v18
    v_cvt_pk_bf16_f32 v19, v17, v18
    v_lshlrev_b32 v14, 16, v16
    v_and_b32 v15, 0xffff0000, v16
    v_lshlrev_b32 v17, 16, v19
    v_and_b32 v18, 0xffff0000, v19
    v_add_f32 v14, v14, v17
    v_add_f32 v15, v15, v18
    v_cvt_pk_bf16_f32 v114, v14, v15
    buffer_store_dword v114, v4, s[24:27], s28 offen offset:0
    v_add_f32 v14, v126, v136
    v_add_f32 v14, v14, v146
    v_add_f32 v14, v14, v156
    v_add_f32 v14, v14, v166
    v_add_f32 v14, v14, v176
    v_add_f32 v14, v14, v186
    v_add_f32 v14, v14, v196
    v_add_f32 v15, v127, v137
    v_add_f32 v15, v15, v147
    v_add_f32 v15, v15, v157
    v_add_f32 v15, v15, v167
    v_add_f32 v15, v15, v177
    v_add_f32 v15, v15, v187
    v_add_f32 v15, v15, v197
    v_cvt_pk_bf16_f32 v16, v14, v15
    v_lshlrev_b32 v14, 16, v16
    v_and_b32 v15, 0xffff0000, v16
    v_mul_f32 v14, v20, v14
    v_mul_f32 v15, v20, v15
    v_cvt_pk_bf16_f32 v16, v14, v15
    v_lshlrev_b32 v17, 16, v120
    v_and_b32 v18, 0xffff0000, v120
    v_mul_f32 v17, v21, v17
    v_mul_f32 v18, v21, v18
    v_cvt_pk_bf16_f32 v19, v17, v18
    v_lshlrev_b32 v14, 16, v16
    v_and_b32 v15, 0xffff0000, v16
    v_lshlrev_b32 v17, 16, v19
    v_and_b32 v18, 0xffff0000, v19
    v_add_f32 v14, v14, v17
    v_add_f32 v15, v15, v18
    v_cvt_pk_bf16_f32 v115, v14, v15
    buffer_store_dword v115, v4, s[24:27], s28 offen offset:256
    v_add_f32 v14, v128, v138
    v_add_f32 v14, v14, v148
    v_add_f32 v14, v14, v158
    v_add_f32 v14, v14, v168
    v_add_f32 v14, v14, v178
    v_add_f32 v14, v14, v188
    v_add_f32 v14, v14, v198
    v_add_f32 v15, v129, v139
    v_add_f32 v15, v15, v149
    v_add_f32 v15, v15, v159
    v_add_f32 v15, v15, v169
    v_add_f32 v15, v15, v179
    v_add_f32 v15, v15, v189
    v_add_f32 v15, v15, v199
    v_cvt_pk_bf16_f32 v16, v14, v15
    v_lshlrev_b32 v14, 16, v16
    v_and_b32 v15, 0xffff0000, v16
    v_mul_f32 v14, v20, v14
    v_mul_f32 v15, v20, v15
    v_cvt_pk_bf16_f32 v16, v14, v15
    v_lshlrev_b32 v17, 16, v121
    v_and_b32 v18, 0xffff0000, v121
    v_mul_f32 v17, v21, v17
    v_mul_f32 v18, v21, v18
    v_cvt_pk_bf16_f32 v19, v17, v18
    v_lshlrev_b32 v14, 16, v16
    v_and_b32 v15, 0xffff0000, v16
    v_lshlrev_b32 v17, 16, v19
    v_and_b32 v18, 0xffff0000, v19
    v_add_f32 v14, v14, v17
    v_add_f32 v15, v15, v18
    v_cvt_pk_bf16_f32 v116, v14, v15
    buffer_store_dword v116, v4, s[24:27], s28 offen offset:512
    v_add_f32 v14, v130, v140
    v_add_f32 v14, v14, v150
    v_add_f32 v14, v14, v160
    v_add_f32 v14, v14, v170
    v_add_f32 v14, v14, v180
    v_add_f32 v14, v14, v190
    v_add_f32 v14, v14, v200
    v_add_f32 v15, v131, v141
    v_add_f32 v15, v15, v151
    v_add_f32 v15, v15, v161
    v_add_f32 v15, v15, v171
    v_add_f32 v15, v15, v181
    v_add_f32 v15, v15, v191
    v_add_f32 v15, v15, v201
    v_cvt_pk_bf16_f32 v16, v14, v15
    v_lshlrev_b32 v14, 16, v16
    v_and_b32 v15, 0xffff0000, v16
    v_mul_f32 v14, v20, v14
    v_mul_f32 v15, v20, v15
    v_cvt_pk_bf16_f32 v16, v14, v15
    v_lshlrev_b32 v17, 16, v122
    v_and_b32 v18, 0xffff0000, v122
    v_mul_f32 v17, v21, v17
    v_mul_f32 v18, v21, v18
    v_cvt_pk_bf16_f32 v19, v17, v18
    v_lshlrev_b32 v14, 16, v16
    v_and_b32 v15, 0xffff0000, v16
    v_lshlrev_b32 v17, 16, v19
    v_and_b32 v18, 0xffff0000, v19
    v_add_f32 v14, v14, v17
    v_add_f32 v15, v15, v18
    v_cvt_pk_bf16_f32 v117, v14, v15
    buffer_store_dword v117, v4, s[24:27], s28 offen offset:768
    v_add_f32 v14, v132, v142
    v_add_f32 v14, v14, v152
    v_add_f32 v14, v14, v162
    v_add_f32 v14, v14, v172
    v_add_f32 v14, v14, v182
    v_add_f32 v14, v14, v192
    v_add_f32 v14, v14, v202
    v_add_f32 v15, v133, v143
    v_add_f32 v15, v15, v153
    v_add_f32 v15, v15, v163
    v_add_f32 v15, v15, v173
    v_add_f32 v15, v15, v183
    v_add_f32 v15, v15, v193
    v_add_f32 v15, v15, v203
    v_cvt_pk_bf16_f32 v16, v14, v15
    v_lshlrev_b32 v14, 16, v16
    v_and_b32 v15, 0xffff0000, v16
    v_mul_f32 v14, v20, v14
    v_mul_f32 v15, v20, v15
    v_cvt_pk_bf16_f32 v16, v14, v15
    v_lshlrev_b32 v17, 16, v123
    v_and_b32 v18, 0xffff0000, v123
    v_mul_f32 v17, v21, v17
    v_mul_f32 v18, v21, v18
    v_cvt_pk_bf16_f32 v19, v17, v18
    v_lshlrev_b32 v14, 16, v16
    v_and_b32 v15, 0xffff0000, v16
    v_lshlrev_b32 v17, 16, v19
    v_and_b32 v18, 0xffff0000, v19
    v_add_f32 v14, v14, v17
    v_add_f32 v15, v15, v18
    v_cvt_pk_bf16_f32 v118, v14, v15
    buffer_store_dword v118, v4, s[24:27], s28 offen offset:1024
    s_branch Lcn
fused_kernel_exit:
    s_waitcnt vmcnt(0)
    s_endpgm
.section .rodata,"a"
.p2align 6
.amdhsa_kernel fused_kernel
  .amdhsa_next_free_vgpr 512
  .amdhsa_next_free_sgpr 102
  .amdhsa_accum_offset 256
  .amdhsa_group_segment_fixed_size 0
  .amdhsa_kernarg_size 160
  .amdhsa_user_sgpr_count 2
  .amdhsa_user_sgpr_kernarg_segment_ptr 1
  .amdhsa_system_sgpr_workgroup_id_x 1
.end_amdhsa_kernel
.text
```
